```python
import torch

def _softmax(x, axis=-1):
    return torch.softmax(x, dim=axis)

def _gelu(x):
    return torch.nn.functional.gelu(x, approximate='tanh')

def _silu(x):
    return torch.nn.functional.silu(x)

def _sigmoid(x):
    return torch.sigmoid(x)

def _layernorm(x, axis=-1, eps=1e-05):
    m = x.mean(dim=axis, keepdim=True)
    v = x.var(dim=axis, keepdim=True, unbiased=False)
    return (x - m) / torch.sqrt(v + eps)

def _scatter_add(tgt, idx, src, axis=0):
    return tgt.clone().index_add_(axis, idx, src)

def _segment_sum(src, seg, n):
    out = torch.zeros((n,) + src.shape[1:], dtype=src.dtype)
    return out.index_add_(0, seg, src)

def _pad(x, pw):
    flat = tuple((v for pair in reversed(pw) for v in pair))
    return torch.nn.functional.pad(x, flat)
kernel_name = 'standalone__conformer_conv_module__speech'

def setup_inputs():

    _w = lambda a: (lambda t: t.to(torch.bfloat16) if t.is_floating_point() else t)(torch.as_tensor(a))
    B, T, D, K = (2, 16000, 512, 5)
    return {'x': _w((lambda *s: torch.randn(*s, dtype=torch.bfloat16) * 0.2)(B, T, D)), 'w_pw1': _w((lambda *s: torch.randn(*s, dtype=torch.bfloat16) * 0.2)(D, 2 * D)), 'dw': _w((lambda *s: torch.randn(*s, dtype=torch.bfloat16) * 0.2)(K, D)), 'w_pw2': _w((lambda *s: torch.randn(*s, dtype=torch.bfloat16) * 0.05)(D, D))}

def reference(x, w_pw1, dw, w_pw2):
    B, T, D = x.shape
    K = dw.shape[0]
    h = x @ w_pw1
    a, b = (h[..., :D].clone(), h[..., D:].clone())
    h = a * _sigmoid(b)
    pad = K // 2
    hp = _pad(h, ((0, 0), (pad, pad), (0, 0)))
    out = torch.zeros_like(h)
    for i in range(K):
        out = out + hp[:, i:i + T, :] * dw[i][None, None, :]
    return _silu(out) @ w_pw2
```

```asm
; @launch grid=(256,1,1) block=(512,1,1) lds=163840
.amdgcn_target "amdgcn-amd-amdhsa--gfx950"
.text
.globl standalone__conformer_conv_module__speech_kernel
.p2align 8
.type standalone__conformer_conv_module__speech_kernel,@function
standalone__conformer_conv_module__speech_kernel:
    s_cmp_ge_u32 s2, 256
    s_cbranch_scc1 L_exit
    s_load_dwordx4 s[4:7], s[0:1], 0
    s_load_dwordx4 s[12:15], s[0:1], 16
    s_load_dwordx4 s[16:19], s[0:1], 32
    s_load_dwordx2 s[24:25], s[0:1], 48
    v_lshrrev_b32 v8, 6, v0
    v_and_b32 v92, 63, v0
    v_readfirstlane_b32 s32, v8
    s_lshr_b32 s50, s2, 3
    s_max_u32 s52, s2, 239
    s_sub_u32 s52, s52, 239
    s_bfm_b32 s53, s52, 0
    s_and_b32 s53, s53, 121856
    s_bcnt1_i32_b32 s53, s53
    s_mov_b32 s58, s53
    s_sub_u32 s2, s2, s53
    s_lshr_b32 s55, 121856, s52
    s_lshl_b32 s37, s2, 17
    v_lshrrev_b32 v8, 4, v92
    s_lshr_b32 s33, s32, 2
    s_and_b32 s34, s32, 3
    s_and_b32 s52, s34, 1
    s_lshl_b32 s52, s52, 3
    s_lshr_b32 s53, s34, 1
    s_or_b32 s52, s52, s53
    v_xor_b32 v9, s52, v92
    v_and_b32 v96, 7, v9
    v_lshlrev_b32 v96, 4, v96
    v_lshrrev_b32 v9, 3, v9
    v_lshl_add_u32 v96, v9, 10, v96
    v_xor_b32 v97, 32, v96
    v_xor_b32 v98, 64, v96
    v_xor_b32 v99, 96, v96
    s_lshl_b32 s52, s34, 13
    s_add_u32 s36, s52, s37
    s_lshl_b32 s59, s34, 10
    v_lshrrev_b32 v15, 1, v92
    v_lshlrev_b32 v15, 10, v15
    v_and_b32 v14, 1, v92
    v_lshl_add_u32 v15, v14, 7, v15
    s_getpc_b64 s[56:57]
L_pc:
    s_lshl_b32 s54, s50, 3
    s_add_u32 s54, s54, s32
    s_lshl_b32 s54, s54, 8
    s_min_u32 s54, s54, L_exit-L_pc-320
    s_and_b32 s56, s56, 0xffffff80
    s_waitcnt lgkmcnt(0)
    s_mov_b32 s8, s6
    s_mov_b32 s9, s7
    s_mov_b32 s6, 32768000
    s_mov_b32 s7, 0x20000
    s_mov_b32 s10, 1048576
    s_mov_b32 s11, 0x20000
    s_bitcmp1_b32 s55, 0
    s_cbranch_scc1 L_helper
    s_cmp_eq_u32 s33, 0
    s_cbranch_scc1 L_A
    s_load_dwordx2 s[94:95], s[56:57], s54 offset:188
    s_load_dwordx2 s[94:95], s[56:57], s54 offset:316
    s_cmp_eq_u32 s34, 0
    s_cbranch_scc0 L_only1
    s_lshl_b32 s54, s50, 15
    s_add_u32 s54, s54, 0
    buffer_load_dword v100, v15, s[8:11], s54 offen
L_only1:
    s_add_u32 m0, s59, 0
    s_add_u32 s52, s36, 0
    buffer_load_dwordx4 v96, s[4:7], s52 offen nt lds
    s_add_u32 m0, s59, 4096
    s_add_u32 s52, s36, 32768
    buffer_load_dwordx4 v97, s[4:7], s52 offen nt lds
    s_add_u32 m0, s59, 8192
    s_add_u32 s52, s36, 65536
    buffer_load_dwordx4 v98, s[4:7], s52 offen nt lds
    s_add_u32 m0, s59, 12288
    s_add_u32 s52, s36, 98304
    buffer_load_dwordx4 v99, s[4:7], s52 offen nt lds
    s_barrier
    s_branch L_B
L_A:
    s_load_dwordx2 s[94:95], s[56:57], s54 offset:188
    s_load_dwordx2 s[94:95], s[56:57], s54 offset:316
    s_lshl_b32 s35, s34, 13
    s_add_u32 s35, s35, 131072
    s_lshl_b32 s39, s32, 6
    v_bfe_u32 v9, v92, 2, 2
    v_lshl_add_u32 v6, v8, 3, v9
    v_lshlrev_b32 v6, 11, v6
    v_lshlrev_b32 v9, 1, v8
    v_xor_b32 v9, v9, v92
    v_and_b32 v9, 3, v9
    v_lshl_add_u32 v6, v9, 4, v6
    s_barrier
    s_add_u32 m0, s35, 0
    s_add_u32 s38, s39, 0
    buffer_load_dwordx4 v6, s[8:11], s38 offen offset:0 lds
    buffer_load_dwordx4 v6, s[8:11], s38 offen offset:1024 lds
    s_add_u32 s38, s39, 6144
    buffer_load_dwordx4 v6, s[8:11], s38 offen offset:2048 lds
    buffer_load_dwordx4 v6, s[8:11], s38 offen offset:3072 lds
    s_add_u32 m0, s35, 4096
    s_add_u32 s38, s39, 65536
    buffer_load_dwordx4 v6, s[8:11], s38 offen offset:0 lds
    buffer_load_dwordx4 v6, s[8:11], s38 offen offset:1024 lds
    s_add_u32 s38, s39, 71680
    buffer_load_dwordx4 v6, s[8:11], s38 offen offset:2048 lds
    buffer_load_dwordx4 v6, s[8:11], s38 offen offset:3072 lds
    s_lshl_b32 s96, s34, 12
    s_add_u32 s96, s96, 98304
    v_lshrrev_b32 v4, 2, v92
    v_lshlrev_b32 v4, 6, v4
    v_bfe_u32 v5, v92, 4, 1
    v_lshl_add_u32 v4, v5, 5, v4
    v_and_b32 v5, 3, v92
    v_lshl_add_u32 v4, v5, 3, v4
    v_add_u32 v4, s35, v4
    v_xor_b32 v5, 32, v4
    v_bfe_u32 v9, v92, 1, 3
    v_xor_b32 v9, v9, v8
    v_lshlrev_b32 v0, 4, v9
    v_and_b32 v9, 15, v92
    v_lshl_add_u32 v0, v9, 10, v0
    v_and_b32 v9, 1, v92
    v_lshl_add_u32 v0, v9, 7, v0
    v_xor_b32 v1, 64, v0
    v_xor_b32 v2, 128, v0
    v_xor_b32 v3, 192, v0
    v_lshlrev_b32 v7, 4, v92
    s_mov_b32 s20, s12
    s_mov_b32 s21, s13
    s_mov_b32 s12, s14
    s_mov_b32 s13, s15
    s_mov_b32 s28, s18
    s_mov_b32 s29, s19
    s_mov_b32 s14, 524288
    s_mov_b32 s15, 0x20000
    s_mov_b32 s18, 32768000
    s_mov_b32 s19, 0x20000
    s_mov_b32 s22, 5120
    s_mov_b32 s23, 0x20000
    s_mov_b32 s26, 2097152
    s_mov_b32 s27, 0x20000
    s_mov_b32 s30, 256
    s_mov_b32 s31, 0x20000
    s_mov_b32 s40, 0xbfb8aa3b
    s_mov_b32 s41, 0xbf317218
    s_lshl_b32 s51, s33, 8
    s_add_u32 s51, s51, s2
    s_lshl_b32 s51, s51, 2
    s_add_u32 s51, s51, s34
    s_lshl_b32 s51, s51, 8
    s_mov_b32 s44, 0x10001
    s_mov_b32 s45, 0x10001
    s_mov_b32 s46, 0x80008000
    s_mov_b32 s47, 0x80008000
    s_mov_b32 s48, 0x80018001
    s_mov_b32 s49, 0x80018001
    s_cmp_ge_u32 s2, 125
    s_cselect_b32 s52, 125, 0
    s_sub_u32 s52, s2, s52
    s_cmp_lg_u32 s52, 0
    s_cselect_b32 s97, 64, 1073741824
    s_cmp_lg_u32 s52, 124
    s_mov_b32 s53, 2048
    s_cselect_b32 s3, s53, 1073741824
    s_sub_u32 s52, s35, s96
    v_subrev_u32 v100, s52, v4
    v_subrev_u32 v101, s52, v5
    s_waitcnt vmcnt(7)
    ds_read_b64_tr_b16 v[32:33], v4 offset:0
    ds_read_b64_tr_b16 v[40:41], v5 offset:0
    s_add_u32 m0, s96, 16384
    s_add_u32 s38, s39, 131072
    buffer_load_dwordx4 v6, s[8:11], s38 offen offset:0 lds
    s_waitcnt vmcnt(7)
    ds_read_b64_tr_b16 v[48:49], v4 offset:1024
    ds_read_b64_tr_b16 v[56:57], v5 offset:1024
    s_add_u32 m0, s96, 16384
    s_add_u32 s38, s39, 131072
    buffer_load_dwordx4 v6, s[8:11], s38 offen offset:1024 lds
    s_waitcnt vmcnt(7)
    ds_read_b64_tr_b16 v[34:35], v4 offset:2048
    ds_read_b64_tr_b16 v[42:43], v5 offset:2048
    s_add_u32 m0, s96, 16384
    s_add_u32 s38, s39, 137216
    buffer_load_dwordx4 v6, s[8:11], s38 offen offset:2048 lds
    s_waitcnt vmcnt(7)
    ds_read_b64_tr_b16 v[50:51], v4 offset:3072
    ds_read_b64_tr_b16 v[58:59], v5 offset:3072
    s_add_u32 m0, s96, 16384
    s_add_u32 s38, s39, 137216
    buffer_load_dwordx4 v6, s[8:11], s38 offen offset:3072 lds
    s_waitcnt vmcnt(7)
    ds_read_b64_tr_b16 v[36:37], v4 offset:4096
    ds_read_b64_tr_b16 v[44:45], v5 offset:4096
    s_add_u32 m0, s96, 0
    s_add_u32 s38, s39, 196608
    buffer_load_dwordx4 v6, s[8:11], s38 offen offset:0 lds
    s_waitcnt vmcnt(7)
    ds_read_b64_tr_b16 v[52:53], v4 offset:5120
    ds_read_b64_tr_b16 v[60:61], v5 offset:5120
    s_add_u32 m0, s96, 0
    s_add_u32 s38, s39, 196608
    buffer_load_dwordx4 v6, s[8:11], s38 offen offset:1024 lds
    s_waitcnt vmcnt(7)
    ds_read_b64_tr_b16 v[38:39], v4 offset:6144
    ds_read_b64_tr_b16 v[46:47], v5 offset:6144
    s_add_u32 m0, s96, 0
    s_add_u32 s38, s39, 202752
    buffer_load_dwordx4 v6, s[8:11], s38 offen offset:2048 lds
    s_waitcnt vmcnt(7)
    ds_read_b64_tr_b16 v[54:55], v4 offset:7168
    ds_read_b64_tr_b16 v[62:63], v5 offset:7168
    s_add_u32 m0, s96, 0
    s_add_u32 s38, s39, 202752
    buffer_load_dwordx4 v6, s[8:11], s38 offen offset:3072 lds
    s_mov_b64 vcc, 0
    s_barrier
    ds_read_b128 v[8:11], v0 offset:0
    ds_read_b128 v[12:15], v1 offset:0
    ds_read_b128 v[16:19], v2 offset:0
    ds_read_b128 v[20:23], v3 offset:0
    s_setprio 2
    s_waitcnt lgkmcnt(2)
    v_mfma_f32_16x16x32_bf16 v[128:131], v[32:35], v[8:11], 0
    s_add_u32 m0, s35, 0
    s_add_u32 s38, s39, 262144
    buffer_load_dwordx4 v6, s[8:11], s38 offen offset:0 lds
    v_mfma_f32_16x16x32_bf16 v[128:131], v[36:39], v[12:15], v[128:131]
    s_waitcnt vmcnt(8)
    ds_read_b64_tr_b16 v[64:65], v100 offset:16384
    v_mfma_f32_16x16x32_bf16 v[160:163], v[44:47], v[12:15], 0
    ds_read_b64_tr_b16 v[72:73], v101 offset:16384
    v_mfma_f32_16x16x32_bf16 v[160:163], v[40:43], v[8:11], v[160:163]
    ds_read_b128 v[24:27], v0 offset:256
    v_mfma_f32_16x16x32_bf16 v[192:195], v[48:51], v[8:11], 0
    ds_read_b128 v[28:31], v1 offset:256
    v_mfma_f32_16x16x32_bf16 v[192:195], v[52:55], v[12:15], v[192:195]
    s_add_u32 m0, s59, 32768
    s_add_u32 s52, s36, 256
    buffer_load_dwordx4 v96, s[4:7], s52 offen nt lds
    s_add_u32 m0, s59, 36864
    s_add_u32 s52, s36, 33024
    buffer_load_dwordx4 v97, s[4:7], s52 offen nt lds
    s_add_u32 m0, s59, 40960
    s_add_u32 s52, s36, 65792
    buffer_load_dwordx4 v98, s[4:7], s52 offen nt lds
    s_add_u32 m0, s59, 45056
    s_add_u32 s52, s36, 98560
    buffer_load_dwordx4 v99, s[4:7], s52 offen nt lds
    v_mfma_f32_16x16x32_bf16 v[224:227], v[60:63], v[12:15], 0
    s_add_u32 m0, s96, 16384
    s_add_u32 s38, s39, 393216
    v_mfma_f32_16x16x32_bf16 v[224:227], v[56:59], v[8:11], v[224:227]
    s_waitcnt lgkmcnt(2)
    v_mfma_f32_16x16x32_bf16 v[132:135], v[32:35], v[16:19], 0
    buffer_load_dwordx4 v6, s[8:11], s38 offen offset:0 lds
    s_add_u32 m0, s35, 0
    s_add_u32 s38, s39, 262144
    buffer_load_dwordx4 v6, s[8:11], s38 offen offset:1024 lds
    v_mfma_f32_16x16x32_bf16 v[132:135], v[36:39], v[20:23], v[132:135]
    s_waitcnt vmcnt(13)
    ds_read_b64_tr_b16 v[80:81], v100 offset:17408
    v_mfma_f32_16x16x32_bf16 v[164:167], v[44:47], v[20:23], 0
    ds_read_b64_tr_b16 v[88:89], v101 offset:17408
    v_mfma_f32_16x16x32_bf16 v[164:167], v[40:43], v[16:19], v[164:167]
    ds_read_b128 v[8:11], v2 offset:256
    v_mfma_f32_16x16x32_bf16 v[196:199], v[48:51], v[16:19], 0
    ds_read_b128 v[12:15], v3 offset:256
    v_mfma_f32_16x16x32_bf16 v[196:199], v[52:55], v[20:23], v[196:199]
    v_mfma_f32_16x16x32_bf16 v[228:231], v[60:63], v[20:23], 0
    s_add_u32 m0, s96, 16384
    s_add_u32 s38, s39, 393216
    v_mfma_f32_16x16x32_bf16 v[228:231], v[56:59], v[16:19], v[228:231]
    s_waitcnt lgkmcnt(2)
    v_mfma_f32_16x16x32_bf16 v[136:139], v[32:35], v[24:27], 0
    buffer_load_dwordx4 v6, s[8:11], s38 offen offset:1024 lds
    s_add_u32 m0, s35, 0
    s_add_u32 s38, s39, 268288
    buffer_load_dwordx4 v6, s[8:11], s38 offen offset:2048 lds
    v_mfma_f32_16x16x32_bf16 v[136:139], v[36:39], v[28:31], v[136:139]
    s_waitcnt vmcnt(14)
    ds_read_b64_tr_b16 v[66:67], v100 offset:18432
    v_mfma_f32_16x16x32_bf16 v[168:171], v[44:47], v[28:31], 0
    ds_read_b64_tr_b16 v[74:75], v101 offset:18432
    v_mfma_f32_16x16x32_bf16 v[168:171], v[40:43], v[24:27], v[168:171]
    ds_read_b128 v[16:19], v0 offset:512
    v_mfma_f32_16x16x32_bf16 v[200:203], v[48:51], v[24:27], 0
    ds_read_b128 v[20:23], v1 offset:512
    v_mfma_f32_16x16x32_bf16 v[200:203], v[52:55], v[28:31], v[200:203]
    v_mfma_f32_16x16x32_bf16 v[232:235], v[60:63], v[28:31], 0
    s_add_u32 m0, s96, 16384
    s_add_u32 s38, s39, 399360
    v_mfma_f32_16x16x32_bf16 v[232:235], v[56:59], v[24:27], v[232:235]
    s_waitcnt lgkmcnt(2)
    v_mfma_f32_16x16x32_bf16 v[140:143], v[32:35], v[8:11], 0
    buffer_load_dwordx4 v6, s[8:11], s38 offen offset:2048 lds
    s_add_u32 m0, s35, 0
    s_add_u32 s38, s39, 268288
    buffer_load_dwordx4 v6, s[8:11], s38 offen offset:3072 lds
    v_mfma_f32_16x16x32_bf16 v[140:143], v[36:39], v[12:15], v[140:143]
    s_waitcnt vmcnt(15)
    ds_read_b64_tr_b16 v[82:83], v100 offset:19456
    v_mfma_f32_16x16x32_bf16 v[172:175], v[44:47], v[12:15], 0
    ds_read_b64_tr_b16 v[90:91], v101 offset:19456
    v_mfma_f32_16x16x32_bf16 v[172:175], v[40:43], v[8:11], v[172:175]
    ds_read_b128 v[24:27], v2 offset:512
    v_mfma_f32_16x16x32_bf16 v[204:207], v[48:51], v[8:11], 0
    ds_read_b128 v[28:31], v3 offset:512
    v_mfma_f32_16x16x32_bf16 v[204:207], v[52:55], v[12:15], v[204:207]
    v_mfma_f32_16x16x32_bf16 v[236:239], v[60:63], v[12:15], 0
    s_add_u32 m0, s96, 16384
    s_add_u32 s38, s39, 399360
    v_mfma_f32_16x16x32_bf16 v[236:239], v[56:59], v[8:11], v[236:239]
    s_waitcnt lgkmcnt(2)
    v_mfma_f32_16x16x32_bf16 v[144:147], v[32:35], v[16:19], 0
    buffer_load_dwordx4 v6, s[8:11], s38 offen offset:3072 lds
    s_add_u32 m0, s35, 4096
    s_add_u32 s38, s39, 327680
    buffer_load_dwordx4 v6, s[8:11], s38 offen offset:0 lds
    v_mfma_f32_16x16x32_bf16 v[144:147], v[36:39], v[20:23], v[144:147]
    s_waitcnt vmcnt(16)
    ds_read_b64_tr_b16 v[68:69], v100 offset:0
    v_mfma_f32_16x16x32_bf16 v[176:179], v[44:47], v[20:23], 0
    ds_read_b64_tr_b16 v[76:77], v101 offset:0
    v_mfma_f32_16x16x32_bf16 v[176:179], v[40:43], v[16:19], v[176:179]
    ds_read_b128 v[8:11], v0 offset:768
    v_mfma_f32_16x16x32_bf16 v[208:211], v[48:51], v[16:19], 0
    ds_read_b128 v[12:15], v1 offset:768
    v_mfma_f32_16x16x32_bf16 v[208:211], v[52:55], v[20:23], v[208:211]
    v_mfma_f32_16x16x32_bf16 v[240:243], v[60:63], v[20:23], 0
    s_add_u32 m0, s96, 0
    s_add_u32 s38, s39, 458752
    v_mfma_f32_16x16x32_bf16 v[240:243], v[56:59], v[16:19], v[240:243]
    s_waitcnt lgkmcnt(2)
    v_mfma_f32_16x16x32_bf16 v[148:151], v[32:35], v[24:27], 0
    buffer_load_dwordx4 v6, s[8:11], s38 offen offset:0 lds
    s_add_u32 m0, s35, 4096
    s_add_u32 s38, s39, 327680
    buffer_load_dwordx4 v6, s[8:11], s38 offen offset:1024 lds
    v_mfma_f32_16x16x32_bf16 v[148:151], v[36:39], v[28:31], v[148:151]
    s_waitcnt vmcnt(17)
    ds_read_b64_tr_b16 v[84:85], v100 offset:1024
    v_mfma_f32_16x16x32_bf16 v[180:183], v[44:47], v[28:31], 0
    ds_read_b64_tr_b16 v[92:93], v101 offset:1024
    v_mfma_f32_16x16x32_bf16 v[180:183], v[40:43], v[24:27], v[180:183]
    ds_read_b128 v[16:19], v2 offset:768
    v_mfma_f32_16x16x32_bf16 v[212:215], v[48:51], v[24:27], 0
    ds_read_b128 v[20:23], v3 offset:768
    v_mfma_f32_16x16x32_bf16 v[212:215], v[52:55], v[28:31], v[212:215]
    v_mfma_f32_16x16x32_bf16 v[244:247], v[60:63], v[28:31], 0
    s_add_u32 m0, s96, 0
    s_add_u32 s38, s39, 458752
    v_mfma_f32_16x16x32_bf16 v[244:247], v[56:59], v[24:27], v[244:247]
    s_waitcnt lgkmcnt(2)
    v_mfma_f32_16x16x32_bf16 v[152:155], v[32:35], v[8:11], 0
    buffer_load_dwordx4 v6, s[8:11], s38 offen offset:1024 lds
    s_add_u32 m0, s35, 4096
    s_add_u32 s38, s39, 333824
    buffer_load_dwordx4 v6, s[8:11], s38 offen offset:2048 lds
    v_mfma_f32_16x16x32_bf16 v[152:155], v[36:39], v[12:15], v[152:155]
    s_waitcnt vmcnt(18)
    ds_read_b64_tr_b16 v[70:71], v100 offset:2048
    v_mfma_f32_16x16x32_bf16 v[184:187], v[44:47], v[12:15], 0
    ds_read_b64_tr_b16 v[78:79], v101 offset:2048
    v_mfma_f32_16x16x32_bf16 v[184:187], v[40:43], v[8:11], v[184:187]
    s_barrier
    ds_read_b128 v[24:27], v0 offset:16384
    v_mfma_f32_16x16x32_bf16 v[216:219], v[48:51], v[8:11], 0
    ds_read_b128 v[28:31], v1 offset:16384
    v_mfma_f32_16x16x32_bf16 v[216:219], v[52:55], v[12:15], v[216:219]
    v_mfma_f32_16x16x32_bf16 v[248:251], v[60:63], v[12:15], 0
    s_add_u32 m0, s96, 0
    s_add_u32 s38, s39, 464896
    v_mfma_f32_16x16x32_bf16 v[248:251], v[56:59], v[8:11], v[248:251]
    s_waitcnt lgkmcnt(2)
    v_mfma_f32_16x16x32_bf16 v[156:159], v[32:35], v[16:19], 0
    buffer_load_dwordx4 v6, s[8:11], s38 offen offset:2048 lds
    s_add_u32 m0, s35, 4096
    s_add_u32 s38, s39, 333824
    buffer_load_dwordx4 v6, s[8:11], s38 offen offset:3072 lds
    v_mfma_f32_16x16x32_bf16 v[156:159], v[36:39], v[20:23], v[156:159]
    s_waitcnt vmcnt(19)
    ds_read_b64_tr_b16 v[86:87], v100 offset:3072
    v_mfma_f32_16x16x32_bf16 v[188:191], v[44:47], v[20:23], 0
    ds_read_b64_tr_b16 v[94:95], v101 offset:3072
    v_mfma_f32_16x16x32_bf16 v[188:191], v[40:43], v[16:19], v[188:191]
    ds_read_b128 v[8:11], v2 offset:16384
    v_mfma_f32_16x16x32_bf16 v[220:223], v[48:51], v[16:19], 0
    ds_read_b128 v[12:15], v3 offset:16384
    v_mfma_f32_16x16x32_bf16 v[220:223], v[52:55], v[20:23], v[220:223]
    v_mfma_f32_16x16x32_bf16 v[252:255], v[60:63], v[20:23], 0
    s_add_u32 m0, s96, 0
    s_add_u32 s38, s39, 464896
    v_mfma_f32_16x16x32_bf16 v[252:255], v[56:59], v[16:19], v[252:255]
    s_waitcnt lgkmcnt(2)
    v_mfma_f32_16x16x32_bf16 v[128:131], v[64:67], v[24:27], v[128:131]
    buffer_load_dwordx4 v6, s[8:11], s38 offen offset:3072 lds
    v_mfma_f32_16x16x32_bf16 v[128:131], v[68:71], v[28:31], v[128:131]
    s_waitcnt vmcnt(19)
    ds_read_b64_tr_b16 v[32:33], v4 offset:0
    v_mfma_f32_16x16x32_bf16 v[160:163], v[76:79], v[28:31], v[160:163]
    ds_read_b64_tr_b16 v[40:41], v5 offset:0
    v_mfma_f32_16x16x32_bf16 v[160:163], v[72:75], v[24:27], v[160:163]
    ds_read_b128 v[16:19], v0 offset:16640
    v_mfma_f32_16x16x32_bf16 v[192:195], v[80:83], v[24:27], v[192:195]
    ds_read_b128 v[20:23], v1 offset:16640
    v_mfma_f32_16x16x32_bf16 v[192:195], v[84:87], v[28:31], v[192:195]
    s_add_u32 m0, s59, 49152
    s_add_u32 s52, s36, 384
    buffer_load_dwordx4 v96, s[4:7], s52 offen nt lds
    s_add_u32 m0, s59, 53248
    s_add_u32 s52, s36, 33152
    buffer_load_dwordx4 v97, s[4:7], s52 offen nt lds
    s_add_u32 m0, s59, 57344
    s_add_u32 s52, s36, 65920
    buffer_load_dwordx4 v98, s[4:7], s52 offen nt lds
    s_add_u32 m0, s59, 61440
    s_add_u32 s52, s36, 98688
    buffer_load_dwordx4 v99, s[4:7], s52 offen nt lds
    v_mfma_f32_16x16x32_bf16 v[224:227], v[92:95], v[28:31], v[224:227]
    s_add_u32 m0, s35, 0
    s_add_u32 s38, s39, 524288
    v_mfma_f32_16x16x32_bf16 v[224:227], v[88:91], v[24:27], v[224:227]
    s_waitcnt lgkmcnt(2)
    v_mfma_f32_16x16x32_bf16 v[132:135], v[64:67], v[8:11], v[132:135]
    buffer_load_dwordx4 v6, s[8:11], s38 offen offset:0 lds
    v_mfma_f32_16x16x32_bf16 v[132:135], v[68:71], v[12:15], v[132:135]
    s_waitcnt vmcnt(18)
    ds_read_b64_tr_b16 v[48:49], v4 offset:1024
    v_mfma_f32_16x16x32_bf16 v[164:167], v[76:79], v[12:15], v[164:167]
    ds_read_b64_tr_b16 v[56:57], v5 offset:1024
    v_mfma_f32_16x16x32_bf16 v[164:167], v[72:75], v[8:11], v[164:167]
    ds_read_b128 v[24:27], v2 offset:16640
    v_mfma_f32_16x16x32_bf16 v[196:199], v[80:83], v[8:11], v[196:199]
    ds_read_b128 v[28:31], v3 offset:16640
    v_mfma_f32_16x16x32_bf16 v[196:199], v[84:87], v[12:15], v[196:199]
    v_mfma_f32_16x16x32_bf16 v[228:231], v[92:95], v[12:15], v[228:231]
    s_add_u32 m0, s35, 0
    s_add_u32 s38, s39, 524288
    v_mfma_f32_16x16x32_bf16 v[228:231], v[88:91], v[8:11], v[228:231]
    s_waitcnt lgkmcnt(2)
    v_mfma_f32_16x16x32_bf16 v[136:139], v[64:67], v[16:19], v[136:139]
    buffer_load_dwordx4 v6, s[8:11], s38 offen offset:1024 lds
    v_mfma_f32_16x16x32_bf16 v[136:139], v[68:71], v[20:23], v[136:139]
    s_waitcnt vmcnt(17)
    ds_read_b64_tr_b16 v[34:35], v4 offset:2048
    v_mfma_f32_16x16x32_bf16 v[168:171], v[76:79], v[20:23], v[168:171]
    ds_read_b64_tr_b16 v[42:43], v5 offset:2048
    v_mfma_f32_16x16x32_bf16 v[168:171], v[72:75], v[16:19], v[168:171]
    ds_read_b128 v[8:11], v0 offset:16896
    v_mfma_f32_16x16x32_bf16 v[200:203], v[80:83], v[16:19], v[200:203]
    ds_read_b128 v[12:15], v1 offset:16896
    v_mfma_f32_16x16x32_bf16 v[200:203], v[84:87], v[20:23], v[200:203]
    v_mfma_f32_16x16x32_bf16 v[232:235], v[92:95], v[20:23], v[232:235]
    s_add_u32 m0, s35, 0
    s_add_u32 s38, s39, 530432
    v_mfma_f32_16x16x32_bf16 v[232:235], v[88:91], v[16:19], v[232:235]
    s_waitcnt lgkmcnt(2)
    v_mfma_f32_16x16x32_bf16 v[140:143], v[64:67], v[24:27], v[140:143]
    buffer_load_dwordx4 v6, s[8:11], s38 offen offset:2048 lds
    v_mfma_f32_16x16x32_bf16 v[140:143], v[68:71], v[28:31], v[140:143]
    s_waitcnt vmcnt(16)
    ds_read_b64_tr_b16 v[50:51], v4 offset:3072
    v_mfma_f32_16x16x32_bf16 v[172:175], v[76:79], v[28:31], v[172:175]
    ds_read_b64_tr_b16 v[58:59], v5 offset:3072
    v_mfma_f32_16x16x32_bf16 v[172:175], v[72:75], v[24:27], v[172:175]
    ds_read_b128 v[16:19], v2 offset:16896
    v_mfma_f32_16x16x32_bf16 v[204:207], v[80:83], v[24:27], v[204:207]
    ds_read_b128 v[20:23], v3 offset:16896
    v_mfma_f32_16x16x32_bf16 v[204:207], v[84:87], v[28:31], v[204:207]
    v_mfma_f32_16x16x32_bf16 v[236:239], v[92:95], v[28:31], v[236:239]
    s_add_u32 m0, s35, 0
    s_add_u32 s38, s39, 530432
    v_mfma_f32_16x16x32_bf16 v[236:239], v[88:91], v[24:27], v[236:239]
    s_waitcnt lgkmcnt(2)
    v_mfma_f32_16x16x32_bf16 v[144:147], v[64:67], v[8:11], v[144:147]
    buffer_load_dwordx4 v6, s[8:11], s38 offen offset:3072 lds
    v_mfma_f32_16x16x32_bf16 v[144:147], v[68:71], v[12:15], v[144:147]
    s_waitcnt vmcnt(15)
    ds_read_b64_tr_b16 v[36:37], v4 offset:4096
    v_mfma_f32_16x16x32_bf16 v[176:179], v[76:79], v[12:15], v[176:179]
    ds_read_b64_tr_b16 v[44:45], v5 offset:4096
    v_mfma_f32_16x16x32_bf16 v[176:179], v[72:75], v[8:11], v[176:179]
    ds_read_b128 v[24:27], v0 offset:17152
    v_mfma_f32_16x16x32_bf16 v[208:211], v[80:83], v[8:11], v[208:211]
    ds_read_b128 v[28:31], v1 offset:17152
    v_mfma_f32_16x16x32_bf16 v[208:211], v[84:87], v[12:15], v[208:211]
    v_mfma_f32_16x16x32_bf16 v[240:243], v[92:95], v[12:15], v[240:243]
    s_add_u32 m0, s35, 4096
    s_add_u32 s38, s39, 589824
    v_mfma_f32_16x16x32_bf16 v[240:243], v[88:91], v[8:11], v[240:243]
    s_waitcnt lgkmcnt(2)
    v_mfma_f32_16x16x32_bf16 v[148:151], v[64:67], v[16:19], v[148:151]
    buffer_load_dwordx4 v6, s[8:11], s38 offen offset:0 lds
    v_mfma_f32_16x16x32_bf16 v[148:151], v[68:71], v[20:23], v[148:151]
    s_waitcnt vmcnt(14)
    ds_read_b64_tr_b16 v[52:53], v4 offset:5120
    v_mfma_f32_16x16x32_bf16 v[180:183], v[76:79], v[20:23], v[180:183]
    ds_read_b64_tr_b16 v[60:61], v5 offset:5120
    v_mfma_f32_16x16x32_bf16 v[180:183], v[72:75], v[16:19], v[180:183]
    ds_read_b128 v[8:11], v2 offset:17152
    v_mfma_f32_16x16x32_bf16 v[212:215], v[80:83], v[16:19], v[212:215]
    ds_read_b128 v[12:15], v3 offset:17152
    v_mfma_f32_16x16x32_bf16 v[212:215], v[84:87], v[20:23], v[212:215]
    v_mfma_f32_16x16x32_bf16 v[244:247], v[92:95], v[20:23], v[244:247]
    s_add_u32 m0, s35, 4096
    s_add_u32 s38, s39, 589824
    v_mfma_f32_16x16x32_bf16 v[244:247], v[88:91], v[16:19], v[244:247]
    s_waitcnt lgkmcnt(2)
    v_mfma_f32_16x16x32_bf16 v[152:155], v[64:67], v[24:27], v[152:155]
    buffer_load_dwordx4 v6, s[8:11], s38 offen offset:1024 lds
    v_mfma_f32_16x16x32_bf16 v[152:155], v[68:71], v[28:31], v[152:155]
    s_waitcnt vmcnt(13)
    ds_read_b64_tr_b16 v[38:39], v4 offset:6144
    v_mfma_f32_16x16x32_bf16 v[184:187], v[76:79], v[28:31], v[184:187]
    ds_read_b64_tr_b16 v[46:47], v5 offset:6144
    v_mfma_f32_16x16x32_bf16 v[184:187], v[72:75], v[24:27], v[184:187]
    s_barrier
    ds_read_b128 v[16:19], v0 offset:32768
    v_mfma_f32_16x16x32_bf16 v[216:219], v[80:83], v[24:27], v[216:219]
    ds_read_b128 v[20:23], v1 offset:32768
    v_mfma_f32_16x16x32_bf16 v[216:219], v[84:87], v[28:31], v[216:219]
    v_mfma_f32_16x16x32_bf16 v[248:251], v[92:95], v[28:31], v[248:251]
    s_add_u32 m0, s35, 4096
    s_add_u32 s38, s39, 595968
    v_mfma_f32_16x16x32_bf16 v[248:251], v[88:91], v[24:27], v[248:251]
    s_waitcnt lgkmcnt(2)
    v_mfma_f32_16x16x32_bf16 v[156:159], v[64:67], v[8:11], v[156:159]
    buffer_load_dwordx4 v6, s[8:11], s38 offen offset:2048 lds
    v_mfma_f32_16x16x32_bf16 v[156:159], v[68:71], v[12:15], v[156:159]
    s_waitcnt vmcnt(12)
    ds_read_b64_tr_b16 v[54:55], v4 offset:7168
    v_mfma_f32_16x16x32_bf16 v[188:191], v[76:79], v[12:15], v[188:191]
    ds_read_b64_tr_b16 v[62:63], v5 offset:7168
    v_mfma_f32_16x16x32_bf16 v[188:191], v[72:75], v[8:11], v[188:191]
    ds_read_b128 v[24:27], v2 offset:32768
    v_mfma_f32_16x16x32_bf16 v[220:223], v[80:83], v[8:11], v[220:223]
    ds_read_b128 v[28:31], v3 offset:32768
    v_mfma_f32_16x16x32_bf16 v[220:223], v[84:87], v[12:15], v[220:223]
    v_mfma_f32_16x16x32_bf16 v[252:255], v[92:95], v[12:15], v[252:255]
    s_add_u32 m0, s35, 4096
    s_add_u32 s38, s39, 595968
    v_mfma_f32_16x16x32_bf16 v[252:255], v[88:91], v[8:11], v[252:255]
    s_waitcnt lgkmcnt(2)
    v_mfma_f32_16x16x32_bf16 v[128:131], v[32:35], v[16:19], v[128:131]
    buffer_load_dwordx4 v6, s[8:11], s38 offen offset:3072 lds
    v_mfma_f32_16x16x32_bf16 v[128:131], v[36:39], v[20:23], v[128:131]
    ds_read_b64_tr_b16 v[64:65], v100 offset:16384
    v_mfma_f32_16x16x32_bf16 v[160:163], v[44:47], v[20:23], v[160:163]
    ds_read_b64_tr_b16 v[72:73], v101 offset:16384
    v_mfma_f32_16x16x32_bf16 v[160:163], v[40:43], v[16:19], v[160:163]
    ds_read_b128 v[8:11], v0 offset:33024
    v_mfma_f32_16x16x32_bf16 v[192:195], v[48:51], v[16:19], v[192:195]
    ds_read_b128 v[12:15], v1 offset:33024
    v_mfma_f32_16x16x32_bf16 v[192:195], v[52:55], v[20:23], v[192:195]
    s_add_u32 m0, s59, 65536
    s_add_u32 s52, s36, 512
    buffer_load_dwordx4 v96, s[4:7], s52 offen nt lds
    s_add_u32 m0, s59, 69632
    s_add_u32 s52, s36, 33280
    buffer_load_dwordx4 v97, s[4:7], s52 offen nt lds
    s_add_u32 m0, s59, 73728
    s_add_u32 s52, s36, 66048
    buffer_load_dwordx4 v98, s[4:7], s52 offen nt lds
    s_add_u32 m0, s59, 77824
    s_add_u32 s52, s36, 98816
    buffer_load_dwordx4 v99, s[4:7], s52 offen nt lds
    v_mfma_f32_16x16x32_bf16 v[224:227], v[60:63], v[20:23], v[224:227]
    s_add_u32 m0, s96, 16384
    s_add_u32 s38, s39, 655360
    v_mfma_f32_16x16x32_bf16 v[224:227], v[56:59], v[16:19], v[224:227]
    s_waitcnt lgkmcnt(2)
    v_mfma_f32_16x16x32_bf16 v[132:135], v[32:35], v[24:27], v[132:135]
    buffer_load_dwordx4 v6, s[8:11], s38 offen offset:0 lds
    v_mfma_f32_16x16x32_bf16 v[132:135], v[36:39], v[28:31], v[132:135]
    ds_read_b64_tr_b16 v[80:81], v100 offset:17408
    v_mfma_f32_16x16x32_bf16 v[164:167], v[44:47], v[28:31], v[164:167]
    ds_read_b64_tr_b16 v[88:89], v101 offset:17408
    v_mfma_f32_16x16x32_bf16 v[164:167], v[40:43], v[24:27], v[164:167]
    ds_read_b128 v[16:19], v2 offset:33024
    v_mfma_f32_16x16x32_bf16 v[196:199], v[48:51], v[24:27], v[196:199]
    ds_read_b128 v[20:23], v3 offset:33024
    v_mfma_f32_16x16x32_bf16 v[196:199], v[52:55], v[28:31], v[196:199]
    v_mfma_f32_16x16x32_bf16 v[228:231], v[60:63], v[28:31], v[228:231]
    s_add_u32 m0, s96, 16384
    s_add_u32 s38, s39, 655360
    v_mfma_f32_16x16x32_bf16 v[228:231], v[56:59], v[24:27], v[228:231]
    s_waitcnt lgkmcnt(2)
    v_mfma_f32_16x16x32_bf16 v[136:139], v[32:35], v[8:11], v[136:139]
    buffer_load_dwordx4 v6, s[8:11], s38 offen offset:1024 lds
    v_mfma_f32_16x16x32_bf16 v[136:139], v[36:39], v[12:15], v[136:139]
    ds_read_b64_tr_b16 v[66:67], v100 offset:18432
    v_mfma_f32_16x16x32_bf16 v[168:171], v[44:47], v[12:15], v[168:171]
    ds_read_b64_tr_b16 v[74:75], v101 offset:18432
    v_mfma_f32_16x16x32_bf16 v[168:171], v[40:43], v[8:11], v[168:171]
    ds_read_b128 v[24:27], v0 offset:33280
    v_mfma_f32_16x16x32_bf16 v[200:203], v[48:51], v[8:11], v[200:203]
    ds_read_b128 v[28:31], v1 offset:33280
    v_mfma_f32_16x16x32_bf16 v[200:203], v[52:55], v[12:15], v[200:203]
    v_mfma_f32_16x16x32_bf16 v[232:235], v[60:63], v[12:15], v[232:235]
    s_add_u32 m0, s96, 16384
    s_add_u32 s38, s39, 661504
    v_mfma_f32_16x16x32_bf16 v[232:235], v[56:59], v[8:11], v[232:235]
    s_waitcnt lgkmcnt(2)
    v_mfma_f32_16x16x32_bf16 v[140:143], v[32:35], v[16:19], v[140:143]
    buffer_load_dwordx4 v6, s[8:11], s38 offen offset:2048 lds
    v_mfma_f32_16x16x32_bf16 v[140:143], v[36:39], v[20:23], v[140:143]
    ds_read_b64_tr_b16 v[82:83], v100 offset:19456
    v_mfma_f32_16x16x32_bf16 v[172:175], v[44:47], v[20:23], v[172:175]
    ds_read_b64_tr_b16 v[90:91], v101 offset:19456
    v_mfma_f32_16x16x32_bf16 v[172:175], v[40:43], v[16:19], v[172:175]
    ds_read_b128 v[8:11], v2 offset:33280
    v_mfma_f32_16x16x32_bf16 v[204:207], v[48:51], v[16:19], v[204:207]
    ds_read_b128 v[12:15], v3 offset:33280
    v_mfma_f32_16x16x32_bf16 v[204:207], v[52:55], v[20:23], v[204:207]
    v_mfma_f32_16x16x32_bf16 v[236:239], v[60:63], v[20:23], v[236:239]
    s_add_u32 m0, s96, 16384
    s_add_u32 s38, s39, 661504
    v_mfma_f32_16x16x32_bf16 v[236:239], v[56:59], v[16:19], v[236:239]
    s_waitcnt lgkmcnt(2)
    v_mfma_f32_16x16x32_bf16 v[144:147], v[32:35], v[24:27], v[144:147]
    buffer_load_dwordx4 v6, s[8:11], s38 offen offset:3072 lds
    v_mfma_f32_16x16x32_bf16 v[144:147], v[36:39], v[28:31], v[144:147]
    ds_read_b64_tr_b16 v[68:69], v100 offset:0
    v_mfma_f32_16x16x32_bf16 v[176:179], v[44:47], v[28:31], v[176:179]
    ds_read_b64_tr_b16 v[76:77], v101 offset:0
    v_mfma_f32_16x16x32_bf16 v[176:179], v[40:43], v[24:27], v[176:179]
    ds_read_b128 v[16:19], v0 offset:33536
    v_mfma_f32_16x16x32_bf16 v[208:211], v[48:51], v[24:27], v[208:211]
    ds_read_b128 v[20:23], v1 offset:33536
    v_mfma_f32_16x16x32_bf16 v[208:211], v[52:55], v[28:31], v[208:211]
    v_mfma_f32_16x16x32_bf16 v[240:243], v[60:63], v[28:31], v[240:243]
    v_mfma_f32_16x16x32_bf16 v[240:243], v[56:59], v[24:27], v[240:243]
    s_waitcnt lgkmcnt(2)
    v_mfma_f32_16x16x32_bf16 v[148:151], v[32:35], v[8:11], v[148:151]
    v_mfma_f32_16x16x32_bf16 v[148:151], v[36:39], v[12:15], v[148:151]
    ds_read_b64_tr_b16 v[84:85], v100 offset:1024
    v_mfma_f32_16x16x32_bf16 v[180:183], v[44:47], v[12:15], v[180:183]
    ds_read_b64_tr_b16 v[92:93], v101 offset:1024
    v_mfma_f32_16x16x32_bf16 v[180:183], v[40:43], v[8:11], v[180:183]
    ds_read_b128 v[24:27], v2 offset:33536
    v_mfma_f32_16x16x32_bf16 v[212:215], v[48:51], v[8:11], v[212:215]
    ds_read_b128 v[28:31], v3 offset:33536
    v_mfma_f32_16x16x32_bf16 v[212:215], v[52:55], v[12:15], v[212:215]
    v_mfma_f32_16x16x32_bf16 v[244:247], v[60:63], v[12:15], v[244:247]
    v_mfma_f32_16x16x32_bf16 v[244:247], v[56:59], v[8:11], v[244:247]
    s_waitcnt lgkmcnt(2)
    v_mfma_f32_16x16x32_bf16 v[152:155], v[32:35], v[16:19], v[152:155]
    v_mfma_f32_16x16x32_bf16 v[152:155], v[36:39], v[20:23], v[152:155]
    ds_read_b64_tr_b16 v[70:71], v100 offset:2048
    v_mfma_f32_16x16x32_bf16 v[184:187], v[44:47], v[20:23], v[184:187]
    ds_read_b64_tr_b16 v[78:79], v101 offset:2048
    v_mfma_f32_16x16x32_bf16 v[184:187], v[40:43], v[16:19], v[184:187]
    s_waitcnt vmcnt(16)
    s_barrier
    ds_read_b128 v[8:11], v0 offset:49152
    v_mfma_f32_16x16x32_bf16 v[216:219], v[48:51], v[16:19], v[216:219]
    ds_read_b128 v[12:15], v1 offset:49152
    v_mfma_f32_16x16x32_bf16 v[216:219], v[52:55], v[20:23], v[216:219]
    v_mfma_f32_16x16x32_bf16 v[248:251], v[60:63], v[20:23], v[248:251]
    v_mfma_f32_16x16x32_bf16 v[248:251], v[56:59], v[16:19], v[248:251]
    s_waitcnt lgkmcnt(2)
    v_mfma_f32_16x16x32_bf16 v[156:159], v[32:35], v[24:27], v[156:159]
    v_mfma_f32_16x16x32_bf16 v[156:159], v[36:39], v[28:31], v[156:159]
    ds_read_b64_tr_b16 v[86:87], v100 offset:3072
    v_mfma_f32_16x16x32_bf16 v[188:191], v[44:47], v[28:31], v[188:191]
    ds_read_b64_tr_b16 v[94:95], v101 offset:3072
    v_mfma_f32_16x16x32_bf16 v[188:191], v[40:43], v[24:27], v[188:191]
    ds_read_b128 v[16:19], v2 offset:49152
    v_mfma_f32_16x16x32_bf16 v[220:223], v[48:51], v[24:27], v[220:223]
    ds_read_b128 v[20:23], v3 offset:49152
    v_mfma_f32_16x16x32_bf16 v[220:223], v[52:55], v[28:31], v[220:223]
    v_mfma_f32_16x16x32_bf16 v[252:255], v[60:63], v[28:31], v[252:255]
    v_mfma_f32_16x16x32_bf16 v[252:255], v[56:59], v[24:27], v[252:255]
    s_waitcnt lgkmcnt(2)
    v_mfma_f32_16x16x32_bf16 v[128:131], v[64:67], v[8:11], v[128:131]
    v_mfma_f32_16x16x32_bf16 v[128:131], v[68:71], v[12:15], v[128:131]
    s_waitcnt vmcnt(15)
    ds_read_b64_tr_b16 v[32:33], v4 offset:0
    v_mfma_f32_16x16x32_bf16 v[160:163], v[76:79], v[12:15], v[160:163]
    ds_read_b64_tr_b16 v[40:41], v5 offset:0
    v_mfma_f32_16x16x32_bf16 v[160:163], v[72:75], v[8:11], v[160:163]
    ds_read_b128 v[24:27], v0 offset:49408
    v_mfma_f32_16x16x32_bf16 v[192:195], v[80:83], v[8:11], v[192:195]
    ds_read_b128 v[28:31], v1 offset:49408
    v_mfma_f32_16x16x32_bf16 v[192:195], v[84:87], v[12:15], v[192:195]
    s_add_u32 m0, s59, 81920
    s_add_u32 s52, s36, 640
    buffer_load_dwordx4 v96, s[4:7], s52 offen nt lds
    s_add_u32 m0, s59, 86016
    s_add_u32 s52, s36, 33408
    buffer_load_dwordx4 v97, s[4:7], s52 offen nt lds
    s_add_u32 m0, s59, 90112
    s_add_u32 s52, s36, 66176
    buffer_load_dwordx4 v98, s[4:7], s52 offen nt lds
    s_add_u32 m0, s59, 94208
    s_add_u32 s52, s36, 98944
    buffer_load_dwordx4 v99, s[4:7], s52 offen nt lds
    v_mfma_f32_16x16x32_bf16 v[224:227], v[92:95], v[12:15], v[224:227]
    s_add_u32 m0, s35, 0
    s_add_u32 s38, s39, 720896
    v_mfma_f32_16x16x32_bf16 v[224:227], v[88:91], v[8:11], v[224:227]
    s_waitcnt lgkmcnt(2)
    v_mfma_f32_16x16x32_bf16 v[132:135], v[64:67], v[16:19], v[132:135]
    buffer_load_dwordx4 v6, s[8:11], s38 offen offset:0 lds
    v_mfma_f32_16x16x32_bf16 v[132:135], v[68:71], v[20:23], v[132:135]
    s_waitcnt vmcnt(19)
    ds_read_b64_tr_b16 v[48:49], v4 offset:1024
    v_mfma_f32_16x16x32_bf16 v[164:167], v[76:79], v[20:23], v[164:167]
    ds_read_b64_tr_b16 v[56:57], v5 offset:1024
    v_mfma_f32_16x16x32_bf16 v[164:167], v[72:75], v[16:19], v[164:167]
    ds_read_b128 v[8:11], v2 offset:49408
    v_mfma_f32_16x16x32_bf16 v[196:199], v[80:83], v[16:19], v[196:199]
    ds_read_b128 v[12:15], v3 offset:49408
    v_mfma_f32_16x16x32_bf16 v[196:199], v[84:87], v[20:23], v[196:199]
    v_mfma_f32_16x16x32_bf16 v[228:231], v[92:95], v[20:23], v[228:231]
    s_add_u32 m0, s35, 0
    s_add_u32 s38, s39, 720896
    v_mfma_f32_16x16x32_bf16 v[228:231], v[88:91], v[16:19], v[228:231]
    s_waitcnt lgkmcnt(2)
    v_mfma_f32_16x16x32_bf16 v[136:139], v[64:67], v[24:27], v[136:139]
    buffer_load_dwordx4 v6, s[8:11], s38 offen offset:1024 lds
    v_mfma_f32_16x16x32_bf16 v[136:139], v[68:71], v[28:31], v[136:139]
    s_waitcnt vmcnt(19)
    ds_read_b64_tr_b16 v[34:35], v4 offset:2048
    v_mfma_f32_16x16x32_bf16 v[168:171], v[76:79], v[28:31], v[168:171]
    ds_read_b64_tr_b16 v[42:43], v5 offset:2048
    v_mfma_f32_16x16x32_bf16 v[168:171], v[72:75], v[24:27], v[168:171]
    ds_read_b128 v[16:19], v0 offset:49664
    v_mfma_f32_16x16x32_bf16 v[200:203], v[80:83], v[24:27], v[200:203]
    ds_read_b128 v[20:23], v1 offset:49664
    v_mfma_f32_16x16x32_bf16 v[200:203], v[84:87], v[28:31], v[200:203]
    v_mfma_f32_16x16x32_bf16 v[232:235], v[92:95], v[28:31], v[232:235]
    s_add_u32 m0, s35, 0
    s_add_u32 s38, s39, 727040
    v_mfma_f32_16x16x32_bf16 v[232:235], v[88:91], v[24:27], v[232:235]
    s_waitcnt lgkmcnt(2)
    v_mfma_f32_16x16x32_bf16 v[140:143], v[64:67], v[8:11], v[140:143]
    buffer_load_dwordx4 v6, s[8:11], s38 offen offset:2048 lds
    v_mfma_f32_16x16x32_bf16 v[140:143], v[68:71], v[12:15], v[140:143]
    s_waitcnt vmcnt(19)
    ds_read_b64_tr_b16 v[50:51], v4 offset:3072
    v_mfma_f32_16x16x32_bf16 v[172:175], v[76:79], v[12:15], v[172:175]
    ds_read_b64_tr_b16 v[58:59], v5 offset:3072
    v_mfma_f32_16x16x32_bf16 v[172:175], v[72:75], v[8:11], v[172:175]
    ds_read_b128 v[24:27], v2 offset:49664
    v_mfma_f32_16x16x32_bf16 v[204:207], v[80:83], v[8:11], v[204:207]
    ds_read_b128 v[28:31], v3 offset:49664
    v_mfma_f32_16x16x32_bf16 v[204:207], v[84:87], v[12:15], v[204:207]
    v_mfma_f32_16x16x32_bf16 v[236:239], v[92:95], v[12:15], v[236:239]
    s_add_u32 m0, s35, 0
    s_add_u32 s38, s39, 727040
    v_mfma_f32_16x16x32_bf16 v[236:239], v[88:91], v[8:11], v[236:239]
    s_waitcnt lgkmcnt(2)
    v_mfma_f32_16x16x32_bf16 v[144:147], v[64:67], v[16:19], v[144:147]
    buffer_load_dwordx4 v6, s[8:11], s38 offen offset:3072 lds
    v_mfma_f32_16x16x32_bf16 v[144:147], v[68:71], v[20:23], v[144:147]
    s_waitcnt vmcnt(19)
    ds_read_b64_tr_b16 v[36:37], v4 offset:4096
    v_mfma_f32_16x16x32_bf16 v[176:179], v[76:79], v[20:23], v[176:179]
    ds_read_b64_tr_b16 v[44:45], v5 offset:4096
    v_mfma_f32_16x16x32_bf16 v[176:179], v[72:75], v[16:19], v[176:179]
    ds_read_b128 v[8:11], v0 offset:49920
    v_mfma_f32_16x16x32_bf16 v[208:211], v[80:83], v[16:19], v[208:211]
    ds_read_b128 v[12:15], v1 offset:49920
    v_mfma_f32_16x16x32_bf16 v[208:211], v[84:87], v[20:23], v[208:211]
    v_mfma_f32_16x16x32_bf16 v[240:243], v[92:95], v[20:23], v[240:243]
    s_add_u32 m0, s35, 4096
    s_add_u32 s38, s39, 786432
    v_mfma_f32_16x16x32_bf16 v[240:243], v[88:91], v[16:19], v[240:243]
    s_waitcnt lgkmcnt(2)
    v_mfma_f32_16x16x32_bf16 v[148:151], v[64:67], v[24:27], v[148:151]
    buffer_load_dwordx4 v6, s[8:11], s38 offen offset:0 lds
    v_mfma_f32_16x16x32_bf16 v[148:151], v[68:71], v[28:31], v[148:151]
    s_waitcnt vmcnt(19)
    ds_read_b64_tr_b16 v[52:53], v4 offset:5120
    v_mfma_f32_16x16x32_bf16 v[180:183], v[76:79], v[28:31], v[180:183]
    ds_read_b64_tr_b16 v[60:61], v5 offset:5120
    v_mfma_f32_16x16x32_bf16 v[180:183], v[72:75], v[24:27], v[180:183]
    ds_read_b128 v[16:19], v2 offset:49920
    v_mfma_f32_16x16x32_bf16 v[212:215], v[80:83], v[24:27], v[212:215]
    ds_read_b128 v[20:23], v3 offset:49920
    v_mfma_f32_16x16x32_bf16 v[212:215], v[84:87], v[28:31], v[212:215]
    v_mfma_f32_16x16x32_bf16 v[244:247], v[92:95], v[28:31], v[244:247]
    s_add_u32 m0, s35, 4096
    s_add_u32 s38, s39, 786432
    v_mfma_f32_16x16x32_bf16 v[244:247], v[88:91], v[24:27], v[244:247]
    s_waitcnt lgkmcnt(2)
    v_mfma_f32_16x16x32_bf16 v[152:155], v[64:67], v[8:11], v[152:155]
    buffer_load_dwordx4 v6, s[8:11], s38 offen offset:1024 lds
    v_mfma_f32_16x16x32_bf16 v[152:155], v[68:71], v[12:15], v[152:155]
    s_waitcnt vmcnt(19)
    ds_read_b64_tr_b16 v[38:39], v4 offset:6144
    v_mfma_f32_16x16x32_bf16 v[184:187], v[76:79], v[12:15], v[184:187]
    ds_read_b64_tr_b16 v[46:47], v5 offset:6144
    v_mfma_f32_16x16x32_bf16 v[184:187], v[72:75], v[8:11], v[184:187]
    s_waitcnt vmcnt(14)
    s_barrier
    v_add_u32 v0, 0x10000, v0
    v_add_u32 v1, 0x10000, v1
    ds_read_b128 v[24:27], v0 offset:0
    v_mfma_f32_16x16x32_bf16 v[216:219], v[80:83], v[8:11], v[216:219]
    ds_read_b128 v[28:31], v1 offset:0
    v_mfma_f32_16x16x32_bf16 v[216:219], v[84:87], v[12:15], v[216:219]
    v_mfma_f32_16x16x32_bf16 v[248:251], v[92:95], v[12:15], v[248:251]
    s_add_u32 m0, s35, 4096
    s_add_u32 s38, s39, 792576
    v_mfma_f32_16x16x32_bf16 v[248:251], v[88:91], v[8:11], v[248:251]
    s_waitcnt lgkmcnt(2)
    v_mfma_f32_16x16x32_bf16 v[156:159], v[64:67], v[16:19], v[156:159]
    buffer_load_dwordx4 v6, s[8:11], s38 offen offset:2048 lds
    v_mfma_f32_16x16x32_bf16 v[156:159], v[68:71], v[20:23], v[156:159]
    ds_read_b64_tr_b16 v[54:55], v4 offset:7168
    v_mfma_f32_16x16x32_bf16 v[188:191], v[76:79], v[20:23], v[188:191]
    ds_read_b64_tr_b16 v[62:63], v5 offset:7168
    v_mfma_f32_16x16x32_bf16 v[188:191], v[72:75], v[16:19], v[188:191]
    v_add_u32 v2, 0x10000, v2
    v_add_u32 v3, 0x10000, v3
    ds_read_b128 v[8:11], v2 offset:0
    v_mfma_f32_16x16x32_bf16 v[220:223], v[80:83], v[16:19], v[220:223]
    ds_read_b128 v[12:15], v3 offset:0
    v_mfma_f32_16x16x32_bf16 v[220:223], v[84:87], v[20:23], v[220:223]
    v_mfma_f32_16x16x32_bf16 v[252:255], v[92:95], v[20:23], v[252:255]
    s_add_u32 m0, s35, 4096
    s_add_u32 s38, s39, 792576
    v_mfma_f32_16x16x32_bf16 v[252:255], v[88:91], v[16:19], v[252:255]
    s_waitcnt lgkmcnt(2)
    v_mfma_f32_16x16x32_bf16 v[128:131], v[32:35], v[24:27], v[128:131]
    buffer_load_dwordx4 v6, s[8:11], s38 offen offset:3072 lds
    v_mfma_f32_16x16x32_bf16 v[128:131], v[36:39], v[28:31], v[128:131]
    s_waitcnt vmcnt(15)
    ds_read_b64_tr_b16 v[64:65], v100 offset:16384
    v_mfma_f32_16x16x32_bf16 v[160:163], v[44:47], v[28:31], v[160:163]
    ds_read_b64_tr_b16 v[72:73], v101 offset:16384
    v_mfma_f32_16x16x32_bf16 v[160:163], v[40:43], v[24:27], v[160:163]
    ds_read_b128 v[16:19], v0 offset:256
    v_mfma_f32_16x16x32_bf16 v[192:195], v[48:51], v[24:27], v[192:195]
    ds_read_b128 v[20:23], v1 offset:256
    v_mfma_f32_16x16x32_bf16 v[192:195], v[52:55], v[28:31], v[192:195]
    s_add_u32 m0, s59, 98304
    s_add_u32 s52, s36, 768
    buffer_load_dwordx4 v96, s[4:7], s52 offen nt lds
    s_add_u32 m0, s59, 102400
    s_add_u32 s52, s36, 33536
    buffer_load_dwordx4 v97, s[4:7], s52 offen nt lds
    s_add_u32 m0, s59, 106496
    s_add_u32 s52, s36, 66304
    buffer_load_dwordx4 v98, s[4:7], s52 offen nt lds
    s_add_u32 m0, s59, 110592
    s_add_u32 s52, s36, 99072
    buffer_load_dwordx4 v99, s[4:7], s52 offen nt lds
    v_mfma_f32_16x16x32_bf16 v[224:227], v[60:63], v[28:31], v[224:227]
    v_mfma_f32_16x16x32_bf16 v[224:227], v[56:59], v[24:27], v[224:227]
    s_waitcnt lgkmcnt(2)
    v_mfma_f32_16x16x32_bf16 v[132:135], v[32:35], v[8:11], v[132:135]
    v_mfma_f32_16x16x32_bf16 v[132:135], v[36:39], v[12:15], v[132:135]
    s_waitcnt vmcnt(18)
    ds_read_b64_tr_b16 v[80:81], v100 offset:17408
    v_mfma_f32_16x16x32_bf16 v[164:167], v[44:47], v[12:15], v[164:167]
    ds_read_b64_tr_b16 v[88:89], v101 offset:17408
    v_mfma_f32_16x16x32_bf16 v[164:167], v[40:43], v[8:11], v[164:167]
    ds_read_b128 v[24:27], v2 offset:256
    v_mfma_f32_16x16x32_bf16 v[196:199], v[48:51], v[8:11], v[196:199]
    ds_read_b128 v[28:31], v3 offset:256
    v_mfma_f32_16x16x32_bf16 v[196:199], v[52:55], v[12:15], v[196:199]
    v_mfma_f32_16x16x32_bf16 v[228:231], v[60:63], v[12:15], v[228:231]
    v_mfma_f32_16x16x32_bf16 v[228:231], v[56:59], v[8:11], v[228:231]
    s_waitcnt lgkmcnt(2)
    v_mfma_f32_16x16x32_bf16 v[136:139], v[32:35], v[16:19], v[136:139]
    v_mfma_f32_16x16x32_bf16 v[136:139], v[36:39], v[20:23], v[136:139]
    s_waitcnt vmcnt(17)
    ds_read_b64_tr_b16 v[66:67], v100 offset:18432
    v_mfma_f32_16x16x32_bf16 v[168:171], v[44:47], v[20:23], v[168:171]
    ds_read_b64_tr_b16 v[74:75], v101 offset:18432
    v_mfma_f32_16x16x32_bf16 v[168:171], v[40:43], v[16:19], v[168:171]
    ds_read_b128 v[8:11], v0 offset:512
    v_mfma_f32_16x16x32_bf16 v[200:203], v[48:51], v[16:19], v[200:203]
    ds_read_b128 v[12:15], v1 offset:512
    v_mfma_f32_16x16x32_bf16 v[200:203], v[52:55], v[20:23], v[200:203]
    v_mfma_f32_16x16x32_bf16 v[232:235], v[60:63], v[20:23], v[232:235]
    v_mfma_f32_16x16x32_bf16 v[232:235], v[56:59], v[16:19], v[232:235]
    s_waitcnt lgkmcnt(2)
    v_mfma_f32_16x16x32_bf16 v[140:143], v[32:35], v[24:27], v[140:143]
    v_mfma_f32_16x16x32_bf16 v[140:143], v[36:39], v[28:31], v[140:143]
    s_waitcnt vmcnt(16)
    ds_read_b64_tr_b16 v[82:83], v100 offset:19456
    v_mfma_f32_16x16x32_bf16 v[172:175], v[44:47], v[28:31], v[172:175]
    ds_read_b64_tr_b16 v[90:91], v101 offset:19456
    v_mfma_f32_16x16x32_bf16 v[172:175], v[40:43], v[24:27], v[172:175]
    ds_read_b128 v[16:19], v2 offset:512
    v_mfma_f32_16x16x32_bf16 v[204:207], v[48:51], v[24:27], v[204:207]
    ds_read_b128 v[20:23], v3 offset:512
    v_mfma_f32_16x16x32_bf16 v[204:207], v[52:55], v[28:31], v[204:207]
    v_mfma_f32_16x16x32_bf16 v[236:239], v[60:63], v[28:31], v[236:239]
    v_mfma_f32_16x16x32_bf16 v[236:239], v[56:59], v[24:27], v[236:239]
    s_waitcnt lgkmcnt(2)
    v_mfma_f32_16x16x32_bf16 v[144:147], v[32:35], v[8:11], v[144:147]
    v_mfma_f32_16x16x32_bf16 v[144:147], v[36:39], v[12:15], v[144:147]
    s_waitcnt vmcnt(11)
    ds_read_b64_tr_b16 v[68:69], v4 offset:0
    v_mfma_f32_16x16x32_bf16 v[176:179], v[44:47], v[12:15], v[176:179]
    ds_read_b64_tr_b16 v[76:77], v5 offset:0
    v_mfma_f32_16x16x32_bf16 v[176:179], v[40:43], v[8:11], v[176:179]
    ds_read_b128 v[24:27], v0 offset:768
    v_mfma_f32_16x16x32_bf16 v[208:211], v[48:51], v[8:11], v[208:211]
    ds_read_b128 v[28:31], v1 offset:768
    v_mfma_f32_16x16x32_bf16 v[208:211], v[52:55], v[12:15], v[208:211]
    v_mfma_f32_16x16x32_bf16 v[240:243], v[60:63], v[12:15], v[240:243]
    s_add_u32 m0, s35, 0
    s_add_u32 s38, s39, 851968
    v_mfma_f32_16x16x32_bf16 v[240:243], v[56:59], v[8:11], v[240:243]
    s_waitcnt lgkmcnt(2)
    v_mfma_f32_16x16x32_bf16 v[148:151], v[32:35], v[16:19], v[148:151]
    buffer_load_dwordx4 v6, s[8:11], s38 offen offset:0 lds
    v_mfma_f32_16x16x32_bf16 v[148:151], v[36:39], v[20:23], v[148:151]
    s_waitcnt vmcnt(11)
    ds_read_b64_tr_b16 v[84:85], v4 offset:1024
    v_mfma_f32_16x16x32_bf16 v[180:183], v[44:47], v[20:23], v[180:183]
    ds_read_b64_tr_b16 v[92:93], v5 offset:1024
    v_mfma_f32_16x16x32_bf16 v[180:183], v[40:43], v[16:19], v[180:183]
    ds_read_b128 v[8:11], v2 offset:768
    v_mfma_f32_16x16x32_bf16 v[212:215], v[48:51], v[16:19], v[212:215]
    ds_read_b128 v[12:15], v3 offset:768
    v_mfma_f32_16x16x32_bf16 v[212:215], v[52:55], v[20:23], v[212:215]
    v_mfma_f32_16x16x32_bf16 v[244:247], v[60:63], v[20:23], v[244:247]
    s_add_u32 m0, s35, 0
    s_add_u32 s38, s39, 851968
    v_mfma_f32_16x16x32_bf16 v[244:247], v[56:59], v[16:19], v[244:247]
    s_waitcnt lgkmcnt(2)
    v_mfma_f32_16x16x32_bf16 v[152:155], v[32:35], v[24:27], v[152:155]
    buffer_load_dwordx4 v6, s[8:11], s38 offen offset:1024 lds
    v_mfma_f32_16x16x32_bf16 v[152:155], v[36:39], v[28:31], v[152:155]
    s_waitcnt vmcnt(11)
    ds_read_b64_tr_b16 v[70:71], v4 offset:2048
    v_mfma_f32_16x16x32_bf16 v[184:187], v[44:47], v[28:31], v[184:187]
    ds_read_b64_tr_b16 v[78:79], v5 offset:2048
    v_mfma_f32_16x16x32_bf16 v[184:187], v[40:43], v[24:27], v[184:187]
    s_barrier
    ds_read_b128 v[16:19], v0 offset:16384
    v_mfma_f32_16x16x32_bf16 v[216:219], v[48:51], v[24:27], v[216:219]
    ds_read_b128 v[20:23], v1 offset:16384
    v_mfma_f32_16x16x32_bf16 v[216:219], v[52:55], v[28:31], v[216:219]
    v_mfma_f32_16x16x32_bf16 v[248:251], v[60:63], v[28:31], v[248:251]
    s_add_u32 m0, s35, 0
    s_add_u32 s38, s39, 858112
    v_mfma_f32_16x16x32_bf16 v[248:251], v[56:59], v[24:27], v[248:251]
    s_waitcnt lgkmcnt(2)
    v_mfma_f32_16x16x32_bf16 v[156:159], v[32:35], v[8:11], v[156:159]
    buffer_load_dwordx4 v6, s[8:11], s38 offen offset:2048 lds
    v_mfma_f32_16x16x32_bf16 v[156:159], v[36:39], v[12:15], v[156:159]
    s_waitcnt vmcnt(11)
    ds_read_b64_tr_b16 v[86:87], v4 offset:3072
    v_mfma_f32_16x16x32_bf16 v[188:191], v[44:47], v[12:15], v[188:191]
    ds_read_b64_tr_b16 v[94:95], v5 offset:3072
    v_mfma_f32_16x16x32_bf16 v[188:191], v[40:43], v[8:11], v[188:191]
    ds_read_b128 v[24:27], v2 offset:16384
    v_mfma_f32_16x16x32_bf16 v[220:223], v[48:51], v[8:11], v[220:223]
    ds_read_b128 v[28:31], v3 offset:16384
    v_mfma_f32_16x16x32_bf16 v[220:223], v[52:55], v[12:15], v[220:223]
    v_mfma_f32_16x16x32_bf16 v[252:255], v[60:63], v[12:15], v[252:255]
    s_add_u32 m0, s35, 0
    s_add_u32 s38, s39, 858112
    v_mfma_f32_16x16x32_bf16 v[252:255], v[56:59], v[8:11], v[252:255]
    s_waitcnt lgkmcnt(2)
    v_mfma_f32_16x16x32_bf16 v[128:131], v[64:67], v[16:19], v[128:131]
    buffer_load_dwordx4 v6, s[8:11], s38 offen offset:3072 lds
    v_mfma_f32_16x16x32_bf16 v[128:131], v[68:71], v[20:23], v[128:131]
    s_waitcnt vmcnt(11)
    ds_read_b64_tr_b16 v[32:33], v4 offset:4096
    v_mfma_f32_16x16x32_bf16 v[160:163], v[76:79], v[20:23], v[160:163]
    ds_read_b64_tr_b16 v[40:41], v5 offset:4096
    v_mfma_f32_16x16x32_bf16 v[160:163], v[72:75], v[16:19], v[160:163]
    ds_read_b128 v[8:11], v0 offset:16640
    v_mfma_f32_16x16x32_bf16 v[192:195], v[80:83], v[16:19], v[192:195]
    ds_read_b128 v[12:15], v1 offset:16640
    v_mfma_f32_16x16x32_bf16 v[192:195], v[84:87], v[20:23], v[192:195]
    s_add_u32 m0, s59, 114688
    s_add_u32 s52, s36, 896
    buffer_load_dwordx4 v96, s[4:7], s52 offen nt lds
    s_add_u32 m0, s59, 118784
    s_add_u32 s52, s36, 33664
    buffer_load_dwordx4 v97, s[4:7], s52 offen nt lds
    s_add_u32 m0, s59, 122880
    s_add_u32 s52, s36, 66432
    buffer_load_dwordx4 v98, s[4:7], s52 offen nt lds
    s_add_u32 m0, s59, 126976
    s_add_u32 s52, s36, 99200
    buffer_load_dwordx4 v99, s[4:7], s52 offen nt lds
    v_mfma_f32_16x16x32_bf16 v[224:227], v[92:95], v[20:23], v[224:227]
    s_add_u32 m0, s35, 4096
    s_add_u32 s38, s39, 917504
    v_mfma_f32_16x16x32_bf16 v[224:227], v[88:91], v[16:19], v[224:227]
    s_waitcnt lgkmcnt(2)
    v_mfma_f32_16x16x32_bf16 v[132:135], v[64:67], v[24:27], v[132:135]
    buffer_load_dwordx4 v6, s[8:11], s38 offen offset:0 lds
    v_mfma_f32_16x16x32_bf16 v[132:135], v[68:71], v[28:31], v[132:135]
    s_waitcnt vmcnt(15)
    ds_read_b64_tr_b16 v[48:49], v4 offset:5120
    v_mfma_f32_16x16x32_bf16 v[164:167], v[76:79], v[28:31], v[164:167]
    ds_read_b64_tr_b16 v[56:57], v5 offset:5120
    v_mfma_f32_16x16x32_bf16 v[164:167], v[72:75], v[24:27], v[164:167]
    ds_read_b128 v[16:19], v2 offset:16640
    v_mfma_f32_16x16x32_bf16 v[196:199], v[80:83], v[24:27], v[196:199]
    ds_read_b128 v[20:23], v3 offset:16640
    v_mfma_f32_16x16x32_bf16 v[196:199], v[84:87], v[28:31], v[196:199]
    v_mfma_f32_16x16x32_bf16 v[228:231], v[92:95], v[28:31], v[228:231]
    s_add_u32 m0, s35, 4096
    s_add_u32 s38, s39, 917504
    v_mfma_f32_16x16x32_bf16 v[228:231], v[88:91], v[24:27], v[228:231]
    s_waitcnt lgkmcnt(2)
    v_mfma_f32_16x16x32_bf16 v[136:139], v[64:67], v[8:11], v[136:139]
    buffer_load_dwordx4 v6, s[8:11], s38 offen offset:1024 lds
    v_mfma_f32_16x16x32_bf16 v[136:139], v[68:71], v[12:15], v[136:139]
    s_waitcnt vmcnt(15)
    ds_read_b64_tr_b16 v[34:35], v4 offset:6144
    v_mfma_f32_16x16x32_bf16 v[168:171], v[76:79], v[12:15], v[168:171]
    ds_read_b64_tr_b16 v[42:43], v5 offset:6144
    v_mfma_f32_16x16x32_bf16 v[168:171], v[72:75], v[8:11], v[168:171]
    ds_read_b128 v[24:27], v0 offset:16896
    v_mfma_f32_16x16x32_bf16 v[200:203], v[80:83], v[8:11], v[200:203]
    ds_read_b128 v[28:31], v1 offset:16896
    v_mfma_f32_16x16x32_bf16 v[200:203], v[84:87], v[12:15], v[200:203]
    v_mfma_f32_16x16x32_bf16 v[232:235], v[92:95], v[12:15], v[232:235]
    s_add_u32 m0, s35, 4096
    s_add_u32 s38, s39, 923648
    v_mfma_f32_16x16x32_bf16 v[232:235], v[88:91], v[8:11], v[232:235]
    s_waitcnt lgkmcnt(2)
    v_mfma_f32_16x16x32_bf16 v[140:143], v[64:67], v[16:19], v[140:143]
    buffer_load_dwordx4 v6, s[8:11], s38 offen offset:2048 lds
    v_mfma_f32_16x16x32_bf16 v[140:143], v[68:71], v[20:23], v[140:143]
    s_waitcnt vmcnt(15)
    ds_read_b64_tr_b16 v[50:51], v4 offset:7168
    v_mfma_f32_16x16x32_bf16 v[172:175], v[76:79], v[20:23], v[172:175]
    ds_read_b64_tr_b16 v[58:59], v5 offset:7168
    v_mfma_f32_16x16x32_bf16 v[172:175], v[72:75], v[16:19], v[172:175]
    ds_read_b128 v[8:11], v2 offset:16896
    v_mfma_f32_16x16x32_bf16 v[204:207], v[80:83], v[16:19], v[204:207]
    ds_read_b128 v[12:15], v3 offset:16896
    v_mfma_f32_16x16x32_bf16 v[204:207], v[84:87], v[20:23], v[204:207]
    v_mfma_f32_16x16x32_bf16 v[236:239], v[92:95], v[20:23], v[236:239]
    s_add_u32 m0, s35, 4096
    s_add_u32 s38, s39, 923648
    v_mfma_f32_16x16x32_bf16 v[236:239], v[88:91], v[16:19], v[236:239]
    s_waitcnt lgkmcnt(2)
    v_mfma_f32_16x16x32_bf16 v[144:147], v[64:67], v[24:27], v[144:147]
    buffer_load_dwordx4 v6, s[8:11], s38 offen offset:3072 lds
    v_mfma_f32_16x16x32_bf16 v[144:147], v[68:71], v[28:31], v[144:147]
    s_waitcnt vmcnt(11)
    ds_read_b64_tr_b16 v[36:37], v4 offset:0
    v_mfma_f32_16x16x32_bf16 v[176:179], v[76:79], v[28:31], v[176:179]
    ds_read_b64_tr_b16 v[44:45], v5 offset:0
    v_mfma_f32_16x16x32_bf16 v[176:179], v[72:75], v[24:27], v[176:179]
    ds_read_b128 v[16:19], v0 offset:17152
    v_mfma_f32_16x16x32_bf16 v[208:211], v[80:83], v[24:27], v[208:211]
    ds_read_b128 v[20:23], v1 offset:17152
    v_mfma_f32_16x16x32_bf16 v[208:211], v[84:87], v[28:31], v[208:211]
    v_mfma_f32_16x16x32_bf16 v[240:243], v[92:95], v[28:31], v[240:243]
    s_add_u32 m0, s35, 0
    s_add_u32 s38, s39, 983040
    v_mfma_f32_16x16x32_bf16 v[240:243], v[88:91], v[24:27], v[240:243]
    s_waitcnt lgkmcnt(2)
    v_mfma_f32_16x16x32_bf16 v[148:151], v[64:67], v[8:11], v[148:151]
    buffer_load_dwordx4 v6, s[8:11], s38 offen offset:0 lds
    v_mfma_f32_16x16x32_bf16 v[148:151], v[68:71], v[12:15], v[148:151]
    s_waitcnt vmcnt(11)
    ds_read_b64_tr_b16 v[52:53], v4 offset:1024
    v_mfma_f32_16x16x32_bf16 v[180:183], v[76:79], v[12:15], v[180:183]
    ds_read_b64_tr_b16 v[60:61], v5 offset:1024
    v_mfma_f32_16x16x32_bf16 v[180:183], v[72:75], v[8:11], v[180:183]
    ds_read_b128 v[24:27], v2 offset:17152
    v_mfma_f32_16x16x32_bf16 v[212:215], v[80:83], v[8:11], v[212:215]
    ds_read_b128 v[28:31], v3 offset:17152
    v_mfma_f32_16x16x32_bf16 v[212:215], v[84:87], v[12:15], v[212:215]
    v_mfma_f32_16x16x32_bf16 v[244:247], v[92:95], v[12:15], v[244:247]
    s_add_u32 m0, s35, 0
    s_add_u32 s38, s39, 983040
    v_mfma_f32_16x16x32_bf16 v[244:247], v[88:91], v[8:11], v[244:247]
    s_waitcnt lgkmcnt(2)
    v_mfma_f32_16x16x32_bf16 v[152:155], v[64:67], v[16:19], v[152:155]
    buffer_load_dwordx4 v6, s[8:11], s38 offen offset:1024 lds
    v_mfma_f32_16x16x32_bf16 v[152:155], v[68:71], v[20:23], v[152:155]
    s_waitcnt vmcnt(11)
    ds_read_b64_tr_b16 v[38:39], v4 offset:2048
    v_mfma_f32_16x16x32_bf16 v[184:187], v[76:79], v[20:23], v[184:187]
    ds_read_b64_tr_b16 v[46:47], v5 offset:2048
    v_mfma_f32_16x16x32_bf16 v[184:187], v[72:75], v[16:19], v[184:187]
    s_barrier
    ds_read_b128 v[8:11], v0 offset:32768
    v_mfma_f32_16x16x32_bf16 v[216:219], v[80:83], v[16:19], v[216:219]
    ds_read_b128 v[12:15], v1 offset:32768
    v_mfma_f32_16x16x32_bf16 v[216:219], v[84:87], v[20:23], v[216:219]
    v_mfma_f32_16x16x32_bf16 v[248:251], v[92:95], v[20:23], v[248:251]
    s_add_u32 m0, s35, 0
    s_add_u32 s38, s39, 989184
    v_mfma_f32_16x16x32_bf16 v[248:251], v[88:91], v[16:19], v[248:251]
    s_waitcnt lgkmcnt(2)
    v_mfma_f32_16x16x32_bf16 v[156:159], v[64:67], v[24:27], v[156:159]
    buffer_load_dwordx4 v6, s[8:11], s38 offen offset:2048 lds
    v_mfma_f32_16x16x32_bf16 v[156:159], v[68:71], v[28:31], v[156:159]
    s_waitcnt vmcnt(11)
    ds_read_b64_tr_b16 v[54:55], v4 offset:3072
    v_mfma_f32_16x16x32_bf16 v[188:191], v[76:79], v[28:31], v[188:191]
    ds_read_b64_tr_b16 v[62:63], v5 offset:3072
    v_mfma_f32_16x16x32_bf16 v[188:191], v[72:75], v[24:27], v[188:191]
    ds_read_b128 v[16:19], v2 offset:32768
    v_mfma_f32_16x16x32_bf16 v[220:223], v[80:83], v[24:27], v[220:223]
    ds_read_b128 v[20:23], v3 offset:32768
    v_mfma_f32_16x16x32_bf16 v[220:223], v[84:87], v[28:31], v[220:223]
    v_mfma_f32_16x16x32_bf16 v[252:255], v[92:95], v[28:31], v[252:255]
    s_add_u32 m0, s35, 0
    s_add_u32 s38, s39, 989184
    v_mfma_f32_16x16x32_bf16 v[252:255], v[88:91], v[24:27], v[252:255]
    s_waitcnt lgkmcnt(2)
    v_mfma_f32_16x16x32_bf16 v[128:131], v[32:35], v[8:11], v[128:131]
    buffer_load_dwordx4 v6, s[8:11], s38 offen offset:3072 lds
    v_mfma_f32_16x16x32_bf16 v[128:131], v[36:39], v[12:15], v[128:131]
    s_waitcnt vmcnt(7)
    ds_read_b64_tr_b16 v[64:65], v4 offset:4096
    v_mfma_f32_16x16x32_bf16 v[160:163], v[44:47], v[12:15], v[160:163]
    ds_read_b64_tr_b16 v[72:73], v5 offset:4096
    v_mfma_f32_16x16x32_bf16 v[160:163], v[40:43], v[8:11], v[160:163]
    ds_read_b128 v[24:27], v0 offset:33024
    v_mfma_f32_16x16x32_bf16 v[192:195], v[48:51], v[8:11], v[192:195]
    ds_read_b128 v[28:31], v1 offset:33024
    v_mfma_f32_16x16x32_bf16 v[192:195], v[52:55], v[12:15], v[192:195]
    v_mfma_f32_16x16x32_bf16 v[224:227], v[60:63], v[12:15], v[224:227]
    s_add_u32 m0, s35, 4096
    s_add_u32 s38, s39, 65792
    v_mfma_f32_16x16x32_bf16 v[224:227], v[56:59], v[8:11], v[224:227]
    s_waitcnt lgkmcnt(2)
    v_mfma_f32_16x16x32_bf16 v[132:135], v[32:35], v[16:19], v[132:135]
    buffer_load_dwordx4 v6, s[8:11], s38 offen offset:0 lds
    v_mfma_f32_16x16x32_bf16 v[132:135], v[36:39], v[20:23], v[132:135]
    s_waitcnt vmcnt(7)
    ds_read_b64_tr_b16 v[80:81], v4 offset:5120
    v_mfma_f32_16x16x32_bf16 v[164:167], v[44:47], v[20:23], v[164:167]
    ds_read_b64_tr_b16 v[88:89], v5 offset:5120
    v_mfma_f32_16x16x32_bf16 v[164:167], v[40:43], v[16:19], v[164:167]
    ds_read_b128 v[8:11], v2 offset:33024
    v_mfma_f32_16x16x32_bf16 v[196:199], v[48:51], v[16:19], v[196:199]
    ds_read_b128 v[12:15], v3 offset:33024
    v_mfma_f32_16x16x32_bf16 v[196:199], v[52:55], v[20:23], v[196:199]
    v_mfma_f32_16x16x32_bf16 v[228:231], v[60:63], v[20:23], v[228:231]
    s_add_u32 m0, s35, 4096
    s_add_u32 s38, s39, 65792
    v_mfma_f32_16x16x32_bf16 v[228:231], v[56:59], v[16:19], v[228:231]
    s_waitcnt lgkmcnt(2)
    v_mfma_f32_16x16x32_bf16 v[136:139], v[32:35], v[24:27], v[136:139]
    buffer_load_dwordx4 v6, s[8:11], s38 offen offset:1024 lds
    v_mfma_f32_16x16x32_bf16 v[136:139], v[36:39], v[28:31], v[136:139]
    s_waitcnt vmcnt(7)
    ds_read_b64_tr_b16 v[66:67], v4 offset:6144
    v_mfma_f32_16x16x32_bf16 v[168:171], v[44:47], v[28:31], v[168:171]
    ds_read_b64_tr_b16 v[74:75], v5 offset:6144
    v_mfma_f32_16x16x32_bf16 v[168:171], v[40:43], v[24:27], v[168:171]
    ds_read_b128 v[16:19], v0 offset:33280
    v_mfma_f32_16x16x32_bf16 v[200:203], v[48:51], v[24:27], v[200:203]
    ds_read_b128 v[20:23], v1 offset:33280
    v_mfma_f32_16x16x32_bf16 v[200:203], v[52:55], v[28:31], v[200:203]
    v_mfma_f32_16x16x32_bf16 v[232:235], v[60:63], v[28:31], v[232:235]
    s_add_u32 m0, s35, 4096
    s_add_u32 s38, s39, 71936
    v_mfma_f32_16x16x32_bf16 v[232:235], v[56:59], v[24:27], v[232:235]
    s_waitcnt lgkmcnt(2)
    v_mfma_f32_16x16x32_bf16 v[140:143], v[32:35], v[8:11], v[140:143]
    buffer_load_dwordx4 v6, s[8:11], s38 offen offset:2048 lds
    v_mfma_f32_16x16x32_bf16 v[140:143], v[36:39], v[12:15], v[140:143]
    s_waitcnt vmcnt(7)
    ds_read_b64_tr_b16 v[82:83], v4 offset:7168
    v_mfma_f32_16x16x32_bf16 v[172:175], v[44:47], v[12:15], v[172:175]
    ds_read_b64_tr_b16 v[90:91], v5 offset:7168
    v_mfma_f32_16x16x32_bf16 v[172:175], v[40:43], v[8:11], v[172:175]
    ds_read_b128 v[24:27], v2 offset:33280
    v_mfma_f32_16x16x32_bf16 v[204:207], v[48:51], v[8:11], v[204:207]
    ds_read_b128 v[28:31], v3 offset:33280
    v_mfma_f32_16x16x32_bf16 v[204:207], v[52:55], v[12:15], v[204:207]
    v_mfma_f32_16x16x32_bf16 v[236:239], v[60:63], v[12:15], v[236:239]
    s_add_u32 m0, s35, 4096
    s_add_u32 s38, s39, 71936
    v_mfma_f32_16x16x32_bf16 v[236:239], v[56:59], v[8:11], v[236:239]
    s_waitcnt lgkmcnt(2)
    v_mfma_f32_16x16x32_bf16 v[144:147], v[32:35], v[16:19], v[144:147]
    buffer_load_dwordx4 v6, s[8:11], s38 offen offset:3072 lds
    v_mfma_f32_16x16x32_bf16 v[144:147], v[36:39], v[20:23], v[144:147]
    s_waitcnt vmcnt(7)
    ds_read_b64_tr_b16 v[68:69], v4 offset:0
    v_mfma_f32_16x16x32_bf16 v[176:179], v[44:47], v[20:23], v[176:179]
    ds_read_b64_tr_b16 v[76:77], v5 offset:0
    v_mfma_f32_16x16x32_bf16 v[176:179], v[40:43], v[16:19], v[176:179]
    ds_read_b128 v[8:11], v0 offset:33536
    v_mfma_f32_16x16x32_bf16 v[208:211], v[48:51], v[16:19], v[208:211]
    ds_read_b128 v[12:15], v1 offset:33536
    v_mfma_f32_16x16x32_bf16 v[208:211], v[52:55], v[20:23], v[208:211]
    v_mfma_f32_16x16x32_bf16 v[240:243], v[60:63], v[20:23], v[240:243]
    s_add_u32 m0, s35, 0
    s_add_u32 s38, s39, 256
    v_mfma_f32_16x16x32_bf16 v[240:243], v[56:59], v[16:19], v[240:243]
    s_waitcnt lgkmcnt(2)
    v_mfma_f32_16x16x32_bf16 v[148:151], v[32:35], v[24:27], v[148:151]
    buffer_load_dwordx4 v6, s[8:11], s38 offen offset:0 lds
    v_mfma_f32_16x16x32_bf16 v[148:151], v[36:39], v[28:31], v[148:151]
    s_waitcnt vmcnt(7)
    ds_read_b64_tr_b16 v[84:85], v4 offset:1024
    v_mfma_f32_16x16x32_bf16 v[180:183], v[44:47], v[28:31], v[180:183]
    ds_read_b64_tr_b16 v[92:93], v5 offset:1024
    v_mfma_f32_16x16x32_bf16 v[180:183], v[40:43], v[24:27], v[180:183]
    ds_read_b128 v[16:19], v2 offset:33536
    v_mfma_f32_16x16x32_bf16 v[212:215], v[48:51], v[24:27], v[212:215]
    ds_read_b128 v[20:23], v3 offset:33536
    v_mfma_f32_16x16x32_bf16 v[212:215], v[52:55], v[28:31], v[212:215]
    v_mfma_f32_16x16x32_bf16 v[244:247], v[60:63], v[28:31], v[244:247]
    s_add_u32 m0, s35, 0
    s_add_u32 s38, s39, 256
    v_mfma_f32_16x16x32_bf16 v[244:247], v[56:59], v[24:27], v[244:247]
    s_waitcnt lgkmcnt(2)
    v_mfma_f32_16x16x32_bf16 v[152:155], v[32:35], v[8:11], v[152:155]
    buffer_load_dwordx4 v6, s[8:11], s38 offen offset:1024 lds
    v_mfma_f32_16x16x32_bf16 v[152:155], v[36:39], v[12:15], v[152:155]
    s_waitcnt vmcnt(7)
    ds_read_b64_tr_b16 v[70:71], v4 offset:2048
    v_mfma_f32_16x16x32_bf16 v[184:187], v[44:47], v[12:15], v[184:187]
    ds_read_b64_tr_b16 v[78:79], v5 offset:2048
    v_mfma_f32_16x16x32_bf16 v[184:187], v[40:43], v[8:11], v[184:187]
    s_barrier
    ds_read_b128 v[24:27], v0 offset:49152
    v_mfma_f32_16x16x32_bf16 v[216:219], v[48:51], v[8:11], v[216:219]
    ds_read_b128 v[28:31], v1 offset:49152
    v_mfma_f32_16x16x32_bf16 v[216:219], v[52:55], v[12:15], v[216:219]
    v_mfma_f32_16x16x32_bf16 v[248:251], v[60:63], v[12:15], v[248:251]
    s_add_u32 m0, s35, 0
    s_add_u32 s38, s39, 6400
    v_mfma_f32_16x16x32_bf16 v[248:251], v[56:59], v[8:11], v[248:251]
    s_waitcnt lgkmcnt(2)
    v_mfma_f32_16x16x32_bf16 v[156:159], v[32:35], v[16:19], v[156:159]
    buffer_load_dwordx4 v6, s[8:11], s38 offen offset:2048 lds
    v_mfma_f32_16x16x32_bf16 v[156:159], v[36:39], v[20:23], v[156:159]
    s_waitcnt vmcnt(7)
    ds_read_b64_tr_b16 v[86:87], v4 offset:3072
    v_mfma_f32_16x16x32_bf16 v[188:191], v[44:47], v[20:23], v[188:191]
    ds_read_b64_tr_b16 v[94:95], v5 offset:3072
    v_mfma_f32_16x16x32_bf16 v[188:191], v[40:43], v[16:19], v[188:191]
    ds_read_b128 v[8:11], v2 offset:49152
    v_mfma_f32_16x16x32_bf16 v[220:223], v[48:51], v[16:19], v[220:223]
    ds_read_b128 v[12:15], v3 offset:49152
    v_mfma_f32_16x16x32_bf16 v[220:223], v[52:55], v[20:23], v[220:223]
    v_mfma_f32_16x16x32_bf16 v[252:255], v[60:63], v[20:23], v[252:255]
    s_add_u32 m0, s35, 0
    s_add_u32 s38, s39, 6400
    v_mfma_f32_16x16x32_bf16 v[252:255], v[56:59], v[16:19], v[252:255]
    s_waitcnt lgkmcnt(2)
    v_mfma_f32_16x16x32_bf16 v[128:131], v[64:67], v[24:27], v[128:131]
    buffer_load_dwordx4 v6, s[8:11], s38 offen offset:3072 lds
    s_setprio 3
    v_mfma_f32_16x16x32_bf16 v[128:131], v[68:71], v[28:31], v[128:131]
    v_mfma_f32_16x16x32_bf16 v[160:163], v[76:79], v[28:31], v[160:163]
    v_mfma_f32_16x16x32_bf16 v[160:163], v[72:75], v[24:27], v[160:163]
    ds_read_b128 v[16:19], v0 offset:49408
    v_mfma_f32_16x16x32_bf16 v[192:195], v[80:83], v[24:27], v[192:195]
    ds_read_b128 v[20:23], v1 offset:49408
    v_mfma_f32_16x16x32_bf16 v[192:195], v[84:87], v[28:31], v[192:195]
    v_mfma_f32_16x16x32_bf16 v[224:227], v[92:95], v[28:31], v[224:227]
    v_mfma_f32_16x16x32_bf16 v[224:227], v[88:91], v[24:27], v[224:227]
    s_waitcnt lgkmcnt(2)
    v_mfma_f32_16x16x32_bf16 v[132:135], v[64:67], v[8:11], v[132:135]
    v_mfma_f32_16x16x32_bf16 v[132:135], v[68:71], v[12:15], v[132:135]
    v_mfma_f32_16x16x32_bf16 v[164:167], v[76:79], v[12:15], v[164:167]
    v_mfma_f32_16x16x32_bf16 v[164:167], v[72:75], v[8:11], v[164:167]
    ds_read_b128 v[24:27], v2 offset:49408
    v_mfma_f32_16x16x32_bf16 v[196:199], v[80:83], v[8:11], v[196:199]
    ds_read_b128 v[28:31], v3 offset:49408
    v_mfma_f32_16x16x32_bf16 v[196:199], v[84:87], v[12:15], v[196:199]
    v_mfma_f32_16x16x32_bf16 v[228:231], v[92:95], v[12:15], v[228:231]
    v_mfma_f32_16x16x32_bf16 v[228:231], v[88:91], v[8:11], v[228:231]
    s_waitcnt lgkmcnt(2)
    v_mfma_f32_16x16x32_bf16 v[136:139], v[64:67], v[16:19], v[136:139]
    s_waitcnt vmcnt(0)
    s_barrier
    v_mfma_f32_16x16x32_bf16 v[136:139], v[68:71], v[20:23], v[136:139]
    v_mfma_f32_16x16x32_bf16 v[168:171], v[76:79], v[20:23], v[168:171]
    v_mfma_f32_16x16x32_bf16 v[168:171], v[72:75], v[16:19], v[168:171]
    ds_read_b128 v[8:11], v0 offset:49664
    v_mfma_f32_16x16x32_bf16 v[200:203], v[80:83], v[16:19], v[200:203]
    ds_read_b128 v[12:15], v1 offset:49664
    v_mfma_f32_16x16x32_bf16 v[200:203], v[84:87], v[20:23], v[200:203]
    v_mfma_f32_16x16x32_bf16 v[232:235], v[92:95], v[20:23], v[232:235]
    v_mfma_f32_16x16x32_bf16 v[232:235], v[88:91], v[16:19], v[232:235]
    s_waitcnt lgkmcnt(2)
    v_mfma_f32_16x16x32_bf16 v[140:143], v[64:67], v[24:27], v[140:143]
    v_mfma_f32_16x16x32_bf16 v[140:143], v[68:71], v[28:31], v[140:143]
    v_mfma_f32_16x16x32_bf16 v[172:175], v[76:79], v[28:31], v[172:175]
    v_mfma_f32_16x16x32_bf16 v[172:175], v[72:75], v[24:27], v[172:175]
    ds_read_b128 v[16:19], v2 offset:49664
    v_mfma_f32_16x16x32_bf16 v[204:207], v[80:83], v[24:27], v[204:207]
    ds_read_b128 v[20:23], v3 offset:49664
    v_mfma_f32_16x16x32_bf16 v[204:207], v[84:87], v[28:31], v[204:207]
    v_mfma_f32_16x16x32_bf16 v[236:239], v[92:95], v[28:31], v[236:239]
    v_mfma_f32_16x16x32_bf16 v[236:239], v[88:91], v[24:27], v[236:239]
    s_waitcnt lgkmcnt(2)
    v_mfma_f32_16x16x32_bf16 v[144:147], v[64:67], v[8:11], v[144:147]
    v_mfma_f32_16x16x32_bf16 v[144:147], v[68:71], v[12:15], v[144:147]
    v_mfma_f32_16x16x32_bf16 v[176:179], v[76:79], v[12:15], v[176:179]
    v_mfma_f32_16x16x32_bf16 v[176:179], v[72:75], v[8:11], v[176:179]
    ds_read_b128 v[24:27], v0 offset:49920
    v_mfma_f32_16x16x32_bf16 v[208:211], v[80:83], v[8:11], v[208:211]
    ds_read_b128 v[28:31], v1 offset:49920
    v_mfma_f32_16x16x32_bf16 v[208:211], v[84:87], v[12:15], v[208:211]
    v_mfma_f32_16x16x32_bf16 v[240:243], v[92:95], v[12:15], v[240:243]
    v_mfma_f32_16x16x32_bf16 v[240:243], v[88:91], v[8:11], v[240:243]
    s_waitcnt lgkmcnt(2)
    v_mfma_f32_16x16x32_bf16 v[148:151], v[64:67], v[16:19], v[148:151]
    v_mfma_f32_16x16x32_bf16 v[148:151], v[68:71], v[20:23], v[148:151]
    v_mfma_f32_16x16x32_bf16 v[180:183], v[76:79], v[20:23], v[180:183]
    v_mfma_f32_16x16x32_bf16 v[180:183], v[72:75], v[16:19], v[180:183]
    ds_read_b128 v[8:11], v2 offset:49920
    v_mfma_f32_16x16x32_bf16 v[212:215], v[80:83], v[16:19], v[212:215]
    ds_read_b128 v[12:15], v3 offset:49920
    v_mfma_f32_16x16x32_bf16 v[212:215], v[84:87], v[20:23], v[212:215]
    v_mfma_f32_16x16x32_bf16 v[244:247], v[92:95], v[20:23], v[244:247]
    v_mfma_f32_16x16x32_bf16 v[244:247], v[88:91], v[16:19], v[244:247]
    s_waitcnt lgkmcnt(2)
    v_mfma_f32_16x16x32_bf16 v[152:155], v[64:67], v[24:27], v[152:155]
    v_mfma_f32_16x16x32_bf16 v[152:155], v[68:71], v[28:31], v[152:155]
    v_mfma_f32_16x16x32_bf16 v[184:187], v[76:79], v[28:31], v[184:187]
    v_mfma_f32_16x16x32_bf16 v[184:187], v[72:75], v[24:27], v[184:187]
    v_mfma_f32_16x16x32_bf16 v[216:219], v[80:83], v[24:27], v[216:219]
    v_mfma_f32_16x16x32_bf16 v[216:219], v[84:87], v[28:31], v[216:219]
    v_mfma_f32_16x16x32_bf16 v[248:251], v[92:95], v[28:31], v[248:251]
    v_mfma_f32_16x16x32_bf16 v[248:251], v[88:91], v[24:27], v[248:251]
    s_waitcnt lgkmcnt(0)
    v_mfma_f32_16x16x32_bf16 v[156:159], v[64:67], v[8:11], v[156:159]
    v_mfma_f32_16x16x32_bf16 v[156:159], v[68:71], v[12:15], v[156:159]
    v_mfma_f32_16x16x32_bf16 v[188:191], v[76:79], v[12:15], v[188:191]
    v_mfma_f32_16x16x32_bf16 v[188:191], v[72:75], v[8:11], v[188:191]
    v_mfma_f32_16x16x32_bf16 v[220:223], v[80:83], v[8:11], v[220:223]
    v_mfma_f32_16x16x32_bf16 v[220:223], v[84:87], v[12:15], v[220:223]
    v_mfma_f32_16x16x32_bf16 v[252:255], v[92:95], v[12:15], v[252:255]
    v_mfma_f32_16x16x32_bf16 v[252:255], v[88:91], v[8:11], v[252:255]
    s_setprio 0
    s_lshl_b32 s96, s50, 2
    s_add_u32 s96, s96, s34
    s_mul_i32 s96, s96, 2560
    s_min_u32 s96, s96, 259584
    s_add_u32 s96, s96, 1048576
    s_call_b64 s[42:43], L_E1
    s_lshl_b32 s96, s50, 2
    s_add_u32 s96, s96, s34
    s_mul_i32 s96, s96, 2560
    s_min_u32 s96, s96, 259584
    s_add_u32 s96, s96, 1572864
    s_add_u32 s54, s39, 4096
    s_mov_b32 s53, s51
    s_add_u32 s52, s53, 1024
    v_mbcnt_lo_u32_b32 v92, -1, 0
    v_mbcnt_hi_u32_b32 v92, -1, v92
    s_mul_i32 s99, s33, 0
    s_buffer_load_dword s98, s[28:31], s99 offset:192
    s_mov_b32 s100, 131072
    v_bfe_u32 v0, v92, 2, 2
    v_and_or_b32 v0, v92, 48, v0
    v_and_b32 v1, 3, v92
    v_lshl_add_u32 v0, v1, 2, v0
    v_bfe_u32 v1, v92, 1, 1
    v_xor_b32 v0, v1, v0
    v_lshl_add_u32 v0, v0, 4, s100
    v_xor_b32 v1, 32, v0
    v_xor_b32 v2, 64, v0
    v_xor_b32 v3, 96, v0
    v_and_b32 v78, 15, v92
    v_lshlrev_b32 v78, 3, v78
    v_lshrrev_b32 v77, 5, v92
    v_lshl_add_u32 v77, v77, 11, v78
    v_mul_f32 v216, s40, v216
    v_mul_f32 v217, s40, v217
    v_mul_f32 v218, s40, v218
    v_mul_f32 v219, s40, v219
    v_mul_f32 v248, s40, v248
    v_mul_f32 v249, s40, v249
    v_mul_f32 v250, s40, v250
    v_mul_f32 v251, s40, v251
    buffer_load_ushort v64, v77, s[20:23], s39 offen offset:0
    v_exp_f32 v216, v216
    v_exp_f32 v217, v217
    v_exp_f32 v218, v218
    v_exp_f32 v219, v219
    v_exp_f32 v248, v248
    v_exp_f32 v249, v249
    v_exp_f32 v250, v250
    v_exp_f32 v251, v251
    v_fma_f32 v216, v216, s41, s41
    v_fma_f32 v217, v217, s41, s41
    v_fma_f32 v218, v218, s41, s41
    v_fma_f32 v219, v219, s41, s41
    v_fma_f32 v248, v248, s41, s41
    v_fma_f32 v249, v249, s41, s41
    v_fma_f32 v250, v250, s41, s41
    v_fma_f32 v251, v251, s41, s41
    v_rcp_f32 v216, v216
    v_rcp_f32 v217, v217
    v_rcp_f32 v218, v218
    v_rcp_f32 v219, v219
    v_rcp_f32 v248, v248
    buffer_load_ushort v65, v77, s[20:23], s39 offen offset:1024
    v_rcp_f32 v249, v249
    v_rcp_f32 v250, v250
    v_rcp_f32 v251, v251
    v_mul_f32 v216, v152, v216
    v_mul_f32 v217, v153, v217
    v_mul_f32 v218, v154, v218
    v_mul_f32 v219, v155, v219
    v_mul_f32 v248, v184, v248
    v_mul_f32 v249, v185, v249
    v_mul_f32 v250, v186, v250
    v_mul_f32 v251, v187, v251
    v_mul_f32 v196, s40, v196
    v_mul_f32 v197, s40, v197
    v_mul_f32 v198, s40, v198
    v_mul_f32 v199, s40, v199
    v_mul_f32 v228, s40, v228
    v_mul_f32 v229, s40, v229
    v_mul_f32 v230, s40, v230
    v_mul_f32 v231, s40, v231
    v_exp_f32 v196, v196
    v_exp_f32 v197, v197
    v_exp_f32 v198, v198
    v_exp_f32 v199, v199
    v_exp_f32 v228, v228
    v_exp_f32 v229, v229
    buffer_load_ushort v72, v78, s[20:23], s54 offen offset:0
    v_exp_f32 v230, v230
    v_exp_f32 v231, v231
    v_fma_f32 v196, v196, s41, s41
    v_fma_f32 v197, v197, s41, s41
    v_fma_f32 v198, v198, s41, s41
    v_fma_f32 v199, v199, s41, s41
    v_fma_f32 v228, v228, s41, s41
    v_fma_f32 v229, v229, s41, s41
    v_fma_f32 v230, v230, s41, s41
    v_fma_f32 v231, v231, s41, s41
    v_rcp_f32 v196, v196
    v_rcp_f32 v197, v197
    v_rcp_f32 v198, v198
    v_rcp_f32 v199, v199
    v_rcp_f32 v228, v228
    v_rcp_f32 v229, v229
    v_rcp_f32 v230, v230
    v_rcp_f32 v231, v231
    v_mul_f32 v196, v132, v196
    v_mul_f32 v197, v133, v197
    v_mul_f32 v198, v134, v198
    v_mul_f32 v199, v135, v199
    v_mul_f32 v228, v164, v228
    v_mul_f32 v229, v165, v229
    buffer_load_ushort v68, v77, s[20:23], s39 offen offset:2
    v_mul_f32 v230, v166, v230
    v_mul_f32 v231, v167, v231
    v_cvt_pk_bf16_f32 v154, v196, v197
    v_cvt_pk_bf16_f32 v155, v198, v199
    v_cvt_pk_bf16_f32 v186, v228, v229
    v_cvt_pk_bf16_f32 v187, v230, v231
    v_cvt_pk_bf16_f32 v164, v216, v217
    v_cvt_pk_bf16_f32 v165, v218, v219
    v_cvt_pk_bf16_f32 v196, v248, v249
    v_cvt_pk_bf16_f32 v197, v250, v251
    v_mul_f32 v220, s40, v220
    v_mul_f32 v221, s40, v221
    v_mul_f32 v222, s40, v222
    v_mul_f32 v223, s40, v223
    v_mul_f32 v252, s40, v252
    v_mul_f32 v253, s40, v253
    v_mul_f32 v254, s40, v254
    v_mul_f32 v255, s40, v255
    v_exp_f32 v220, v220
    v_exp_f32 v221, v221
    v_exp_f32 v222, v222
    v_exp_f32 v223, v223
    v_exp_f32 v252, v252
    v_exp_f32 v253, v253
    v_exp_f32 v254, v254
    v_exp_f32 v255, v255
    buffer_load_ushort v69, v77, s[20:23], s39 offen offset:1026
    s_waitcnt lgkmcnt(0)
    s_mov_b32 s58, 0x8000
L_rpollb:
    s_cmp_lt_u32 s98, 6
    s_cbranch_scc1 L_rrepollb
L_rpolledb:
    v_fma_f32 v220, v220, s41, s41
    v_fma_f32 v221, v221, s41, s41
    v_fma_f32 v222, v222, s41, s41
    v_fma_f32 v223, v223, s41, s41
    s_buffer_load_dwordx2 s[94:95], s[24:27], s96 offset:60
    v_fma_f32 v252, v252, s41, s41
    v_fma_f32 v253, v253, s41, s41
    v_fma_f32 v254, v254, s41, s41
    v_fma_f32 v255, v255, s41, s41
    v_rcp_f32 v220, v220
    v_rcp_f32 v221, v221
    v_rcp_f32 v222, v222
    v_rcp_f32 v223, v223
    v_rcp_f32 v252, v252
    v_rcp_f32 v253, v253
    s_buffer_load_dwordx2 s[94:95], s[24:27], s96 offset:188
    v_rcp_f32 v254, v254
    v_rcp_f32 v255, v255
    v_mul_f32 v220, v156, v220
    v_mul_f32 v221, v157, v221
    v_mul_f32 v222, v158, v222
    v_mul_f32 v223, v159, v223
    v_mul_f32 v252, v188, v252
    v_mul_f32 v253, v189, v253
    v_mul_f32 v254, v190, v254
    v_mul_f32 v255, v191, v255
    v_cvt_pk_bf16_f32 v166, v220, v221
    v_cvt_pk_bf16_f32 v167, v222, v223
    buffer_load_ushort v74, v78, s[20:23], s54 offen offset:2
    v_cvt_pk_bf16_f32 v198, v252, v253
    v_cvt_pk_bf16_f32 v199, v254, v255
    s_buffer_load_dwordx2 s[94:95], s[24:27], s96 offset:316
    v_mul_f32 v192, s40, v192
    v_mul_f32 v193, s40, v193
    v_mul_f32 v194, s40, v194
    v_mul_f32 v195, s40, v195
    v_mul_f32 v224, s40, v224
    v_mul_f32 v225, s40, v225
    v_mul_f32 v226, s40, v226
    v_mul_f32 v227, s40, v227
    v_exp_f32 v192, v192
    v_exp_f32 v193, v193
    v_exp_f32 v194, v194
    v_exp_f32 v195, v195
    s_buffer_load_dwordx2 s[94:95], s[24:27], s96 offset:444
    v_exp_f32 v224, v224
    v_exp_f32 v225, v225
    v_exp_f32 v226, v226
    v_exp_f32 v227, v227
    v_fma_f32 v192, v192, s41, s41
    v_fma_f32 v193, v193, s41, s41
    v_fma_f32 v194, v194, s41, s41
    v_fma_f32 v195, v195, s41, s41
    v_fma_f32 v224, v224, s41, s41
    v_fma_f32 v225, v225, s41, s41
    v_fma_f32 v226, v226, s41, s41
    v_fma_f32 v227, v227, s41, s41
    s_buffer_load_dwordx2 s[94:95], s[24:27], s96 offset:572
    v_rcp_f32 v192, v192
    v_rcp_f32 v193, v193
    v_rcp_f32 v194, v194
    v_rcp_f32 v195, v195
    v_rcp_f32 v224, v224
    v_rcp_f32 v225, v225
    v_rcp_f32 v226, v226
    v_rcp_f32 v227, v227
    s_buffer_load_dwordx2 s[94:95], s[24:27], s96 offset:700
    v_mul_f32 v192, v128, v192
    v_mul_f32 v193, v129, v193
    v_mul_f32 v194, v130, v194
    v_mul_f32 v195, v131, v195
    v_mul_f32 v224, v160, v224
    v_mul_f32 v225, v161, v225
    v_mul_f32 v226, v162, v226
    v_mul_f32 v227, v163, v227
    v_cvt_pk_bf16_f32 v152, v192, v193
    v_cvt_pk_bf16_f32 v153, v194, v195
    v_cvt_pk_bf16_f32 v184, v224, v225
    v_cvt_pk_bf16_f32 v185, v226, v227
    v_cndmask_b32 v84, v164, v152, s[44:45]
    v_cndmask_b32 v85, v165, v153, s[44:45]
    v_cndmask_b32 v86, v166, v154, s[44:45]
    v_cndmask_b32 v87, v167, v155, s[44:45]
    s_buffer_load_dwordx2 s[94:95], s[24:27], s96 offset:828
    v_cndmask_b32 v88, v196, v184, s[44:45]
    v_cndmask_b32 v89, v197, v185, s[44:45]
    v_cndmask_b32 v90, v198, v186, s[44:45]
    v_cndmask_b32 v91, v199, v187, s[44:45]
    s_mov_b64 exec, s[48:49]
    buffer_store_dwordx4 v[84:87], v5, s[24:27], s52 offen offset:0 sc1
    buffer_store_dwordx4 v[88:91], v5, s[24:27], s52 offen offset:128 sc1
    s_mov_b64 exec, -1
    v_and_b32 v76, 3, v92
    v_mul_u32_u24 v76, 0x5555, v76
    v_lshlrev_b32 v79, 4, v92
    v_mul_f32 v212, s40, v212
    v_mul_f32 v213, s40, v213
    v_mul_f32 v214, s40, v214
    v_mul_f32 v215, s40, v215
    v_mul_f32 v244, s40, v244
    v_mul_f32 v245, s40, v245
    v_mul_f32 v246, s40, v246
    v_mul_f32 v247, s40, v247
    v_exp_f32 v212, v212
    s_buffer_load_dwordx2 s[94:95], s[24:27], s96 offset:956
    v_exp_f32 v213, v213
    v_exp_f32 v214, v214
    v_exp_f32 v215, v215
    v_exp_f32 v244, v244
    v_exp_f32 v245, v245
    v_exp_f32 v246, v246
    v_exp_f32 v247, v247
    v_fma_f32 v212, v212, s41, s41
    s_buffer_load_dwordx2 s[94:95], s[24:27], s96 offset:1084
    v_fma_f32 v213, v213, s41, s41
    v_fma_f32 v214, v214, s41, s41
    v_fma_f32 v215, v215, s41, s41
    v_fma_f32 v244, v244, s41, s41
    v_fma_f32 v245, v245, s41, s41
    v_fma_f32 v246, v246, s41, s41
    v_fma_f32 v247, v247, s41, s41
    v_rcp_f32 v212, v212
    v_rcp_f32 v213, v213
    v_rcp_f32 v214, v214
    v_rcp_f32 v215, v215
    v_rcp_f32 v244, v244
    s_buffer_load_dwordx2 s[94:95], s[24:27], s96 offset:1212
    v_rcp_f32 v245, v245
    v_rcp_f32 v246, v246
    v_rcp_f32 v247, v247
    v_mul_f32 v212, v148, v212
    v_mul_f32 v213, v149, v213
    v_mul_f32 v214, v150, v214
    v_mul_f32 v215, v151, v215
    v_mul_f32 v244, v180, v244
    v_mul_f32 v245, v181, v245
    v_mul_f32 v246, v182, v246
    v_mul_f32 v247, v183, v247
    v_cvt_pk_bf16_f32 v162, v212, v213
    s_buffer_load_dwordx2 s[94:95], s[24:27], s96 offset:1340
    v_cvt_pk_bf16_f32 v163, v214, v215
    v_cvt_pk_bf16_f32 v194, v244, v245
    v_cvt_pk_bf16_f32 v195, v246, v247
    v_mul_f32 v208, s40, v208
    v_mul_f32 v209, s40, v209
    v_mul_f32 v210, s40, v210
    v_mul_f32 v211, s40, v211
    v_mul_f32 v240, s40, v240
    v_mul_f32 v241, s40, v241
    v_mul_f32 v242, s40, v242
    v_mul_f32 v243, s40, v243
    v_exp_f32 v208, v208
    v_exp_f32 v209, v209
    v_exp_f32 v210, v210
    s_buffer_load_dwordx2 s[94:95], s[24:27], s96 offset:1468
    v_exp_f32 v211, v211
    v_exp_f32 v240, v240
    v_exp_f32 v241, v241
    v_exp_f32 v242, v242
    v_exp_f32 v243, v243
    v_fma_f32 v208, v208, s41, s41
    v_fma_f32 v209, v209, s41, s41
    v_fma_f32 v210, v210, s41, s41
    v_fma_f32 v211, v211, s41, s41
    v_fma_f32 v240, v240, s41, s41
    s_buffer_load_dwordx2 s[94:95], s[24:27], s96 offset:1596
    v_fma_f32 v241, v241, s41, s41
    v_fma_f32 v242, v242, s41, s41
    v_fma_f32 v243, v243, s41, s41
    v_rcp_f32 v208, v208
    v_rcp_f32 v209, v209
    v_rcp_f32 v210, v210
    v_rcp_f32 v211, v211
    v_rcp_f32 v240, v240
    v_rcp_f32 v241, v241
    v_rcp_f32 v242, v242
    s_buffer_load_dwordx2 s[94:95], s[24:27], s96 offset:1724
    v_rcp_f32 v243, v243
    v_mul_f32 v208, v144, v208
    v_mul_f32 v209, v145, v209
    v_mul_f32 v210, v146, v210
    v_mul_f32 v211, v147, v211
    v_mul_f32 v240, v176, v240
    v_mul_f32 v241, v177, v241
    v_mul_f32 v242, v178, v242
    v_mul_f32 v243, v179, v243
    v_cvt_pk_bf16_f32 v160, v208, v209
    v_cvt_pk_bf16_f32 v161, v210, v211
    v_cvt_pk_bf16_f32 v192, v240, v241
    v_cvt_pk_bf16_f32 v193, v242, v243
    s_waitcnt vmcnt(2)
    v_lshlrev_b32 v72, v79, v72
    s_buffer_load_dwordx2 s[94:95], s[24:27], s96 offset:1852
    v_lshlrev_b32 v74, v79, v74
    s_mov_b32 s100, 0xf00000f0
    s_mov_b32 s101, 0xf00000f0
    v_cndmask_b32 v66, 0, v64, s[100:101]
    v_cndmask_b32 v67, 0, v65, s[100:101]
    v_cndmask_b32 v70, 0, v68, s[100:101]
    v_cndmask_b32 v71, 0, v69, s[100:101]
    s_mov_b32 s100, 0xf00000f
    s_mov_b32 s101, 0xf00000f
    v_cndmask_b32 v64, 0, v64, s[100:101]
    v_cndmask_b32 v65, 0, v65, s[100:101]
    v_cndmask_b32 v68, 0, v68, s[100:101]
    v_cndmask_b32 v69, 0, v69, s[100:101]
    s_mov_b32 s100, 0xc0000c
    s_mov_b32 s101, 0xc0000c00
    v_cndmask_b32 v73, 0, v72, s[100:101]
    v_cndmask_b32 v75, 0, v74, s[100:101]
    s_mov_b32 s100, 0x300003
    s_mov_b32 s101, 0x30000300
    v_cndmask_b32 v72, 0, v72, s[100:101]
    v_cndmask_b32 v74, 0, v74, s[100:101]
    v_mul_f32 v204, s40, v204
    v_mul_f32 v205, s40, v205
    v_mul_f32 v206, s40, v206
    s_buffer_load_dwordx2 s[94:95], s[24:27], s96 offset:1980
    v_mul_f32 v207, s40, v207
    v_mul_f32 v236, s40, v236
    v_mul_f32 v237, s40, v237
    v_mul_f32 v238, s40, v238
    v_mul_f32 v239, s40, v239
    v_exp_f32 v204, v204
    v_exp_f32 v205, v205
    v_exp_f32 v206, v206
    v_exp_f32 v207, v207
    v_exp_f32 v236, v236
    v_exp_f32 v237, v237
    s_buffer_load_dwordx2 s[94:95], s[24:27], s96 offset:2108
    v_exp_f32 v238, v238
    v_exp_f32 v239, v239
    v_fma_f32 v204, v204, s41, s41
    v_fma_f32 v205, v205, s41, s41
    v_fma_f32 v206, v206, s41, s41
    v_fma_f32 v207, v207, s41, s41
    v_fma_f32 v236, v236, s41, s41
    v_fma_f32 v237, v237, s41, s41
    v_fma_f32 v238, v238, s41, s41
    v_fma_f32 v239, v239, s41, s41
    v_rcp_f32 v204, v204
    v_rcp_f32 v205, v205
    s_buffer_load_dwordx2 s[94:95], s[24:27], s96 offset:2236
    v_rcp_f32 v206, v206
    v_rcp_f32 v207, v207
    v_rcp_f32 v236, v236
    v_rcp_f32 v237, v237
    v_rcp_f32 v238, v238
    v_rcp_f32 v239, v239
    v_mul_f32 v204, v140, v204
    v_mul_f32 v205, v141, v205
    v_mul_f32 v206, v142, v206
    s_buffer_load_dwordx2 s[94:95], s[24:27], s96 offset:2364
    v_mul_f32 v207, v143, v207
    v_mul_f32 v236, v172, v236
    v_mul_f32 v237, v173, v237
    v_mul_f32 v238, v174, v238
    v_mul_f32 v239, v175, v239
    v_cvt_pk_bf16_f32 v158, v204, v205
    v_cvt_pk_bf16_f32 v159, v206, v207
    v_cvt_pk_bf16_f32 v190, v236, v237
    v_cvt_pk_bf16_f32 v191, v238, v239
    v_mul_f32 v200, s40, v200
    v_mul_f32 v201, s40, v201
    v_mul_f32 v202, s40, v202
    v_mul_f32 v203, s40, v203
    v_mul_f32 v232, s40, v232
    v_mul_f32 v233, s40, v233
    v_mul_f32 v234, s40, v234
    s_buffer_load_dwordx2 s[94:95], s[24:27], s96 offset:2492
    v_mul_f32 v235, s40, v235
    v_exp_f32 v200, v200
    v_exp_f32 v201, v201
    v_exp_f32 v202, v202
    v_exp_f32 v203, v203
    v_exp_f32 v232, v232
    v_exp_f32 v233, v233
    v_exp_f32 v234, v234
    v_exp_f32 v235, v235
    s_setprio 3
    v_mfma_f32_16x16x16_bf16 v[128:131], v[72:73], v[166:167], 0
    v_fma_f32 v200, v200, s41, s41
    v_fma_f32 v201, v201, s41, s41
    v_fma_f32 v202, v202, s41, s41
    v_mfma_f32_16x16x16_bf16 v[132:135], v[74:75], v[198:199], 0
    s_setprio 0
    v_fma_f32 v203, v203, s41, s41
    v_fma_f32 v232, v232, s41, s41
    v_fma_f32 v233, v233, s41, s41
    v_fma_f32 v234, v234, s41, s41
    v_fma_f32 v235, v235, s41, s41
    v_rcp_f32 v200, v200
    v_rcp_f32 v201, v201
    v_rcp_f32 v202, v202
    v_rcp_f32 v203, v203
    v_rcp_f32 v232, v232
    v_rcp_f32 v233, v233
    v_rcp_f32 v234, v234
    v_rcp_f32 v235, v235
    s_setprio 3
    v_smfmac_f32_16x16x64_bf16 v[128:131], v[64:67], v[158:165], v76
    v_mul_f32 v200, v136, v200
    v_smfmac_f32_16x16x64_bf16 v[132:135], v[68:71], v[190:197], v76
    s_setprio 0
    v_mul_f32 v201, v137, v201
    v_mul_f32 v202, v138, v202
    v_mul_f32 v203, v139, v203
    v_mul_f32 v232, v168, v232
    v_mul_f32 v233, v169, v233
    v_mul_f32 v234, v170, v234
    v_mul_f32 v235, v171, v235
    v_cvt_pk_bf16_f32 v156, v200, v201
    v_cvt_pk_bf16_f32 v157, v202, v203
    v_cvt_pk_bf16_f32 v188, v232, v233
    s_barrier
    v_cvt_pk_bf16_f32 v189, v234, v235
    v_exp_f32 v84, v128
    v_exp_f32 v85, v129
    v_exp_f32 v86, v130
    v_exp_f32 v87, v131
    v_exp_f32 v88, v132
    v_exp_f32 v89, v133
    v_exp_f32 v90, v134
    v_exp_f32 v91, v135
    s_setprio 3
    v_mfma_f32_16x16x16_bf16 v[136:139], v[72:73], v[164:165], 0
    v_fma_f32 v84, v84, s40, s40
    v_fma_f32 v85, v85, s40, s40
    v_fma_f32 v86, v86, s40, s40
    v_mfma_f32_16x16x16_bf16 v[140:143], v[74:75], v[196:197], 0
    s_setprio 1
    v_fma_f32 v87, v87, s40, s40
    v_fma_f32 v88, v88, s40, s40
    v_fma_f32 v89, v89, s40, s40
    v_fma_f32 v90, v90, s40, s40
    v_fma_f32 v91, v91, s40, s40
    v_rcp_f32 v84, v84
    v_rcp_f32 v85, v85
    v_xor_b32 v4, 80, v4
    ds_write_b128 v4, v[116:119] offset:0
    v_rcp_f32 v86, v86
    v_rcp_f32 v87, v87
    v_rcp_f32 v88, v88
    v_rcp_f32 v89, v89
    v_rcp_f32 v90, v90
    v_rcp_f32 v91, v91
    s_mov_b64 exec, s[48:49]
    buffer_load_dwordx4 v[148:151], v6, s[24:27], s53 offen offset:0 sc1
    buffer_load_dwordx4 v[180:183], v6, s[24:27], s53 offen offset:128 sc1
    s_mov_b64 exec, -1
    s_setprio 3
    v_smfmac_f32_16x16x64_bf16 v[136:139], v[64:67], v[156:163], v76
    v_mul_f32 v84, v128, v84
    v_smfmac_f32_16x16x64_bf16 v[140:143], v[68:71], v[188:195], v76
    s_setprio 1
    v_mul_f32 v85, v129, v85
    v_mul_f32 v86, v130, v86
    v_mul_f32 v87, v131, v87
    v_mul_f32 v88, v132, v88
    v_mul_f32 v89, v133, v89
    v_mul_f32 v90, v134, v90
    v_mul_f32 v91, v135, v91
    v_cvt_pk_bf16_f32 v244, v84, v85
    v_cvt_pk_bf16_f32 v245, v86, v87
    v_cvt_pk_bf16_f32 v246, v88, v89
    v_cvt_pk_bf16_f32 v247, v90, v91
    v_exp_f32 v84, v136
    ds_write_b128 v4, v[244:247] offset:32768
    v_exp_f32 v85, v137
    v_exp_f32 v86, v138
    v_exp_f32 v87, v139
    v_exp_f32 v88, v140
    v_exp_f32 v89, v141
    v_exp_f32 v90, v142
    v_exp_f32 v91, v143
    s_setprio 3
    v_mfma_f32_16x16x16_bf16 v[128:131], v[72:73], v[162:163], 0
    v_fma_f32 v84, v84, s40, s40
    v_fma_f32 v85, v85, s40, s40
    v_fma_f32 v86, v86, s40, s40
    v_mfma_f32_16x16x16_bf16 v[132:135], v[74:75], v[194:195], 0
    s_setprio 1
    v_fma_f32 v87, v87, s40, s40
    v_fma_f32 v88, v88, s40, s40
    v_fma_f32 v89, v89, s40, s40
    v_fma_f32 v90, v90, s40, s40
    v_fma_f32 v91, v91, s40, s40
    v_rcp_f32 v84, v84
    v_rcp_f32 v85, v85
    v_xor_b32 v4, 16, v4
    ds_write_b128 v4, v[112:115] offset:0
    v_rcp_f32 v86, v86
    v_rcp_f32 v87, v87
    v_rcp_f32 v88, v88
    v_rcp_f32 v89, v89
    v_rcp_f32 v90, v90
    v_rcp_f32 v91, v91
    s_setprio 3
    v_smfmac_f32_16x16x64_bf16 v[128:131], v[64:67], v[154:161], v76
    v_mul_f32 v84, v136, v84
    v_smfmac_f32_16x16x64_bf16 v[132:135], v[68:71], v[186:193], v76
    s_setprio 1
    v_mul_f32 v85, v137, v85
    v_mul_f32 v86, v138, v86
    v_mul_f32 v87, v139, v87
    v_mul_f32 v88, v140, v88
    v_mul_f32 v89, v141, v89
    v_mul_f32 v90, v142, v90
    v_mul_f32 v91, v143, v91
    v_cvt_pk_bf16_f32 v240, v84, v85
    v_cvt_pk_bf16_f32 v241, v86, v87
    v_cvt_pk_bf16_f32 v242, v88, v89
    v_cvt_pk_bf16_f32 v243, v90, v91
    v_exp_f32 v84, v128
    ds_write_b128 v4, v[240:243] offset:32768
    v_exp_f32 v85, v129
    v_exp_f32 v86, v130
    v_exp_f32 v87, v131
    v_exp_f32 v88, v132
    v_exp_f32 v89, v133
    v_exp_f32 v90, v134
    v_exp_f32 v91, v135
    s_setprio 3
    v_mfma_f32_16x16x16_bf16 v[136:139], v[72:73], v[160:161], 0
    v_fma_f32 v84, v84, s40, s40
    v_fma_f32 v85, v85, s40, s40
    v_fma_f32 v86, v86, s40, s40
    v_mfma_f32_16x16x16_bf16 v[140:143], v[74:75], v[192:193], 0
    s_setprio 1
    v_fma_f32 v87, v87, s40, s40
    v_fma_f32 v88, v88, s40, s40
    v_fma_f32 v89, v89, s40, s40
    v_fma_f32 v90, v90, s40, s40
    v_fma_f32 v91, v91, s40, s40
    v_rcp_f32 v84, v84
    v_rcp_f32 v85, v85
    v_xor_b32 v4, 112, v4
    ds_write_b128 v4, v[108:111] offset:0
    v_rcp_f32 v86, v86
    v_rcp_f32 v87, v87
    v_rcp_f32 v88, v88
    v_rcp_f32 v89, v89
    v_rcp_f32 v90, v90
    v_rcp_f32 v91, v91
    s_setprio 3
    v_smfmac_f32_16x16x64_bf16 v[136:139], v[64:67], v[152:159], v76
    v_mul_f32 v84, v128, v84
    v_smfmac_f32_16x16x64_bf16 v[140:143], v[68:71], v[184:191], v76
    s_setprio 1
    v_mul_f32 v85, v129, v85
    v_mul_f32 v86, v130, v86
    v_mul_f32 v87, v131, v87
    v_mul_f32 v88, v132, v88
    v_mul_f32 v89, v133, v89
    v_mul_f32 v90, v134, v90
    v_mul_f32 v91, v135, v91
    v_cvt_pk_bf16_f32 v236, v84, v85
    v_cvt_pk_bf16_f32 v237, v86, v87
    v_cvt_pk_bf16_f32 v238, v88, v89
    v_cvt_pk_bf16_f32 v239, v90, v91
    s_waitcnt vmcnt(0)
    s_mov_b64 exec, s[48:49]
    s_mov_b32 s58, 0x8000
L_pollb:
    v_max3_u32 v82, v148, v149, v150
    v_max3_u32 v83, v180, v181, v182
    v_max3_u32 v82, v82, v151, v183
    v_max_u32 v82, v82, v83
    v_cmp_ne_u32 vcc, -1, v82
    s_nop 1
    s_cmp_eq_u64 vcc, exec
    s_cbranch_scc0 L_repollb
L_polledb:
    s_mov_b64 exec, -1
    s_mov_b64 vcc, s[46:47]
    v_cndmask_b32_dpp v168, v152, v148, vcc row_shl:1 row_mask:0xf bank_mask:0xf bound_ctrl:1
    v_cndmask_b32_dpp v169, v153, v149, vcc row_shl:1 row_mask:0xf bank_mask:0xf bound_ctrl:1
    ds_write_b128 v4, v[236:239] offset:32768
    v_cndmask_b32_dpp v170, v154, v150, vcc row_shl:1 row_mask:0xf bank_mask:0xf bound_ctrl:1
    v_cndmask_b32_dpp v171, v155, v151, vcc row_shl:1 row_mask:0xf bank_mask:0xf bound_ctrl:1
    v_cndmask_b32_dpp v200, v184, v180, vcc row_shl:1 row_mask:0xf bank_mask:0xf bound_ctrl:1
    v_cndmask_b32_dpp v201, v185, v181, vcc row_shl:1 row_mask:0xf bank_mask:0xf bound_ctrl:1
    v_cndmask_b32_dpp v202, v186, v182, vcc row_shl:1 row_mask:0xf bank_mask:0xf bound_ctrl:1
    v_cndmask_b32_dpp v203, v187, v183, vcc row_shl:1 row_mask:0xf bank_mask:0xf bound_ctrl:1
    v_mov_b32_dpp v148, v164 row_shr:1 row_mask:0xf bank_mask:0xf
    v_mov_b32_dpp v149, v165 row_shr:1 row_mask:0xf bank_mask:0xf
    v_mov_b32_dpp v150, v166 row_shr:1 row_mask:0xf bank_mask:0xf
    v_mov_b32_dpp v151, v167 row_shr:1 row_mask:0xf bank_mask:0xf
    v_mov_b32_dpp v180, v196 row_shr:1 row_mask:0xf bank_mask:0xf
    v_mov_b32_dpp v181, v197 row_shr:1 row_mask:0xf bank_mask:0xf
    v_mov_b32_dpp v182, v198 row_shr:1 row_mask:0xf bank_mask:0xf
    v_mov_b32_dpp v183, v199 row_shr:1 row_mask:0xf bank_mask:0xf
    v_exp_f32 v84, v136
    v_exp_f32 v85, v137
    v_exp_f32 v86, v138
    v_exp_f32 v87, v139
    v_exp_f32 v88, v140
    v_exp_f32 v89, v141
    v_exp_f32 v90, v142
    v_exp_f32 v91, v143
    s_setprio 3
    v_mfma_f32_16x16x16_bf16 v[128:131], v[72:73], v[168:169], 0
    v_fma_f32 v84, v84, s40, s40
    v_fma_f32 v85, v85, s40, s40
    v_fma_f32 v86, v86, s40, s40
    v_mfma_f32_16x16x16_bf16 v[132:135], v[74:75], v[200:201], 0
    s_setprio 1
    v_fma_f32 v87, v87, s40, s40
    v_fma_f32 v88, v88, s40, s40
    v_fma_f32 v89, v89, s40, s40
    v_fma_f32 v90, v90, s40, s40
    v_fma_f32 v91, v91, s40, s40
    v_rcp_f32 v84, v84
    v_rcp_f32 v85, v85
    v_xor_b32 v4, 16, v4
    ds_write_b128 v4, v[104:107] offset:0
    v_rcp_f32 v86, v86
    v_rcp_f32 v87, v87
    v_rcp_f32 v88, v88
    v_rcp_f32 v89, v89
    v_rcp_f32 v90, v90
    v_rcp_f32 v91, v91
    s_setprio 3
    v_smfmac_f32_16x16x64_bf16 v[128:131], v[64:67], v[160:167], v76
    v_mul_f32 v84, v136, v84
    v_smfmac_f32_16x16x64_bf16 v[132:135], v[68:71], v[192:199], v76
    s_setprio 1
    v_mul_f32 v85, v137, v85
    v_mul_f32 v86, v138, v86
    v_mul_f32 v87, v139, v87
    v_mul_f32 v88, v140, v88
    v_mul_f32 v89, v141, v89
    v_mul_f32 v90, v142, v90
    v_mul_f32 v91, v143, v91
    v_cvt_pk_bf16_f32 v232, v84, v85
    v_cvt_pk_bf16_f32 v233, v86, v87
    v_cvt_pk_bf16_f32 v234, v88, v89
    v_cvt_pk_bf16_f32 v235, v90, v91
    v_exp_f32 v84, v128
    ds_write_b128 v4, v[232:235] offset:32768
    v_exp_f32 v85, v129
    v_exp_f32 v86, v130
    s_lshl_b32 s38, s32, 16
    s_add_u32 s38, s38, 1572864
    v_exp_f32 v87, v131
    buffer_load_dwordx4 v[32:35], v7, s[24:27], s38 offen offset:0 sc1
    v_exp_f32 v88, v132
    v_exp_f32 v89, v133
    v_exp_f32 v90, v134
    v_exp_f32 v91, v135
    s_setprio 3
    v_mfma_f32_16x16x16_bf16 v[136:139], v[72:73], v[170:171], 0
    v_fma_f32 v84, v84, s40, s40
    v_fma_f32 v85, v85, s40, s40
    v_fma_f32 v86, v86, s40, s40
    v_mfma_f32_16x16x16_bf16 v[140:143], v[74:75], v[202:203], 0
    s_setprio 1
    v_fma_f32 v87, v87, s40, s40
    v_fma_f32 v88, v88, s40, s40
    v_fma_f32 v89, v89, s40, s40
    v_fma_f32 v90, v90, s40, s40
    v_fma_f32 v91, v91, s40, s40
    v_rcp_f32 v84, v84
    buffer_load_dwordx4 v[36:39], v7, s[24:27], s38 offen offset:1024 sc1
    v_rcp_f32 v85, v85
    v_xor_b32 v4, 64, v4
    ds_write_b128 v4, v[120:123] offset:0
    v_rcp_f32 v86, v86
    v_rcp_f32 v87, v87
    v_rcp_f32 v88, v88
    v_rcp_f32 v89, v89
    v_rcp_f32 v90, v90
    v_rcp_f32 v91, v91
    s_setprio 3
    v_smfmac_f32_16x16x64_bf16 v[136:139], v[64:67], v[162:169], v76
    v_mul_f32 v84, v128, v84
    v_smfmac_f32_16x16x64_bf16 v[140:143], v[68:71], v[194:201], v76
    s_setprio 1
    v_mul_f32 v85, v129, v85
    v_mul_f32 v86, v130, v86
    v_mul_f32 v87, v131, v87
    buffer_load_dwordx4 v[40:43], v7, s[24:27], s38 offen offset:2048 sc1
    v_mul_f32 v88, v132, v88
    v_mul_f32 v89, v133, v89
    v_mul_f32 v90, v134, v90
    v_mul_f32 v91, v135, v91
    v_cvt_pk_bf16_f32 v248, v84, v85
    v_cvt_pk_bf16_f32 v249, v86, v87
    v_cvt_pk_bf16_f32 v250, v88, v89
    v_cvt_pk_bf16_f32 v251, v90, v91
    v_exp_f32 v84, v136
    ds_write_b128 v4, v[248:251] offset:32768
    v_exp_f32 v85, v137
    v_exp_f32 v86, v138
    v_exp_f32 v87, v139
    v_exp_f32 v88, v140
    buffer_load_dwordx4 v[44:47], v7, s[24:27], s38 offen offset:3072 sc1
    s_add_u32 s38, s38, 4096
    v_exp_f32 v89, v141
    v_exp_f32 v90, v142
    v_exp_f32 v91, v143
    s_setprio 3
    v_mfma_f32_16x16x16_bf16 v[128:131], v[72:73], v[156:157], 0
    v_fma_f32 v84, v84, s40, s40
    v_fma_f32 v85, v85, s40, s40
    v_fma_f32 v86, v86, s40, s40
    v_mfma_f32_16x16x16_bf16 v[132:135], v[74:75], v[188:189], 0
    s_setprio 1
    v_fma_f32 v87, v87, s40, s40
    v_fma_f32 v88, v88, s40, s40
    v_fma_f32 v89, v89, s40, s40
    v_fma_f32 v90, v90, s40, s40
    v_fma_f32 v91, v91, s40, s40
    v_rcp_f32 v84, v84
    v_rcp_f32 v85, v85
    v_xor_b32 v4, 16, v4
    ds_write_b128 v4, v[124:127] offset:0
    buffer_load_dwordx4 v[48:51], v7, s[24:27], s38 offen offset:0 sc1
    v_rcp_f32 v86, v86
    v_rcp_f32 v87, v87
    v_rcp_f32 v88, v88
    v_rcp_f32 v89, v89
    v_rcp_f32 v90, v90
    v_rcp_f32 v91, v91
    s_setprio 3
    v_smfmac_f32_16x16x64_bf16 v[128:131], v[64:67], v[148:155], v76
    v_mul_f32 v84, v136, v84
    v_smfmac_f32_16x16x64_bf16 v[132:135], v[68:71], v[180:187], v76
    s_setprio 1
    v_mul_f32 v85, v137, v85
    v_mul_f32 v86, v138, v86
    v_mul_f32 v87, v139, v87
    v_mul_f32 v88, v140, v88
    v_mul_f32 v89, v141, v89
    buffer_load_dwordx4 v[52:55], v7, s[24:27], s38 offen offset:1024 sc1
    v_mul_f32 v90, v142, v90
    v_mul_f32 v91, v143, v91
    v_cvt_pk_bf16_f32 v252, v84, v85
    v_cvt_pk_bf16_f32 v253, v86, v87
    v_cvt_pk_bf16_f32 v254, v88, v89
    v_cvt_pk_bf16_f32 v255, v90, v91
    v_exp_f32 v84, v128
    ds_write_b128 v4, v[252:255] offset:32768
    v_exp_f32 v85, v129
    v_exp_f32 v86, v130
    v_exp_f32 v87, v131
    v_exp_f32 v88, v132
    v_exp_f32 v89, v133
    buffer_load_dwordx4 v[56:59], v7, s[24:27], s38 offen offset:2048 sc1
    v_exp_f32 v90, v134
    v_exp_f32 v91, v135
    s_setprio 3
    v_mfma_f32_16x16x16_bf16 v[136:139], v[72:73], v[158:159], 0
    v_fma_f32 v84, v84, s40, s40
    v_fma_f32 v85, v85, s40, s40
    v_fma_f32 v86, v86, s40, s40
    v_mfma_f32_16x16x16_bf16 v[140:143], v[74:75], v[190:191], 0
    s_setprio 1
    v_fma_f32 v87, v87, s40, s40
    v_fma_f32 v88, v88, s40, s40
    v_fma_f32 v89, v89, s40, s40
    v_fma_f32 v90, v90, s40, s40
    v_fma_f32 v91, v91, s40, s40
    v_rcp_f32 v84, v84
    v_rcp_f32 v85, v85
    v_xor_b32 v4, 112, v4
    ds_write_b128 v4, v[96:99] offset:0
    v_rcp_f32 v86, v86
    buffer_load_dwordx4 v[60:63], v7, s[24:27], s38 offen offset:3072 sc1
    s_add_u32 s38, s38, 4096
    v_rcp_f32 v87, v87
    v_rcp_f32 v88, v88
    v_rcp_f32 v89, v89
    v_rcp_f32 v90, v90
    v_rcp_f32 v91, v91
    s_setprio 3
    v_smfmac_f32_16x16x64_bf16 v[136:139], v[64:67], v[150:157], v76
    v_mul_f32 v84, v128, v84
    v_smfmac_f32_16x16x64_bf16 v[140:143], v[68:71], v[182:189], v76
    s_setprio 1
    v_mul_f32 v85, v129, v85
    v_mul_f32 v86, v130, v86
    v_mul_f32 v87, v131, v87
    v_mul_f32 v88, v132, v88
    v_mul_f32 v89, v133, v89
    v_mul_f32 v90, v134, v90
    v_mul_f32 v91, v135, v91
    v_cvt_pk_bf16_f32 v224, v84, v85
    v_cvt_pk_bf16_f32 v225, v86, v87
    v_cvt_pk_bf16_f32 v226, v88, v89
    v_cvt_pk_bf16_f32 v227, v90, v91
    v_exp_f32 v84, v136
    ds_write_b128 v4, v[224:227] offset:32768
    v_exp_f32 v85, v137
    ds_read_b128 v[8:11], v0 offset:0
    v_exp_f32 v86, v138
    v_exp_f32 v87, v139
    v_exp_f32 v88, v140
    ds_read_b128 v[12:15], v0 offset:8192
    v_exp_f32 v89, v141
    v_exp_f32 v90, v142
    v_exp_f32 v91, v143
    ds_read_b128 v[16:19], v1 offset:1024
    v_fma_f32 v84, v84, s40, s40
    v_fma_f32 v85, v85, s40, s40
    v_fma_f32 v86, v86, s40, s40
    v_fma_f32 v87, v87, s40, s40
    v_fma_f32 v88, v88, s40, s40
    v_fma_f32 v89, v89, s40, s40
    ds_read_b128 v[20:23], v1 offset:9216
    v_fma_f32 v90, v90, s40, s40
    v_fma_f32 v91, v91, s40, s40
    v_rcp_f32 v84, v84
    v_rcp_f32 v85, v85
    v_xor_b32 v4, 16, v4
    ds_write_b128 v4, v[100:103] offset:0
    v_rcp_f32 v86, v86
    v_rcp_f32 v87, v87
    v_rcp_f32 v88, v88
    v_rcp_f32 v89, v89
    v_rcp_f32 v90, v90
    v_rcp_f32 v91, v91
    v_mul_f32 v84, v136, v84
    v_mul_f32 v85, v137, v85
    v_mul_f32 v86, v138, v86
    v_mul_f32 v87, v139, v87
    v_mul_f32 v88, v140, v88
    v_mul_f32 v89, v141, v89
    v_mul_f32 v90, v142, v90
    v_mul_f32 v91, v143, v91
    v_cvt_pk_bf16_f32 v228, v84, v85
    v_cvt_pk_bf16_f32 v229, v86, v87
    v_cvt_pk_bf16_f32 v230, v88, v89
    v_cvt_pk_bf16_f32 v231, v90, v91
    ds_write_b128 v4, v[228:231] offset:32768
    s_waitcnt lgkmcnt(1)
    s_mov_b64 vcc, -1
    s_branch L_G2
L_B:
    s_lshl_b32 s35, s34, 13
    s_add_u32 s35, s35, 131072
    s_lshl_b32 s39, s32, 6
    v_bfe_u32 v9, v92, 2, 2
    v_lshl_add_u32 v6, v8, 3, v9
    v_lshlrev_b32 v6, 11, v6
    v_lshlrev_b32 v9, 1, v8
    v_xor_b32 v9, v9, v92
    v_and_b32 v9, 3, v9
    v_lshl_add_u32 v6, v9, 4, v6
    v_lshrrev_b32 v4, 2, v92
    v_lshlrev_b32 v4, 6, v4
    v_bfe_u32 v5, v92, 4, 1
    v_lshl_add_u32 v4, v5, 5, v4
    v_and_b32 v5, 3, v92
    v_lshl_add_u32 v4, v5, 3, v4
    v_add_u32 v4, s35, v4
    v_xor_b32 v5, 32, v4
    v_bfe_u32 v9, v92, 1, 3
    v_xor_b32 v9, v9, v8
    v_lshlrev_b32 v0, 4, v9
    v_and_b32 v9, 15, v92
    v_lshl_add_u32 v0, v9, 10, v0
    v_and_b32 v9, 1, v92
    v_lshl_add_u32 v0, v9, 7, v0
    v_xor_b32 v1, 64, v0
    v_xor_b32 v2, 128, v0
    v_xor_b32 v3, 192, v0
    v_lshlrev_b32 v7, 4, v92
    s_mov_b32 s20, s12
    s_mov_b32 s21, s13
    s_mov_b32 s12, s14
    s_mov_b32 s13, s15
    s_mov_b32 s28, s18
    s_mov_b32 s29, s19
    s_mov_b32 s14, 524288
    s_mov_b32 s15, 0x20000
    s_mov_b32 s18, 32768000
    s_mov_b32 s19, 0x20000
    s_mov_b32 s22, 5120
    s_mov_b32 s23, 0x20000
    s_mov_b32 s26, 2097152
    s_mov_b32 s27, 0x20000
    s_mov_b32 s30, 256
    s_mov_b32 s31, 0x20000
    s_mov_b32 s40, 0xbfb8aa3b
    s_mov_b32 s41, 0xbf317218
    s_lshl_b32 s51, s33, 8
    s_add_u32 s51, s51, s2
    s_lshl_b32 s51, s51, 2
    s_add_u32 s51, s51, s34
    s_lshl_b32 s51, s51, 8
    s_mov_b32 s44, 0x10001
    s_mov_b32 s45, 0x10001
    s_mov_b32 s46, 0x80008000
    s_mov_b32 s47, 0x80008000
    s_mov_b32 s48, 0x80018001
    s_mov_b32 s49, 0x80018001
    s_cmp_ge_u32 s2, 125
    s_cselect_b32 s52, 125, 0
    s_sub_u32 s52, s2, s52
    s_cmp_lg_u32 s52, 0
    s_cselect_b32 s97, 64, 1073741824
    s_cmp_lg_u32 s52, 124
    s_mov_b32 s53, 2048
    s_cselect_b32 s3, s53, 1073741824
    s_add_u32 m0, s59, 16384
    s_add_u32 s52, s36, 128
    buffer_load_dwordx4 v96, s[4:7], s52 offen nt lds
    s_add_u32 m0, s59, 20480
    s_add_u32 s52, s36, 32896
    buffer_load_dwordx4 v97, s[4:7], s52 offen nt lds
    s_add_u32 m0, s59, 24576
    s_add_u32 s52, s36, 65664
    buffer_load_dwordx4 v98, s[4:7], s52 offen nt lds
    s_add_u32 m0, s59, 28672
    s_add_u32 s52, s36, 98432
    buffer_load_dwordx4 v99, s[4:7], s52 offen nt lds
    s_lshl_b32 s96, s50, 2
    s_add_u32 s96, s96, s34
    s_mul_i32 s96, s96, 10240
    s_add_u32 s96, s96, 256
    s_waitcnt vmcnt(4)
    s_barrier
    s_buffer_load_dwordx2 s[94:95], s[8:11], s96 offset:60
    s_buffer_load_dwordx2 s[94:95], s[8:11], s96 offset:188
    s_buffer_load_dwordx2 s[94:95], s[8:11], s96 offset:1084
    s_buffer_load_dwordx2 s[94:95], s[8:11], s96 offset:1212
    s_buffer_load_dwordx2 s[94:95], s[8:11], s96 offset:2108
    s_waitcnt vmcnt(0)
    s_barrier
    s_buffer_load_dwordx2 s[94:95], s[8:11], s96 offset:2236
    s_buffer_load_dwordx2 s[94:95], s[8:11], s96 offset:3132
    s_buffer_load_dwordx2 s[94:95], s[8:11], s96 offset:3260
    s_buffer_load_dwordx2 s[94:95], s[8:11], s96 offset:4156
    s_buffer_load_dwordx2 s[94:95], s[8:11], s96 offset:4284
    s_barrier
    s_buffer_load_dwordx2 s[94:95], s[8:11], s96 offset:5180
    s_buffer_load_dwordx2 s[94:95], s[8:11], s96 offset:5308
    s_buffer_load_dwordx2 s[94:95], s[8:11], s96 offset:6204
    s_buffer_load_dwordx2 s[94:95], s[8:11], s96 offset:6332
    s_buffer_load_dwordx2 s[94:95], s[8:11], s96 offset:7228
    s_barrier
    s_buffer_load_dwordx2 s[94:95], s[8:11], s96 offset:7356
    s_buffer_load_dwordx2 s[94:95], s[8:11], s96 offset:8252
    s_buffer_load_dwordx2 s[94:95], s[8:11], s96 offset:8380
    s_buffer_load_dwordx2 s[94:95], s[8:11], s96 offset:9276
    s_buffer_load_dwordx2 s[94:95], s[8:11], s96 offset:9404
    s_barrier
    s_lshl_b32 s54, s50, 2
    s_add_u32 s54, s54, s34
    s_lshl_b32 s54, s54, 7
    s_buffer_load_dwordx2 s[94:95], s[20:23], s54 offset:60
    s_barrier
    s_lshr_b32 s52, s2, 5
    s_lshl_b32 s53, s34, 5
    s_add_u32 s52, s52, s53
    s_and_b32 s53, s2, 31
    s_cmp_eq_u32 s52, s53
    s_cbranch_scc0 L_notrig
    s_mov_b32 s98, 1
    s_atomic_add s98, s[28:29], 224
L_notrig:
    s_barrier
    s_barrier
    s_mov_b64 vcc, 0
    s_waitcnt vmcnt(0) lgkmcnt(0)
    ds_read_b128 v[8:11], v0 offset:0
    ds_read_b128 v[12:15], v1 offset:0
    ds_read_b128 v[16:19], v2 offset:0
    ds_read_b128 v[20:23], v3 offset:0
    s_barrier
    ds_read_b64_tr_b16 v[32:33], v4 offset:0
    ds_read_b64_tr_b16 v[40:41], v5 offset:0
    ds_read_b64_tr_b16 v[48:49], v4 offset:1024
    ds_read_b64_tr_b16 v[56:57], v5 offset:1024
    ds_read_b64_tr_b16 v[34:35], v4 offset:2048
    s_add_u32 m0, s35, 0
    s_add_u32 s38, s39, 131072
    ds_read_b64_tr_b16 v[42:43], v5 offset:2048
    ds_read_b64_tr_b16 v[50:51], v4 offset:3072
    s_waitcnt lgkmcnt(5)
    buffer_load_dwordx4 v6, s[8:11], s38 offen offset:0 lds
    ds_read_b64_tr_b16 v[58:59], v5 offset:3072
    ds_read_b64_tr_b16 v[36:37], v4 offset:4096
    s_waitcnt lgkmcnt(5)
    buffer_load_dwordx4 v6, s[8:11], s38 offen offset:1024 lds
    s_add_u32 s38, s39, 137216
    ds_read_b64_tr_b16 v[44:45], v5 offset:4096
    ds_read_b64_tr_b16 v[52:53], v4 offset:5120
    s_waitcnt lgkmcnt(5)
    buffer_load_dwordx4 v6, s[8:11], s38 offen offset:2048 lds
    ds_read_b64_tr_b16 v[60:61], v5 offset:5120
    ds_read_b64_tr_b16 v[38:39], v4 offset:6144
    s_waitcnt lgkmcnt(5)
    buffer_load_dwordx4 v6, s[8:11], s38 offen offset:3072 lds
    s_add_u32 m0, s35, 4096
    s_add_u32 s38, s39, 196608
    ds_read_b64_tr_b16 v[46:47], v5 offset:6144
    ds_read_b64_tr_b16 v[54:55], v4 offset:7168
    s_waitcnt lgkmcnt(5)
    buffer_load_dwordx4 v6, s[8:11], s38 offen offset:0 lds
    ds_read_b64_tr_b16 v[62:63], v5 offset:7168
    s_waitcnt lgkmcnt(4)
    buffer_load_dwordx4 v6, s[8:11], s38 offen offset:1024 lds
    s_add_u32 s38, s39, 202752
    s_waitcnt lgkmcnt(2)
    buffer_load_dwordx4 v6, s[8:11], s38 offen offset:2048 lds
    s_waitcnt lgkmcnt(0)
    buffer_load_dwordx4 v6, s[8:11], s38 offen offset:3072 lds
    s_setprio 2
    s_waitcnt lgkmcnt(2)
    v_mfma_f32_16x16x32_bf16 v[128:131], v[32:35], v[8:11], 0
    v_mfma_f32_16x16x32_bf16 v[128:131], v[36:39], v[12:15], v[128:131]
    s_waitcnt vmcnt(7)
    ds_read_b64_tr_b16 v[64:65], v4 offset:0
    v_mfma_f32_16x16x32_bf16 v[160:163], v[44:47], v[12:15], 0
    ds_read_b64_tr_b16 v[72:73], v5 offset:0
    v_mfma_f32_16x16x32_bf16 v[160:163], v[40:43], v[8:11], v[160:163]
    ds_read_b128 v[24:27], v0 offset:256
    v_mfma_f32_16x16x32_bf16 v[192:195], v[48:51], v[8:11], 0
    ds_read_b128 v[28:31], v1 offset:256
    v_mfma_f32_16x16x32_bf16 v[192:195], v[52:55], v[12:15], v[192:195]
    s_add_u32 m0, s35, 0
    v_mfma_f32_16x16x32_bf16 v[224:227], v[60:63], v[12:15], 0
    s_add_u32 s38, s39, 262144
    v_mfma_f32_16x16x32_bf16 v[224:227], v[56:59], v[8:11], v[224:227]
    s_waitcnt lgkmcnt(2)
    v_mfma_f32_16x16x32_bf16 v[132:135], v[32:35], v[16:19], 0
    buffer_load_dwordx4 v6, s[8:11], s38 offen offset:0 lds
    v_mfma_f32_16x16x32_bf16 v[132:135], v[36:39], v[20:23], v[132:135]
    s_waitcnt vmcnt(7)
    ds_read_b64_tr_b16 v[80:81], v4 offset:1024
    v_mfma_f32_16x16x32_bf16 v[164:167], v[44:47], v[20:23], 0
    ds_read_b64_tr_b16 v[88:89], v5 offset:1024
    v_mfma_f32_16x16x32_bf16 v[164:167], v[40:43], v[16:19], v[164:167]
    ds_read_b128 v[8:11], v2 offset:256
    v_mfma_f32_16x16x32_bf16 v[196:199], v[48:51], v[16:19], 0
    ds_read_b128 v[12:15], v3 offset:256
    v_mfma_f32_16x16x32_bf16 v[196:199], v[52:55], v[20:23], v[196:199]
    v_mfma_f32_16x16x32_bf16 v[228:231], v[60:63], v[20:23], 0
    v_mfma_f32_16x16x32_bf16 v[228:231], v[56:59], v[16:19], v[228:231]
    s_waitcnt lgkmcnt(2)
    v_mfma_f32_16x16x32_bf16 v[136:139], v[32:35], v[24:27], 0
    buffer_load_dwordx4 v6, s[8:11], s38 offen offset:1024 lds
    v_mfma_f32_16x16x32_bf16 v[136:139], v[36:39], v[28:31], v[136:139]
    s_waitcnt vmcnt(7)
    ds_read_b64_tr_b16 v[66:67], v4 offset:2048
    v_mfma_f32_16x16x32_bf16 v[168:171], v[44:47], v[28:31], 0
    ds_read_b64_tr_b16 v[74:75], v5 offset:2048
    v_mfma_f32_16x16x32_bf16 v[168:171], v[40:43], v[24:27], v[168:171]
    ds_read_b128 v[16:19], v0 offset:512
    v_mfma_f32_16x16x32_bf16 v[200:203], v[48:51], v[24:27], 0
    ds_read_b128 v[20:23], v1 offset:512
    v_mfma_f32_16x16x32_bf16 v[200:203], v[52:55], v[28:31], v[200:203]
    v_mfma_f32_16x16x32_bf16 v[232:235], v[60:63], v[28:31], 0
    s_add_u32 s38, s39, 268288
    v_mfma_f32_16x16x32_bf16 v[232:235], v[56:59], v[24:27], v[232:235]
    s_waitcnt lgkmcnt(2)
    v_mfma_f32_16x16x32_bf16 v[140:143], v[32:35], v[8:11], 0
    buffer_load_dwordx4 v6, s[8:11], s38 offen offset:2048 lds
    v_mfma_f32_16x16x32_bf16 v[140:143], v[36:39], v[12:15], v[140:143]
    s_waitcnt vmcnt(7)
    ds_read_b64_tr_b16 v[82:83], v4 offset:3072
    v_mfma_f32_16x16x32_bf16 v[172:175], v[44:47], v[12:15], 0
    ds_read_b64_tr_b16 v[90:91], v5 offset:3072
    v_mfma_f32_16x16x32_bf16 v[172:175], v[40:43], v[8:11], v[172:175]
    ds_read_b128 v[24:27], v2 offset:512
    v_mfma_f32_16x16x32_bf16 v[204:207], v[48:51], v[8:11], 0
    ds_read_b128 v[28:31], v3 offset:512
    v_mfma_f32_16x16x32_bf16 v[204:207], v[52:55], v[12:15], v[204:207]
    v_mfma_f32_16x16x32_bf16 v[236:239], v[60:63], v[12:15], 0
    v_mfma_f32_16x16x32_bf16 v[236:239], v[56:59], v[8:11], v[236:239]
    s_waitcnt lgkmcnt(2)
    v_mfma_f32_16x16x32_bf16 v[144:147], v[32:35], v[16:19], 0
    buffer_load_dwordx4 v6, s[8:11], s38 offen offset:3072 lds
    v_mfma_f32_16x16x32_bf16 v[144:147], v[36:39], v[20:23], v[144:147]
    s_waitcnt vmcnt(7)
    ds_read_b64_tr_b16 v[68:69], v4 offset:4096
    v_mfma_f32_16x16x32_bf16 v[176:179], v[44:47], v[20:23], 0
    ds_read_b64_tr_b16 v[76:77], v5 offset:4096
    v_mfma_f32_16x16x32_bf16 v[176:179], v[40:43], v[16:19], v[176:179]
    ds_read_b128 v[8:11], v0 offset:768
    v_mfma_f32_16x16x32_bf16 v[208:211], v[48:51], v[16:19], 0
    ds_read_b128 v[12:15], v1 offset:768
    v_mfma_f32_16x16x32_bf16 v[208:211], v[52:55], v[20:23], v[208:211]
    s_add_u32 m0, s35, 4096
    v_mfma_f32_16x16x32_bf16 v[240:243], v[60:63], v[20:23], 0
    s_add_u32 s38, s39, 327680
    v_mfma_f32_16x16x32_bf16 v[240:243], v[56:59], v[16:19], v[240:243]
    s_waitcnt lgkmcnt(2)
    v_mfma_f32_16x16x32_bf16 v[148:151], v[32:35], v[24:27], 0
    buffer_load_dwordx4 v6, s[8:11], s38 offen offset:0 lds
    v_mfma_f32_16x16x32_bf16 v[148:151], v[36:39], v[28:31], v[148:151]
    s_waitcnt vmcnt(7)
    ds_read_b64_tr_b16 v[84:85], v4 offset:5120
    v_mfma_f32_16x16x32_bf16 v[180:183], v[44:47], v[28:31], 0
    ds_read_b64_tr_b16 v[92:93], v5 offset:5120
    v_mfma_f32_16x16x32_bf16 v[180:183], v[40:43], v[24:27], v[180:183]
    ds_read_b128 v[16:19], v2 offset:768
    v_mfma_f32_16x16x32_bf16 v[212:215], v[48:51], v[24:27], 0
    ds_read_b128 v[20:23], v3 offset:768
    v_mfma_f32_16x16x32_bf16 v[212:215], v[52:55], v[28:31], v[212:215]
    v_mfma_f32_16x16x32_bf16 v[244:247], v[60:63], v[28:31], 0
    v_mfma_f32_16x16x32_bf16 v[244:247], v[56:59], v[24:27], v[244:247]
    s_waitcnt lgkmcnt(2)
    v_mfma_f32_16x16x32_bf16 v[152:155], v[32:35], v[8:11], 0
    buffer_load_dwordx4 v6, s[8:11], s38 offen offset:1024 lds
    v_mfma_f32_16x16x32_bf16 v[152:155], v[36:39], v[12:15], v[152:155]
    s_waitcnt vmcnt(7)
    ds_read_b64_tr_b16 v[70:71], v4 offset:6144
    v_mfma_f32_16x16x32_bf16 v[184:187], v[44:47], v[12:15], 0
    ds_read_b64_tr_b16 v[78:79], v5 offset:6144
    v_mfma_f32_16x16x32_bf16 v[184:187], v[40:43], v[8:11], v[184:187]
    ds_read_b128 v[24:27], v0 offset:16384
    v_mfma_f32_16x16x32_bf16 v[216:219], v[48:51], v[8:11], 0
    ds_read_b128 v[28:31], v1 offset:16384
    v_mfma_f32_16x16x32_bf16 v[216:219], v[52:55], v[12:15], v[216:219]
    v_mfma_f32_16x16x32_bf16 v[248:251], v[60:63], v[12:15], 0
    s_add_u32 s38, s39, 333824
    v_mfma_f32_16x16x32_bf16 v[248:251], v[56:59], v[8:11], v[248:251]
    s_waitcnt lgkmcnt(2)
    v_mfma_f32_16x16x32_bf16 v[156:159], v[32:35], v[16:19], 0
    buffer_load_dwordx4 v6, s[8:11], s38 offen offset:2048 lds
    v_mfma_f32_16x16x32_bf16 v[156:159], v[36:39], v[20:23], v[156:159]
    s_waitcnt vmcnt(7)
    ds_read_b64_tr_b16 v[86:87], v4 offset:7168
    v_mfma_f32_16x16x32_bf16 v[188:191], v[44:47], v[20:23], 0
    ds_read_b64_tr_b16 v[94:95], v5 offset:7168
    v_mfma_f32_16x16x32_bf16 v[188:191], v[40:43], v[16:19], v[188:191]
    ds_read_b128 v[8:11], v2 offset:16384
    v_mfma_f32_16x16x32_bf16 v[220:223], v[48:51], v[16:19], 0
    ds_read_b128 v[12:15], v3 offset:16384
    v_mfma_f32_16x16x32_bf16 v[220:223], v[52:55], v[20:23], v[220:223]
    v_mfma_f32_16x16x32_bf16 v[252:255], v[60:63], v[20:23], 0
    v_mfma_f32_16x16x32_bf16 v[252:255], v[56:59], v[16:19], v[252:255]
    s_waitcnt lgkmcnt(2)
    v_mfma_f32_16x16x32_bf16 v[128:131], v[64:67], v[24:27], v[128:131]
    buffer_load_dwordx4 v6, s[8:11], s38 offen offset:3072 lds
    v_mfma_f32_16x16x32_bf16 v[128:131], v[68:71], v[28:31], v[128:131]
    s_waitcnt vmcnt(7)
    ds_read_b64_tr_b16 v[32:33], v4 offset:0
    v_mfma_f32_16x16x32_bf16 v[160:163], v[76:79], v[28:31], v[160:163]
    ds_read_b64_tr_b16 v[40:41], v5 offset:0
    v_mfma_f32_16x16x32_bf16 v[160:163], v[72:75], v[24:27], v[160:163]
    ds_read_b128 v[16:19], v0 offset:16640
    v_mfma_f32_16x16x32_bf16 v[192:195], v[80:83], v[24:27], v[192:195]
    ds_read_b128 v[20:23], v1 offset:16640
    v_mfma_f32_16x16x32_bf16 v[192:195], v[84:87], v[28:31], v[192:195]
    s_add_u32 m0, s35, 0
    v_mfma_f32_16x16x32_bf16 v[224:227], v[92:95], v[28:31], v[224:227]
    s_add_u32 s38, s39, 393216
    v_mfma_f32_16x16x32_bf16 v[224:227], v[88:91], v[24:27], v[224:227]
    s_waitcnt lgkmcnt(2)
    v_mfma_f32_16x16x32_bf16 v[132:135], v[64:67], v[8:11], v[132:135]
    buffer_load_dwordx4 v6, s[8:11], s38 offen offset:0 lds
    v_mfma_f32_16x16x32_bf16 v[132:135], v[68:71], v[12:15], v[132:135]
    s_waitcnt vmcnt(7)
    ds_read_b64_tr_b16 v[48:49], v4 offset:1024
    v_mfma_f32_16x16x32_bf16 v[164:167], v[76:79], v[12:15], v[164:167]
    ds_read_b64_tr_b16 v[56:57], v5 offset:1024
    v_mfma_f32_16x16x32_bf16 v[164:167], v[72:75], v[8:11], v[164:167]
    ds_read_b128 v[24:27], v2 offset:16640
    v_mfma_f32_16x16x32_bf16 v[196:199], v[80:83], v[8:11], v[196:199]
    ds_read_b128 v[28:31], v3 offset:16640
    v_mfma_f32_16x16x32_bf16 v[196:199], v[84:87], v[12:15], v[196:199]
    v_mfma_f32_16x16x32_bf16 v[228:231], v[92:95], v[12:15], v[228:231]
    v_mfma_f32_16x16x32_bf16 v[228:231], v[88:91], v[8:11], v[228:231]
    s_waitcnt lgkmcnt(2)
    v_mfma_f32_16x16x32_bf16 v[136:139], v[64:67], v[16:19], v[136:139]
    buffer_load_dwordx4 v6, s[8:11], s38 offen offset:1024 lds
    v_mfma_f32_16x16x32_bf16 v[136:139], v[68:71], v[20:23], v[136:139]
    s_waitcnt vmcnt(7)
    ds_read_b64_tr_b16 v[34:35], v4 offset:2048
    v_mfma_f32_16x16x32_bf16 v[168:171], v[76:79], v[20:23], v[168:171]
    ds_read_b64_tr_b16 v[42:43], v5 offset:2048
    v_mfma_f32_16x16x32_bf16 v[168:171], v[72:75], v[16:19], v[168:171]
    ds_read_b128 v[8:11], v0 offset:16896
    v_mfma_f32_16x16x32_bf16 v[200:203], v[80:83], v[16:19], v[200:203]
    ds_read_b128 v[12:15], v1 offset:16896
    v_mfma_f32_16x16x32_bf16 v[200:203], v[84:87], v[20:23], v[200:203]
    v_mfma_f32_16x16x32_bf16 v[232:235], v[92:95], v[20:23], v[232:235]
    s_add_u32 s38, s39, 399360
    v_mfma_f32_16x16x32_bf16 v[232:235], v[88:91], v[16:19], v[232:235]
    s_waitcnt lgkmcnt(2)
    v_mfma_f32_16x16x32_bf16 v[140:143], v[64:67], v[24:27], v[140:143]
    buffer_load_dwordx4 v6, s[8:11], s38 offen offset:2048 lds
    v_mfma_f32_16x16x32_bf16 v[140:143], v[68:71], v[28:31], v[140:143]
    s_waitcnt vmcnt(7)
    ds_read_b64_tr_b16 v[50:51], v4 offset:3072
    v_mfma_f32_16x16x32_bf16 v[172:175], v[76:79], v[28:31], v[172:175]
    ds_read_b64_tr_b16 v[58:59], v5 offset:3072
    v_mfma_f32_16x16x32_bf16 v[172:175], v[72:75], v[24:27], v[172:175]
    ds_read_b128 v[16:19], v2 offset:16896
    v_mfma_f32_16x16x32_bf16 v[204:207], v[80:83], v[24:27], v[204:207]
    ds_read_b128 v[20:23], v3 offset:16896
    v_mfma_f32_16x16x32_bf16 v[204:207], v[84:87], v[28:31], v[204:207]
    v_mfma_f32_16x16x32_bf16 v[236:239], v[92:95], v[28:31], v[236:239]
    v_mfma_f32_16x16x32_bf16 v[236:239], v[88:91], v[24:27], v[236:239]
    s_waitcnt lgkmcnt(2)
    v_mfma_f32_16x16x32_bf16 v[144:147], v[64:67], v[8:11], v[144:147]
    buffer_load_dwordx4 v6, s[8:11], s38 offen offset:3072 lds
    v_mfma_f32_16x16x32_bf16 v[144:147], v[68:71], v[12:15], v[144:147]
    s_waitcnt vmcnt(7)
    ds_read_b64_tr_b16 v[36:37], v4 offset:4096
    v_mfma_f32_16x16x32_bf16 v[176:179], v[76:79], v[12:15], v[176:179]
    ds_read_b64_tr_b16 v[44:45], v5 offset:4096
    v_mfma_f32_16x16x32_bf16 v[176:179], v[72:75], v[8:11], v[176:179]
    ds_read_b128 v[24:27], v0 offset:17152
    v_mfma_f32_16x16x32_bf16 v[208:211], v[80:83], v[8:11], v[208:211]
    ds_read_b128 v[28:31], v1 offset:17152
    v_mfma_f32_16x16x32_bf16 v[208:211], v[84:87], v[12:15], v[208:211]
    s_add_u32 m0, s35, 4096
    v_mfma_f32_16x16x32_bf16 v[240:243], v[92:95], v[12:15], v[240:243]
    s_add_u32 s38, s39, 458752
    v_mfma_f32_16x16x32_bf16 v[240:243], v[88:91], v[8:11], v[240:243]
    s_waitcnt lgkmcnt(2)
    v_mfma_f32_16x16x32_bf16 v[148:151], v[64:67], v[16:19], v[148:151]
    buffer_load_dwordx4 v6, s[8:11], s38 offen offset:0 lds
    v_mfma_f32_16x16x32_bf16 v[148:151], v[68:71], v[20:23], v[148:151]
    s_waitcnt vmcnt(7)
    ds_read_b64_tr_b16 v[52:53], v4 offset:5120
    v_mfma_f32_16x16x32_bf16 v[180:183], v[76:79], v[20:23], v[180:183]
    ds_read_b64_tr_b16 v[60:61], v5 offset:5120
    v_mfma_f32_16x16x32_bf16 v[180:183], v[72:75], v[16:19], v[180:183]
    ds_read_b128 v[8:11], v2 offset:17152
    v_mfma_f32_16x16x32_bf16 v[212:215], v[80:83], v[16:19], v[212:215]
    ds_read_b128 v[12:15], v3 offset:17152
    v_mfma_f32_16x16x32_bf16 v[212:215], v[84:87], v[20:23], v[212:215]
    v_mfma_f32_16x16x32_bf16 v[244:247], v[92:95], v[20:23], v[244:247]
    v_mfma_f32_16x16x32_bf16 v[244:247], v[88:91], v[16:19], v[244:247]
    s_waitcnt lgkmcnt(2)
    v_mfma_f32_16x16x32_bf16 v[152:155], v[64:67], v[24:27], v[152:155]
    buffer_load_dwordx4 v6, s[8:11], s38 offen offset:1024 lds
    v_mfma_f32_16x16x32_bf16 v[152:155], v[68:71], v[28:31], v[152:155]
    s_waitcnt vmcnt(7)
    ds_read_b64_tr_b16 v[38:39], v4 offset:6144
    v_mfma_f32_16x16x32_bf16 v[184:187], v[76:79], v[28:31], v[184:187]
    ds_read_b64_tr_b16 v[46:47], v5 offset:6144
    v_mfma_f32_16x16x32_bf16 v[184:187], v[72:75], v[24:27], v[184:187]
    ds_read_b128 v[16:19], v0 offset:32768
    v_mfma_f32_16x16x32_bf16 v[216:219], v[80:83], v[24:27], v[216:219]
    ds_read_b128 v[20:23], v1 offset:32768
    v_mfma_f32_16x16x32_bf16 v[216:219], v[84:87], v[28:31], v[216:219]
    v_mfma_f32_16x16x32_bf16 v[248:251], v[92:95], v[28:31], v[248:251]
    s_add_u32 s38, s39, 464896
    v_mfma_f32_16x16x32_bf16 v[248:251], v[88:91], v[24:27], v[248:251]
    s_waitcnt lgkmcnt(2)
    v_mfma_f32_16x16x32_bf16 v[156:159], v[64:67], v[8:11], v[156:159]
    buffer_load_dwordx4 v6, s[8:11], s38 offen offset:2048 lds
    v_mfma_f32_16x16x32_bf16 v[156:159], v[68:71], v[12:15], v[156:159]
    s_waitcnt vmcnt(7)
    ds_read_b64_tr_b16 v[54:55], v4 offset:7168
    v_mfma_f32_16x16x32_bf16 v[188:191], v[76:79], v[12:15], v[188:191]
    ds_read_b64_tr_b16 v[62:63], v5 offset:7168
    v_mfma_f32_16x16x32_bf16 v[188:191], v[72:75], v[8:11], v[188:191]
    ds_read_b128 v[24:27], v2 offset:32768
    v_mfma_f32_16x16x32_bf16 v[220:223], v[80:83], v[8:11], v[220:223]
    ds_read_b128 v[28:31], v3 offset:32768
    v_mfma_f32_16x16x32_bf16 v[220:223], v[84:87], v[12:15], v[220:223]
    v_mfma_f32_16x16x32_bf16 v[252:255], v[92:95], v[12:15], v[252:255]
    v_mfma_f32_16x16x32_bf16 v[252:255], v[88:91], v[8:11], v[252:255]
    s_waitcnt lgkmcnt(2)
    v_mfma_f32_16x16x32_bf16 v[128:131], v[32:35], v[16:19], v[128:131]
    buffer_load_dwordx4 v6, s[8:11], s38 offen offset:3072 lds
    v_mfma_f32_16x16x32_bf16 v[128:131], v[36:39], v[20:23], v[128:131]
    s_waitcnt vmcnt(7)
    ds_read_b64_tr_b16 v[64:65], v4 offset:0
    v_mfma_f32_16x16x32_bf16 v[160:163], v[44:47], v[20:23], v[160:163]
    ds_read_b64_tr_b16 v[72:73], v5 offset:0
    v_mfma_f32_16x16x32_bf16 v[160:163], v[40:43], v[16:19], v[160:163]
    ds_read_b128 v[8:11], v0 offset:33024
    v_mfma_f32_16x16x32_bf16 v[192:195], v[48:51], v[16:19], v[192:195]
    ds_read_b128 v[12:15], v1 offset:33024
    v_mfma_f32_16x16x32_bf16 v[192:195], v[52:55], v[20:23], v[192:195]
    s_add_u32 m0, s35, 0
    v_mfma_f32_16x16x32_bf16 v[224:227], v[60:63], v[20:23], v[224:227]
    s_add_u32 s38, s39, 524288
    v_mfma_f32_16x16x32_bf16 v[224:227], v[56:59], v[16:19], v[224:227]
    s_waitcnt lgkmcnt(2)
    v_mfma_f32_16x16x32_bf16 v[132:135], v[32:35], v[24:27], v[132:135]
    buffer_load_dwordx4 v6, s[8:11], s38 offen offset:0 lds
    v_mfma_f32_16x16x32_bf16 v[132:135], v[36:39], v[28:31], v[132:135]
    s_waitcnt vmcnt(7)
    ds_read_b64_tr_b16 v[80:81], v4 offset:1024
    v_mfma_f32_16x16x32_bf16 v[164:167], v[44:47], v[28:31], v[164:167]
    ds_read_b64_tr_b16 v[88:89], v5 offset:1024
    v_mfma_f32_16x16x32_bf16 v[164:167], v[40:43], v[24:27], v[164:167]
    ds_read_b128 v[16:19], v2 offset:33024
    v_mfma_f32_16x16x32_bf16 v[196:199], v[48:51], v[24:27], v[196:199]
    ds_read_b128 v[20:23], v3 offset:33024
    v_mfma_f32_16x16x32_bf16 v[196:199], v[52:55], v[28:31], v[196:199]
    v_mfma_f32_16x16x32_bf16 v[228:231], v[60:63], v[28:31], v[228:231]
    v_mfma_f32_16x16x32_bf16 v[228:231], v[56:59], v[24:27], v[228:231]
    s_waitcnt lgkmcnt(2)
    v_mfma_f32_16x16x32_bf16 v[136:139], v[32:35], v[8:11], v[136:139]
    buffer_load_dwordx4 v6, s[8:11], s38 offen offset:1024 lds
    v_mfma_f32_16x16x32_bf16 v[136:139], v[36:39], v[12:15], v[136:139]
    s_waitcnt vmcnt(7)
    ds_read_b64_tr_b16 v[66:67], v4 offset:2048
    v_mfma_f32_16x16x32_bf16 v[168:171], v[44:47], v[12:15], v[168:171]
    ds_read_b64_tr_b16 v[74:75], v5 offset:2048
    v_mfma_f32_16x16x32_bf16 v[168:171], v[40:43], v[8:11], v[168:171]
    ds_read_b128 v[24:27], v0 offset:33280
    v_mfma_f32_16x16x32_bf16 v[200:203], v[48:51], v[8:11], v[200:203]
    ds_read_b128 v[28:31], v1 offset:33280
    v_mfma_f32_16x16x32_bf16 v[200:203], v[52:55], v[12:15], v[200:203]
    v_mfma_f32_16x16x32_bf16 v[232:235], v[60:63], v[12:15], v[232:235]
    s_add_u32 s38, s39, 530432
    v_mfma_f32_16x16x32_bf16 v[232:235], v[56:59], v[8:11], v[232:235]
    s_waitcnt lgkmcnt(2)
    v_mfma_f32_16x16x32_bf16 v[140:143], v[32:35], v[16:19], v[140:143]
    buffer_load_dwordx4 v6, s[8:11], s38 offen offset:2048 lds
    v_mfma_f32_16x16x32_bf16 v[140:143], v[36:39], v[20:23], v[140:143]
    s_waitcnt vmcnt(7)
    ds_read_b64_tr_b16 v[82:83], v4 offset:3072
    v_mfma_f32_16x16x32_bf16 v[172:175], v[44:47], v[20:23], v[172:175]
    ds_read_b64_tr_b16 v[90:91], v5 offset:3072
    v_mfma_f32_16x16x32_bf16 v[172:175], v[40:43], v[16:19], v[172:175]
    ds_read_b128 v[8:11], v2 offset:33280
    v_mfma_f32_16x16x32_bf16 v[204:207], v[48:51], v[16:19], v[204:207]
    ds_read_b128 v[12:15], v3 offset:33280
    v_mfma_f32_16x16x32_bf16 v[204:207], v[52:55], v[20:23], v[204:207]
    v_mfma_f32_16x16x32_bf16 v[236:239], v[60:63], v[20:23], v[236:239]
    v_mfma_f32_16x16x32_bf16 v[236:239], v[56:59], v[16:19], v[236:239]
    s_waitcnt lgkmcnt(2)
    v_mfma_f32_16x16x32_bf16 v[144:147], v[32:35], v[24:27], v[144:147]
    buffer_load_dwordx4 v6, s[8:11], s38 offen offset:3072 lds
    v_mfma_f32_16x16x32_bf16 v[144:147], v[36:39], v[28:31], v[144:147]
    s_waitcnt vmcnt(7)
    ds_read_b64_tr_b16 v[68:69], v4 offset:4096
    v_mfma_f32_16x16x32_bf16 v[176:179], v[44:47], v[28:31], v[176:179]
    ds_read_b64_tr_b16 v[76:77], v5 offset:4096
    v_mfma_f32_16x16x32_bf16 v[176:179], v[40:43], v[24:27], v[176:179]
    ds_read_b128 v[16:19], v0 offset:33536
    v_mfma_f32_16x16x32_bf16 v[208:211], v[48:51], v[24:27], v[208:211]
    ds_read_b128 v[20:23], v1 offset:33536
    v_mfma_f32_16x16x32_bf16 v[208:211], v[52:55], v[28:31], v[208:211]
    s_add_u32 m0, s35, 4096
    v_mfma_f32_16x16x32_bf16 v[240:243], v[60:63], v[28:31], v[240:243]
    s_add_u32 s38, s39, 589824
    v_mfma_f32_16x16x32_bf16 v[240:243], v[56:59], v[24:27], v[240:243]
    s_waitcnt lgkmcnt(2)
    v_mfma_f32_16x16x32_bf16 v[148:151], v[32:35], v[8:11], v[148:151]
    buffer_load_dwordx4 v6, s[8:11], s38 offen offset:0 lds
    v_mfma_f32_16x16x32_bf16 v[148:151], v[36:39], v[12:15], v[148:151]
    s_waitcnt vmcnt(7)
    ds_read_b64_tr_b16 v[84:85], v4 offset:5120
    v_mfma_f32_16x16x32_bf16 v[180:183], v[44:47], v[12:15], v[180:183]
    ds_read_b64_tr_b16 v[92:93], v5 offset:5120
    v_mfma_f32_16x16x32_bf16 v[180:183], v[40:43], v[8:11], v[180:183]
    ds_read_b128 v[24:27], v2 offset:33536
    v_mfma_f32_16x16x32_bf16 v[212:215], v[48:51], v[8:11], v[212:215]
    ds_read_b128 v[28:31], v3 offset:33536
    v_mfma_f32_16x16x32_bf16 v[212:215], v[52:55], v[12:15], v[212:215]
    v_mfma_f32_16x16x32_bf16 v[244:247], v[60:63], v[12:15], v[244:247]
    v_mfma_f32_16x16x32_bf16 v[244:247], v[56:59], v[8:11], v[244:247]
    s_waitcnt lgkmcnt(2)
    v_mfma_f32_16x16x32_bf16 v[152:155], v[32:35], v[16:19], v[152:155]
    buffer_load_dwordx4 v6, s[8:11], s38 offen offset:1024 lds
    v_mfma_f32_16x16x32_bf16 v[152:155], v[36:39], v[20:23], v[152:155]
    s_waitcnt vmcnt(7)
    ds_read_b64_tr_b16 v[70:71], v4 offset:6144
    v_mfma_f32_16x16x32_bf16 v[184:187], v[44:47], v[20:23], v[184:187]
    ds_read_b64_tr_b16 v[78:79], v5 offset:6144
    v_mfma_f32_16x16x32_bf16 v[184:187], v[40:43], v[16:19], v[184:187]
    ds_read_b128 v[8:11], v0 offset:49152
    v_mfma_f32_16x16x32_bf16 v[216:219], v[48:51], v[16:19], v[216:219]
    ds_read_b128 v[12:15], v1 offset:49152
    v_mfma_f32_16x16x32_bf16 v[216:219], v[52:55], v[20:23], v[216:219]
    v_mfma_f32_16x16x32_bf16 v[248:251], v[60:63], v[20:23], v[248:251]
    s_add_u32 s38, s39, 595968
    v_mfma_f32_16x16x32_bf16 v[248:251], v[56:59], v[16:19], v[248:251]
    s_waitcnt lgkmcnt(2)
    v_mfma_f32_16x16x32_bf16 v[156:159], v[32:35], v[24:27], v[156:159]
    buffer_load_dwordx4 v6, s[8:11], s38 offen offset:2048 lds
    v_mfma_f32_16x16x32_bf16 v[156:159], v[36:39], v[28:31], v[156:159]
    s_waitcnt vmcnt(7)
    ds_read_b64_tr_b16 v[86:87], v4 offset:7168
    v_mfma_f32_16x16x32_bf16 v[188:191], v[44:47], v[28:31], v[188:191]
    ds_read_b64_tr_b16 v[94:95], v5 offset:7168
    v_mfma_f32_16x16x32_bf16 v[188:191], v[40:43], v[24:27], v[188:191]
    ds_read_b128 v[16:19], v2 offset:49152
    v_mfma_f32_16x16x32_bf16 v[220:223], v[48:51], v[24:27], v[220:223]
    ds_read_b128 v[20:23], v3 offset:49152
    v_mfma_f32_16x16x32_bf16 v[220:223], v[52:55], v[28:31], v[220:223]
    v_mfma_f32_16x16x32_bf16 v[252:255], v[60:63], v[28:31], v[252:255]
    v_mfma_f32_16x16x32_bf16 v[252:255], v[56:59], v[24:27], v[252:255]
    s_waitcnt lgkmcnt(2)
    v_mfma_f32_16x16x32_bf16 v[128:131], v[64:67], v[8:11], v[128:131]
    buffer_load_dwordx4 v6, s[8:11], s38 offen offset:3072 lds
    v_mfma_f32_16x16x32_bf16 v[128:131], v[68:71], v[12:15], v[128:131]
    s_waitcnt vmcnt(7)
    ds_read_b64_tr_b16 v[32:33], v4 offset:0
    v_mfma_f32_16x16x32_bf16 v[160:163], v[76:79], v[12:15], v[160:163]
    ds_read_b64_tr_b16 v[40:41], v5 offset:0
    v_mfma_f32_16x16x32_bf16 v[160:163], v[72:75], v[8:11], v[160:163]
    ds_read_b128 v[24:27], v0 offset:49408
    v_mfma_f32_16x16x32_bf16 v[192:195], v[80:83], v[8:11], v[192:195]
    ds_read_b128 v[28:31], v1 offset:49408
    v_mfma_f32_16x16x32_bf16 v[192:195], v[84:87], v[12:15], v[192:195]
    s_add_u32 m0, s35, 0
    v_mfma_f32_16x16x32_bf16 v[224:227], v[92:95], v[12:15], v[224:227]
    s_add_u32 s38, s39, 655360
    v_mfma_f32_16x16x32_bf16 v[224:227], v[88:91], v[8:11], v[224:227]
    s_waitcnt lgkmcnt(2)
    v_mfma_f32_16x16x32_bf16 v[132:135], v[64:67], v[16:19], v[132:135]
    buffer_load_dwordx4 v6, s[8:11], s38 offen offset:0 lds
    v_mfma_f32_16x16x32_bf16 v[132:135], v[68:71], v[20:23], v[132:135]
    s_waitcnt vmcnt(7)
    ds_read_b64_tr_b16 v[48:49], v4 offset:1024
    v_mfma_f32_16x16x32_bf16 v[164:167], v[76:79], v[20:23], v[164:167]
    ds_read_b64_tr_b16 v[56:57], v5 offset:1024
    v_mfma_f32_16x16x32_bf16 v[164:167], v[72:75], v[16:19], v[164:167]
    ds_read_b128 v[8:11], v2 offset:49408
    v_mfma_f32_16x16x32_bf16 v[196:199], v[80:83], v[16:19], v[196:199]
    ds_read_b128 v[12:15], v3 offset:49408
    v_mfma_f32_16x16x32_bf16 v[196:199], v[84:87], v[20:23], v[196:199]
    v_mfma_f32_16x16x32_bf16 v[228:231], v[92:95], v[20:23], v[228:231]
    v_mfma_f32_16x16x32_bf16 v[228:231], v[88:91], v[16:19], v[228:231]
    s_waitcnt lgkmcnt(2)
    v_mfma_f32_16x16x32_bf16 v[136:139], v[64:67], v[24:27], v[136:139]
    buffer_load_dwordx4 v6, s[8:11], s38 offen offset:1024 lds
    v_mfma_f32_16x16x32_bf16 v[136:139], v[68:71], v[28:31], v[136:139]
    s_waitcnt vmcnt(7)
    ds_read_b64_tr_b16 v[34:35], v4 offset:2048
    v_mfma_f32_16x16x32_bf16 v[168:171], v[76:79], v[28:31], v[168:171]
    ds_read_b64_tr_b16 v[42:43], v5 offset:2048
    v_mfma_f32_16x16x32_bf16 v[168:171], v[72:75], v[24:27], v[168:171]
    ds_read_b128 v[16:19], v0 offset:49664
    v_mfma_f32_16x16x32_bf16 v[200:203], v[80:83], v[24:27], v[200:203]
    ds_read_b128 v[20:23], v1 offset:49664
    v_mfma_f32_16x16x32_bf16 v[200:203], v[84:87], v[28:31], v[200:203]
    v_mfma_f32_16x16x32_bf16 v[232:235], v[92:95], v[28:31], v[232:235]
    s_add_u32 s38, s39, 661504
    v_mfma_f32_16x16x32_bf16 v[232:235], v[88:91], v[24:27], v[232:235]
    s_waitcnt lgkmcnt(2)
    v_mfma_f32_16x16x32_bf16 v[140:143], v[64:67], v[8:11], v[140:143]
    buffer_load_dwordx4 v6, s[8:11], s38 offen offset:2048 lds
    v_mfma_f32_16x16x32_bf16 v[140:143], v[68:71], v[12:15], v[140:143]
    s_waitcnt vmcnt(7)
    ds_read_b64_tr_b16 v[50:51], v4 offset:3072
    v_mfma_f32_16x16x32_bf16 v[172:175], v[76:79], v[12:15], v[172:175]
    ds_read_b64_tr_b16 v[58:59], v5 offset:3072
    v_mfma_f32_16x16x32_bf16 v[172:175], v[72:75], v[8:11], v[172:175]
    ds_read_b128 v[24:27], v2 offset:49664
    v_mfma_f32_16x16x32_bf16 v[204:207], v[80:83], v[8:11], v[204:207]
    ds_read_b128 v[28:31], v3 offset:49664
    v_mfma_f32_16x16x32_bf16 v[204:207], v[84:87], v[12:15], v[204:207]
    v_mfma_f32_16x16x32_bf16 v[236:239], v[92:95], v[12:15], v[236:239]
    v_mfma_f32_16x16x32_bf16 v[236:239], v[88:91], v[8:11], v[236:239]
    s_waitcnt lgkmcnt(2)
    v_mfma_f32_16x16x32_bf16 v[144:147], v[64:67], v[16:19], v[144:147]
    buffer_load_dwordx4 v6, s[8:11], s38 offen offset:3072 lds
    v_mfma_f32_16x16x32_bf16 v[144:147], v[68:71], v[20:23], v[144:147]
    s_waitcnt vmcnt(7)
    ds_read_b64_tr_b16 v[36:37], v4 offset:4096
    v_mfma_f32_16x16x32_bf16 v[176:179], v[76:79], v[20:23], v[176:179]
    ds_read_b64_tr_b16 v[44:45], v5 offset:4096
    v_mfma_f32_16x16x32_bf16 v[176:179], v[72:75], v[16:19], v[176:179]
    ds_read_b128 v[8:11], v0 offset:49920
    v_mfma_f32_16x16x32_bf16 v[208:211], v[80:83], v[16:19], v[208:211]
    ds_read_b128 v[12:15], v1 offset:49920
    v_mfma_f32_16x16x32_bf16 v[208:211], v[84:87], v[20:23], v[208:211]
    s_add_u32 m0, s35, 4096
    v_mfma_f32_16x16x32_bf16 v[240:243], v[92:95], v[20:23], v[240:243]
    s_add_u32 s38, s39, 720896
    v_mfma_f32_16x16x32_bf16 v[240:243], v[88:91], v[16:19], v[240:243]
    s_waitcnt lgkmcnt(2)
    v_mfma_f32_16x16x32_bf16 v[148:151], v[64:67], v[24:27], v[148:151]
    buffer_load_dwordx4 v6, s[8:11], s38 offen offset:0 lds
    v_mfma_f32_16x16x32_bf16 v[148:151], v[68:71], v[28:31], v[148:151]
    s_waitcnt vmcnt(7)
    ds_read_b64_tr_b16 v[52:53], v4 offset:5120
    v_mfma_f32_16x16x32_bf16 v[180:183], v[76:79], v[28:31], v[180:183]
    ds_read_b64_tr_b16 v[60:61], v5 offset:5120
    v_mfma_f32_16x16x32_bf16 v[180:183], v[72:75], v[24:27], v[180:183]
    ds_read_b128 v[16:19], v2 offset:49920
    v_mfma_f32_16x16x32_bf16 v[212:215], v[80:83], v[24:27], v[212:215]
    ds_read_b128 v[20:23], v3 offset:49920
    v_mfma_f32_16x16x32_bf16 v[212:215], v[84:87], v[28:31], v[212:215]
    v_mfma_f32_16x16x32_bf16 v[244:247], v[92:95], v[28:31], v[244:247]
    v_mfma_f32_16x16x32_bf16 v[244:247], v[88:91], v[24:27], v[244:247]
    s_waitcnt lgkmcnt(2)
    v_mfma_f32_16x16x32_bf16 v[152:155], v[64:67], v[8:11], v[152:155]
    buffer_load_dwordx4 v6, s[8:11], s38 offen offset:1024 lds
    v_mfma_f32_16x16x32_bf16 v[152:155], v[68:71], v[12:15], v[152:155]
    s_waitcnt vmcnt(7)
    ds_read_b64_tr_b16 v[38:39], v4 offset:6144
    v_mfma_f32_16x16x32_bf16 v[184:187], v[76:79], v[12:15], v[184:187]
    ds_read_b64_tr_b16 v[46:47], v5 offset:6144
    v_mfma_f32_16x16x32_bf16 v[184:187], v[72:75], v[8:11], v[184:187]
    v_add_u32 v0, 0x10000, v0
    v_add_u32 v1, 0x10000, v1
    ds_read_b128 v[24:27], v0 offset:0
    v_mfma_f32_16x16x32_bf16 v[216:219], v[80:83], v[8:11], v[216:219]
    ds_read_b128 v[28:31], v1 offset:0
    v_mfma_f32_16x16x32_bf16 v[216:219], v[84:87], v[12:15], v[216:219]
    v_mfma_f32_16x16x32_bf16 v[248:251], v[92:95], v[12:15], v[248:251]
    s_add_u32 s38, s39, 727040
    v_mfma_f32_16x16x32_bf16 v[248:251], v[88:91], v[8:11], v[248:251]
    s_waitcnt lgkmcnt(2)
    v_mfma_f32_16x16x32_bf16 v[156:159], v[64:67], v[16:19], v[156:159]
    buffer_load_dwordx4 v6, s[8:11], s38 offen offset:2048 lds
    v_mfma_f32_16x16x32_bf16 v[156:159], v[68:71], v[20:23], v[156:159]
    s_waitcnt vmcnt(7)
    ds_read_b64_tr_b16 v[54:55], v4 offset:7168
    v_mfma_f32_16x16x32_bf16 v[188:191], v[76:79], v[20:23], v[188:191]
    ds_read_b64_tr_b16 v[62:63], v5 offset:7168
    v_mfma_f32_16x16x32_bf16 v[188:191], v[72:75], v[16:19], v[188:191]
    v_add_u32 v2, 0x10000, v2
    v_add_u32 v3, 0x10000, v3
    ds_read_b128 v[8:11], v2 offset:0
    v_mfma_f32_16x16x32_bf16 v[220:223], v[80:83], v[16:19], v[220:223]
    ds_read_b128 v[12:15], v3 offset:0
    v_mfma_f32_16x16x32_bf16 v[220:223], v[84:87], v[20:23], v[220:223]
    v_mfma_f32_16x16x32_bf16 v[252:255], v[92:95], v[20:23], v[252:255]
    v_mfma_f32_16x16x32_bf16 v[252:255], v[88:91], v[16:19], v[252:255]
    s_waitcnt lgkmcnt(2)
    v_mfma_f32_16x16x32_bf16 v[128:131], v[32:35], v[24:27], v[128:131]
    buffer_load_dwordx4 v6, s[8:11], s38 offen offset:3072 lds
    v_mfma_f32_16x16x32_bf16 v[128:131], v[36:39], v[28:31], v[128:131]
    s_waitcnt vmcnt(7)
    ds_read_b64_tr_b16 v[64:65], v4 offset:0
    v_mfma_f32_16x16x32_bf16 v[160:163], v[44:47], v[28:31], v[160:163]
    ds_read_b64_tr_b16 v[72:73], v5 offset:0
    v_mfma_f32_16x16x32_bf16 v[160:163], v[40:43], v[24:27], v[160:163]
    ds_read_b128 v[16:19], v0 offset:256
    v_mfma_f32_16x16x32_bf16 v[192:195], v[48:51], v[24:27], v[192:195]
    ds_read_b128 v[20:23], v1 offset:256
    v_mfma_f32_16x16x32_bf16 v[192:195], v[52:55], v[28:31], v[192:195]
    s_add_u32 m0, s35, 0
    v_mfma_f32_16x16x32_bf16 v[224:227], v[60:63], v[28:31], v[224:227]
    s_add_u32 s38, s39, 786432
    v_mfma_f32_16x16x32_bf16 v[224:227], v[56:59], v[24:27], v[224:227]
    s_waitcnt lgkmcnt(2)
    v_mfma_f32_16x16x32_bf16 v[132:135], v[32:35], v[8:11], v[132:135]
    buffer_load_dwordx4 v6, s[8:11], s38 offen offset:0 lds
    v_mfma_f32_16x16x32_bf16 v[132:135], v[36:39], v[12:15], v[132:135]
    s_waitcnt vmcnt(7)
    ds_read_b64_tr_b16 v[80:81], v4 offset:1024
    v_mfma_f32_16x16x32_bf16 v[164:167], v[44:47], v[12:15], v[164:167]
    ds_read_b64_tr_b16 v[88:89], v5 offset:1024
    v_mfma_f32_16x16x32_bf16 v[164:167], v[40:43], v[8:11], v[164:167]
    ds_read_b128 v[24:27], v2 offset:256
    v_mfma_f32_16x16x32_bf16 v[196:199], v[48:51], v[8:11], v[196:199]
    ds_read_b128 v[28:31], v3 offset:256
    v_mfma_f32_16x16x32_bf16 v[196:199], v[52:55], v[12:15], v[196:199]
    v_mfma_f32_16x16x32_bf16 v[228:231], v[60:63], v[12:15], v[228:231]
    v_mfma_f32_16x16x32_bf16 v[228:231], v[56:59], v[8:11], v[228:231]
    s_waitcnt lgkmcnt(2)
    v_mfma_f32_16x16x32_bf16 v[136:139], v[32:35], v[16:19], v[136:139]
    buffer_load_dwordx4 v6, s[8:11], s38 offen offset:1024 lds
    v_mfma_f32_16x16x32_bf16 v[136:139], v[36:39], v[20:23], v[136:139]
    s_waitcnt vmcnt(7)
    ds_read_b64_tr_b16 v[66:67], v4 offset:2048
    v_mfma_f32_16x16x32_bf16 v[168:171], v[44:47], v[20:23], v[168:171]
    ds_read_b64_tr_b16 v[74:75], v5 offset:2048
    v_mfma_f32_16x16x32_bf16 v[168:171], v[40:43], v[16:19], v[168:171]
    ds_read_b128 v[8:11], v0 offset:512
    v_mfma_f32_16x16x32_bf16 v[200:203], v[48:51], v[16:19], v[200:203]
    ds_read_b128 v[12:15], v1 offset:512
    v_mfma_f32_16x16x32_bf16 v[200:203], v[52:55], v[20:23], v[200:203]
    v_mfma_f32_16x16x32_bf16 v[232:235], v[60:63], v[20:23], v[232:235]
    s_add_u32 s38, s39, 792576
    v_mfma_f32_16x16x32_bf16 v[232:235], v[56:59], v[16:19], v[232:235]
    s_waitcnt lgkmcnt(2)
    v_mfma_f32_16x16x32_bf16 v[140:143], v[32:35], v[24:27], v[140:143]
    buffer_load_dwordx4 v6, s[8:11], s38 offen offset:2048 lds
    v_mfma_f32_16x16x32_bf16 v[140:143], v[36:39], v[28:31], v[140:143]
    s_waitcnt vmcnt(7)
    ds_read_b64_tr_b16 v[82:83], v4 offset:3072
    v_mfma_f32_16x16x32_bf16 v[172:175], v[44:47], v[28:31], v[172:175]
    ds_read_b64_tr_b16 v[90:91], v5 offset:3072
    v_mfma_f32_16x16x32_bf16 v[172:175], v[40:43], v[24:27], v[172:175]
    ds_read_b128 v[16:19], v2 offset:512
    v_mfma_f32_16x16x32_bf16 v[204:207], v[48:51], v[24:27], v[204:207]
    ds_read_b128 v[20:23], v3 offset:512
    v_mfma_f32_16x16x32_bf16 v[204:207], v[52:55], v[28:31], v[204:207]
    v_mfma_f32_16x16x32_bf16 v[236:239], v[60:63], v[28:31], v[236:239]
    v_mfma_f32_16x16x32_bf16 v[236:239], v[56:59], v[24:27], v[236:239]
    s_waitcnt lgkmcnt(2)
    v_mfma_f32_16x16x32_bf16 v[144:147], v[32:35], v[8:11], v[144:147]
    buffer_load_dwordx4 v6, s[8:11], s38 offen offset:3072 lds
    v_mfma_f32_16x16x32_bf16 v[144:147], v[36:39], v[12:15], v[144:147]
    s_waitcnt vmcnt(7)
    ds_read_b64_tr_b16 v[68:69], v4 offset:4096
    v_mfma_f32_16x16x32_bf16 v[176:179], v[44:47], v[12:15], v[176:179]
    ds_read_b64_tr_b16 v[76:77], v5 offset:4096
    v_mfma_f32_16x16x32_bf16 v[176:179], v[40:43], v[8:11], v[176:179]
    ds_read_b128 v[24:27], v0 offset:768
    v_mfma_f32_16x16x32_bf16 v[208:211], v[48:51], v[8:11], v[208:211]
    ds_read_b128 v[28:31], v1 offset:768
    v_mfma_f32_16x16x32_bf16 v[208:211], v[52:55], v[12:15], v[208:211]
    s_add_u32 m0, s35, 4096
    v_mfma_f32_16x16x32_bf16 v[240:243], v[60:63], v[12:15], v[240:243]
    s_add_u32 s38, s39, 851968
    v_mfma_f32_16x16x32_bf16 v[240:243], v[56:59], v[8:11], v[240:243]
    s_waitcnt lgkmcnt(2)
    v_mfma_f32_16x16x32_bf16 v[148:151], v[32:35], v[16:19], v[148:151]
    buffer_load_dwordx4 v6, s[8:11], s38 offen offset:0 lds
    v_mfma_f32_16x16x32_bf16 v[148:151], v[36:39], v[20:23], v[148:151]
    s_waitcnt vmcnt(7)
    ds_read_b64_tr_b16 v[84:85], v4 offset:5120
    v_mfma_f32_16x16x32_bf16 v[180:183], v[44:47], v[20:23], v[180:183]
    ds_read_b64_tr_b16 v[92:93], v5 offset:5120
    v_mfma_f32_16x16x32_bf16 v[180:183], v[40:43], v[16:19], v[180:183]
    ds_read_b128 v[8:11], v2 offset:768
    v_mfma_f32_16x16x32_bf16 v[212:215], v[48:51], v[16:19], v[212:215]
    ds_read_b128 v[12:15], v3 offset:768
    v_mfma_f32_16x16x32_bf16 v[212:215], v[52:55], v[20:23], v[212:215]
    v_mfma_f32_16x16x32_bf16 v[244:247], v[60:63], v[20:23], v[244:247]
    v_mfma_f32_16x16x32_bf16 v[244:247], v[56:59], v[16:19], v[244:247]
    s_waitcnt lgkmcnt(2)
    v_mfma_f32_16x16x32_bf16 v[152:155], v[32:35], v[24:27], v[152:155]
    buffer_load_dwordx4 v6, s[8:11], s38 offen offset:1024 lds
    v_mfma_f32_16x16x32_bf16 v[152:155], v[36:39], v[28:31], v[152:155]
    s_waitcnt vmcnt(7)
    ds_read_b64_tr_b16 v[70:71], v4 offset:6144
    v_mfma_f32_16x16x32_bf16 v[184:187], v[44:47], v[28:31], v[184:187]
    ds_read_b64_tr_b16 v[78:79], v5 offset:6144
    v_mfma_f32_16x16x32_bf16 v[184:187], v[40:43], v[24:27], v[184:187]
    ds_read_b128 v[16:19], v0 offset:16384
    v_mfma_f32_16x16x32_bf16 v[216:219], v[48:51], v[24:27], v[216:219]
    ds_read_b128 v[20:23], v1 offset:16384
    v_mfma_f32_16x16x32_bf16 v[216:219], v[52:55], v[28:31], v[216:219]
    v_mfma_f32_16x16x32_bf16 v[248:251], v[60:63], v[28:31], v[248:251]
    s_add_u32 s38, s39, 858112
    v_mfma_f32_16x16x32_bf16 v[248:251], v[56:59], v[24:27], v[248:251]
    s_waitcnt lgkmcnt(2)
    v_mfma_f32_16x16x32_bf16 v[156:159], v[32:35], v[8:11], v[156:159]
    buffer_load_dwordx4 v6, s[8:11], s38 offen offset:2048 lds
    v_mfma_f32_16x16x32_bf16 v[156:159], v[36:39], v[12:15], v[156:159]
    s_waitcnt vmcnt(7)
    ds_read_b64_tr_b16 v[86:87], v4 offset:7168
    v_mfma_f32_16x16x32_bf16 v[188:191], v[44:47], v[12:15], v[188:191]
    ds_read_b64_tr_b16 v[94:95], v5 offset:7168
    v_mfma_f32_16x16x32_bf16 v[188:191], v[40:43], v[8:11], v[188:191]
    ds_read_b128 v[24:27], v2 offset:16384
    v_mfma_f32_16x16x32_bf16 v[220:223], v[48:51], v[8:11], v[220:223]
    ds_read_b128 v[28:31], v3 offset:16384
    v_mfma_f32_16x16x32_bf16 v[220:223], v[52:55], v[12:15], v[220:223]
    v_mfma_f32_16x16x32_bf16 v[252:255], v[60:63], v[12:15], v[252:255]
    v_mfma_f32_16x16x32_bf16 v[252:255], v[56:59], v[8:11], v[252:255]
    s_waitcnt lgkmcnt(2)
    v_mfma_f32_16x16x32_bf16 v[128:131], v[64:67], v[16:19], v[128:131]
    buffer_load_dwordx4 v6, s[8:11], s38 offen offset:3072 lds
    v_mfma_f32_16x16x32_bf16 v[128:131], v[68:71], v[20:23], v[128:131]
    s_waitcnt vmcnt(7)
    ds_read_b64_tr_b16 v[32:33], v4 offset:0
    v_mfma_f32_16x16x32_bf16 v[160:163], v[76:79], v[20:23], v[160:163]
    ds_read_b64_tr_b16 v[40:41], v5 offset:0
    v_mfma_f32_16x16x32_bf16 v[160:163], v[72:75], v[16:19], v[160:163]
    ds_read_b128 v[8:11], v0 offset:16640
    v_mfma_f32_16x16x32_bf16 v[192:195], v[80:83], v[16:19], v[192:195]
    ds_read_b128 v[12:15], v1 offset:16640
    v_mfma_f32_16x16x32_bf16 v[192:195], v[84:87], v[20:23], v[192:195]
    s_add_u32 m0, s35, 0
    v_mfma_f32_16x16x32_bf16 v[224:227], v[92:95], v[20:23], v[224:227]
    s_add_u32 s38, s39, 917504
    v_mfma_f32_16x16x32_bf16 v[224:227], v[88:91], v[16:19], v[224:227]
    s_waitcnt lgkmcnt(2)
    v_mfma_f32_16x16x32_bf16 v[132:135], v[64:67], v[24:27], v[132:135]
    buffer_load_dwordx4 v6, s[8:11], s38 offen offset:0 lds
    v_mfma_f32_16x16x32_bf16 v[132:135], v[68:71], v[28:31], v[132:135]
    s_waitcnt vmcnt(7)
    ds_read_b64_tr_b16 v[48:49], v4 offset:1024
    v_mfma_f32_16x16x32_bf16 v[164:167], v[76:79], v[28:31], v[164:167]
    ds_read_b64_tr_b16 v[56:57], v5 offset:1024
    v_mfma_f32_16x16x32_bf16 v[164:167], v[72:75], v[24:27], v[164:167]
    ds_read_b128 v[16:19], v2 offset:16640
    v_mfma_f32_16x16x32_bf16 v[196:199], v[80:83], v[24:27], v[196:199]
    ds_read_b128 v[20:23], v3 offset:16640
    v_mfma_f32_16x16x32_bf16 v[196:199], v[84:87], v[28:31], v[196:199]
    v_mfma_f32_16x16x32_bf16 v[228:231], v[92:95], v[28:31], v[228:231]
    v_mfma_f32_16x16x32_bf16 v[228:231], v[88:91], v[24:27], v[228:231]
    s_waitcnt lgkmcnt(2)
    v_mfma_f32_16x16x32_bf16 v[136:139], v[64:67], v[8:11], v[136:139]
    buffer_load_dwordx4 v6, s[8:11], s38 offen offset:1024 lds
    v_mfma_f32_16x16x32_bf16 v[136:139], v[68:71], v[12:15], v[136:139]
    s_waitcnt vmcnt(7)
    ds_read_b64_tr_b16 v[34:35], v4 offset:2048
    v_mfma_f32_16x16x32_bf16 v[168:171], v[76:79], v[12:15], v[168:171]
    ds_read_b64_tr_b16 v[42:43], v5 offset:2048
    v_mfma_f32_16x16x32_bf16 v[168:171], v[72:75], v[8:11], v[168:171]
    ds_read_b128 v[24:27], v0 offset:16896
    v_mfma_f32_16x16x32_bf16 v[200:203], v[80:83], v[8:11], v[200:203]
    ds_read_b128 v[28:31], v1 offset:16896
    v_mfma_f32_16x16x32_bf16 v[200:203], v[84:87], v[12:15], v[200:203]
    v_mfma_f32_16x16x32_bf16 v[232:235], v[92:95], v[12:15], v[232:235]
    s_add_u32 s38, s39, 923648
    v_mfma_f32_16x16x32_bf16 v[232:235], v[88:91], v[8:11], v[232:235]
    s_waitcnt lgkmcnt(2)
    v_mfma_f32_16x16x32_bf16 v[140:143], v[64:67], v[16:19], v[140:143]
    buffer_load_dwordx4 v6, s[8:11], s38 offen offset:2048 lds
    v_mfma_f32_16x16x32_bf16 v[140:143], v[68:71], v[20:23], v[140:143]
    s_waitcnt vmcnt(7)
    ds_read_b64_tr_b16 v[50:51], v4 offset:3072
    v_mfma_f32_16x16x32_bf16 v[172:175], v[76:79], v[20:23], v[172:175]
    ds_read_b64_tr_b16 v[58:59], v5 offset:3072
    v_mfma_f32_16x16x32_bf16 v[172:175], v[72:75], v[16:19], v[172:175]
    ds_read_b128 v[8:11], v2 offset:16896
    v_mfma_f32_16x16x32_bf16 v[204:207], v[80:83], v[16:19], v[204:207]
    ds_read_b128 v[12:15], v3 offset:16896
    v_mfma_f32_16x16x32_bf16 v[204:207], v[84:87], v[20:23], v[204:207]
    v_mfma_f32_16x16x32_bf16 v[236:239], v[92:95], v[20:23], v[236:239]
    v_mfma_f32_16x16x32_bf16 v[236:239], v[88:91], v[16:19], v[236:239]
    s_waitcnt lgkmcnt(2)
    v_mfma_f32_16x16x32_bf16 v[144:147], v[64:67], v[24:27], v[144:147]
    buffer_load_dwordx4 v6, s[8:11], s38 offen offset:3072 lds
    v_mfma_f32_16x16x32_bf16 v[144:147], v[68:71], v[28:31], v[144:147]
    s_waitcnt vmcnt(7)
    ds_read_b64_tr_b16 v[36:37], v4 offset:4096
    v_mfma_f32_16x16x32_bf16 v[176:179], v[76:79], v[28:31], v[176:179]
    ds_read_b64_tr_b16 v[44:45], v5 offset:4096
    v_mfma_f32_16x16x32_bf16 v[176:179], v[72:75], v[24:27], v[176:179]
    ds_read_b128 v[16:19], v0 offset:17152
    v_mfma_f32_16x16x32_bf16 v[208:211], v[80:83], v[24:27], v[208:211]
    ds_read_b128 v[20:23], v1 offset:17152
    v_mfma_f32_16x16x32_bf16 v[208:211], v[84:87], v[28:31], v[208:211]
    s_add_u32 m0, s35, 4096
    v_mfma_f32_16x16x32_bf16 v[240:243], v[92:95], v[28:31], v[240:243]
    s_add_u32 s38, s39, 983040
    v_mfma_f32_16x16x32_bf16 v[240:243], v[88:91], v[24:27], v[240:243]
    s_waitcnt lgkmcnt(2)
    v_mfma_f32_16x16x32_bf16 v[148:151], v[64:67], v[8:11], v[148:151]
    buffer_load_dwordx4 v6, s[8:11], s38 offen offset:0 lds
    v_mfma_f32_16x16x32_bf16 v[148:151], v[68:71], v[12:15], v[148:151]
    s_waitcnt vmcnt(7)
    ds_read_b64_tr_b16 v[52:53], v4 offset:5120
    v_mfma_f32_16x16x32_bf16 v[180:183], v[76:79], v[12:15], v[180:183]
    ds_read_b64_tr_b16 v[60:61], v5 offset:5120
    v_mfma_f32_16x16x32_bf16 v[180:183], v[72:75], v[8:11], v[180:183]
    ds_read_b128 v[24:27], v2 offset:17152
    v_mfma_f32_16x16x32_bf16 v[212:215], v[80:83], v[8:11], v[212:215]
    ds_read_b128 v[28:31], v3 offset:17152
    v_mfma_f32_16x16x32_bf16 v[212:215], v[84:87], v[12:15], v[212:215]
    v_mfma_f32_16x16x32_bf16 v[244:247], v[92:95], v[12:15], v[244:247]
    v_mfma_f32_16x16x32_bf16 v[244:247], v[88:91], v[8:11], v[244:247]
    s_waitcnt lgkmcnt(2)
    v_mfma_f32_16x16x32_bf16 v[152:155], v[64:67], v[16:19], v[152:155]
    buffer_load_dwordx4 v6, s[8:11], s38 offen offset:1024 lds
    v_mfma_f32_16x16x32_bf16 v[152:155], v[68:71], v[20:23], v[152:155]
    s_waitcnt vmcnt(7)
    ds_read_b64_tr_b16 v[38:39], v4 offset:6144
    v_mfma_f32_16x16x32_bf16 v[184:187], v[76:79], v[20:23], v[184:187]
    ds_read_b64_tr_b16 v[46:47], v5 offset:6144
    v_mfma_f32_16x16x32_bf16 v[184:187], v[72:75], v[16:19], v[184:187]
    ds_read_b128 v[8:11], v0 offset:32768
    v_mfma_f32_16x16x32_bf16 v[216:219], v[80:83], v[16:19], v[216:219]
    ds_read_b128 v[12:15], v1 offset:32768
    v_mfma_f32_16x16x32_bf16 v[216:219], v[84:87], v[20:23], v[216:219]
    v_mfma_f32_16x16x32_bf16 v[248:251], v[92:95], v[20:23], v[248:251]
    s_add_u32 s38, s39, 989184
    v_mfma_f32_16x16x32_bf16 v[248:251], v[88:91], v[16:19], v[248:251]
    s_waitcnt lgkmcnt(2)
    v_mfma_f32_16x16x32_bf16 v[156:159], v[64:67], v[24:27], v[156:159]
    buffer_load_dwordx4 v6, s[8:11], s38 offen offset:2048 lds
    v_mfma_f32_16x16x32_bf16 v[156:159], v[68:71], v[28:31], v[156:159]
    s_waitcnt vmcnt(7)
    ds_read_b64_tr_b16 v[54:55], v4 offset:7168
    v_mfma_f32_16x16x32_bf16 v[188:191], v[76:79], v[28:31], v[188:191]
    ds_read_b64_tr_b16 v[62:63], v5 offset:7168
    v_mfma_f32_16x16x32_bf16 v[188:191], v[72:75], v[24:27], v[188:191]
    ds_read_b128 v[16:19], v2 offset:32768
    v_mfma_f32_16x16x32_bf16 v[220:223], v[80:83], v[24:27], v[220:223]
    ds_read_b128 v[20:23], v3 offset:32768
    v_mfma_f32_16x16x32_bf16 v[220:223], v[84:87], v[28:31], v[220:223]
    v_mfma_f32_16x16x32_bf16 v[252:255], v[92:95], v[28:31], v[252:255]
    v_mfma_f32_16x16x32_bf16 v[252:255], v[88:91], v[24:27], v[252:255]
    s_waitcnt lgkmcnt(2)
    v_mfma_f32_16x16x32_bf16 v[128:131], v[32:35], v[8:11], v[128:131]
    buffer_load_dwordx4 v6, s[8:11], s38 offen offset:3072 lds
    v_mfma_f32_16x16x32_bf16 v[128:131], v[36:39], v[12:15], v[128:131]
    s_waitcnt vmcnt(7)
    ds_read_b64_tr_b16 v[64:65], v4 offset:0
    v_mfma_f32_16x16x32_bf16 v[160:163], v[44:47], v[12:15], v[160:163]
    ds_read_b64_tr_b16 v[72:73], v5 offset:0
    v_mfma_f32_16x16x32_bf16 v[160:163], v[40:43], v[8:11], v[160:163]
    ds_read_b128 v[24:27], v0 offset:33024
    v_mfma_f32_16x16x32_bf16 v[192:195], v[48:51], v[8:11], v[192:195]
    ds_read_b128 v[28:31], v1 offset:33024
    v_mfma_f32_16x16x32_bf16 v[192:195], v[52:55], v[12:15], v[192:195]
    v_mfma_f32_16x16x32_bf16 v[224:227], v[60:63], v[12:15], v[224:227]
    v_mfma_f32_16x16x32_bf16 v[224:227], v[56:59], v[8:11], v[224:227]
    s_waitcnt lgkmcnt(2)
    v_mfma_f32_16x16x32_bf16 v[132:135], v[32:35], v[16:19], v[132:135]
    v_mfma_f32_16x16x32_bf16 v[132:135], v[36:39], v[20:23], v[132:135]
    s_waitcnt vmcnt(6)
    ds_read_b64_tr_b16 v[80:81], v4 offset:1024
    v_mfma_f32_16x16x32_bf16 v[164:167], v[44:47], v[20:23], v[164:167]
    ds_read_b64_tr_b16 v[88:89], v5 offset:1024
    v_mfma_f32_16x16x32_bf16 v[164:167], v[40:43], v[16:19], v[164:167]
    ds_read_b128 v[8:11], v2 offset:33024
    v_mfma_f32_16x16x32_bf16 v[196:199], v[48:51], v[16:19], v[196:199]
    ds_read_b128 v[12:15], v3 offset:33024
    v_mfma_f32_16x16x32_bf16 v[196:199], v[52:55], v[20:23], v[196:199]
    v_mfma_f32_16x16x32_bf16 v[228:231], v[60:63], v[20:23], v[228:231]
    v_mfma_f32_16x16x32_bf16 v[228:231], v[56:59], v[16:19], v[228:231]
    s_waitcnt lgkmcnt(2)
    v_mfma_f32_16x16x32_bf16 v[136:139], v[32:35], v[24:27], v[136:139]
    v_mfma_f32_16x16x32_bf16 v[136:139], v[36:39], v[28:31], v[136:139]
    s_waitcnt vmcnt(5)
    ds_read_b64_tr_b16 v[66:67], v4 offset:2048
    v_mfma_f32_16x16x32_bf16 v[168:171], v[44:47], v[28:31], v[168:171]
    ds_read_b64_tr_b16 v[74:75], v5 offset:2048
    v_mfma_f32_16x16x32_bf16 v[168:171], v[40:43], v[24:27], v[168:171]
    ds_read_b128 v[16:19], v0 offset:33280
    v_mfma_f32_16x16x32_bf16 v[200:203], v[48:51], v[24:27], v[200:203]
    ds_read_b128 v[20:23], v1 offset:33280
    v_mfma_f32_16x16x32_bf16 v[200:203], v[52:55], v[28:31], v[200:203]
    v_mfma_f32_16x16x32_bf16 v[232:235], v[60:63], v[28:31], v[232:235]
    v_mfma_f32_16x16x32_bf16 v[232:235], v[56:59], v[24:27], v[232:235]
    s_waitcnt lgkmcnt(2)
    v_mfma_f32_16x16x32_bf16 v[140:143], v[32:35], v[8:11], v[140:143]
    v_mfma_f32_16x16x32_bf16 v[140:143], v[36:39], v[12:15], v[140:143]
    s_waitcnt vmcnt(4)
    ds_read_b64_tr_b16 v[82:83], v4 offset:3072
    v_mfma_f32_16x16x32_bf16 v[172:175], v[44:47], v[12:15], v[172:175]
    ds_read_b64_tr_b16 v[90:91], v5 offset:3072
    v_mfma_f32_16x16x32_bf16 v[172:175], v[40:43], v[8:11], v[172:175]
    ds_read_b128 v[24:27], v2 offset:33280
    v_mfma_f32_16x16x32_bf16 v[204:207], v[48:51], v[8:11], v[204:207]
    ds_read_b128 v[28:31], v3 offset:33280
    v_mfma_f32_16x16x32_bf16 v[204:207], v[52:55], v[12:15], v[204:207]
    v_mfma_f32_16x16x32_bf16 v[236:239], v[60:63], v[12:15], v[236:239]
    v_mfma_f32_16x16x32_bf16 v[236:239], v[56:59], v[8:11], v[236:239]
    s_waitcnt lgkmcnt(2)
    v_mfma_f32_16x16x32_bf16 v[144:147], v[32:35], v[16:19], v[144:147]
    v_mfma_f32_16x16x32_bf16 v[144:147], v[36:39], v[20:23], v[144:147]
    s_waitcnt vmcnt(3)
    ds_read_b64_tr_b16 v[68:69], v4 offset:4096
    v_mfma_f32_16x16x32_bf16 v[176:179], v[44:47], v[20:23], v[176:179]
    ds_read_b64_tr_b16 v[76:77], v5 offset:4096
    v_mfma_f32_16x16x32_bf16 v[176:179], v[40:43], v[16:19], v[176:179]
    ds_read_b128 v[8:11], v0 offset:33536
    v_mfma_f32_16x16x32_bf16 v[208:211], v[48:51], v[16:19], v[208:211]
    ds_read_b128 v[12:15], v1 offset:33536
    v_mfma_f32_16x16x32_bf16 v[208:211], v[52:55], v[20:23], v[208:211]
    v_mfma_f32_16x16x32_bf16 v[240:243], v[60:63], v[20:23], v[240:243]
    v_mfma_f32_16x16x32_bf16 v[240:243], v[56:59], v[16:19], v[240:243]
    s_waitcnt lgkmcnt(2)
    v_mfma_f32_16x16x32_bf16 v[148:151], v[32:35], v[24:27], v[148:151]
    v_mfma_f32_16x16x32_bf16 v[148:151], v[36:39], v[28:31], v[148:151]
    s_waitcnt vmcnt(2)
    ds_read_b64_tr_b16 v[84:85], v4 offset:5120
    v_mfma_f32_16x16x32_bf16 v[180:183], v[44:47], v[28:31], v[180:183]
    ds_read_b64_tr_b16 v[92:93], v5 offset:5120
    v_mfma_f32_16x16x32_bf16 v[180:183], v[40:43], v[24:27], v[180:183]
    ds_read_b128 v[16:19], v2 offset:33536
    v_mfma_f32_16x16x32_bf16 v[212:215], v[48:51], v[24:27], v[212:215]
    ds_read_b128 v[20:23], v3 offset:33536
    v_mfma_f32_16x16x32_bf16 v[212:215], v[52:55], v[28:31], v[212:215]
    v_mfma_f32_16x16x32_bf16 v[244:247], v[60:63], v[28:31], v[244:247]
    v_mfma_f32_16x16x32_bf16 v[244:247], v[56:59], v[24:27], v[244:247]
    s_waitcnt lgkmcnt(2)
    v_mfma_f32_16x16x32_bf16 v[152:155], v[32:35], v[8:11], v[152:155]
    v_mfma_f32_16x16x32_bf16 v[152:155], v[36:39], v[12:15], v[152:155]
    s_waitcnt vmcnt(1)
    ds_read_b64_tr_b16 v[70:71], v4 offset:6144
    v_mfma_f32_16x16x32_bf16 v[184:187], v[44:47], v[12:15], v[184:187]
    ds_read_b64_tr_b16 v[78:79], v5 offset:6144
    v_mfma_f32_16x16x32_bf16 v[184:187], v[40:43], v[8:11], v[184:187]
    ds_read_b128 v[24:27], v0 offset:49152
    v_mfma_f32_16x16x32_bf16 v[216:219], v[48:51], v[8:11], v[216:219]
    ds_read_b128 v[28:31], v1 offset:49152
    v_mfma_f32_16x16x32_bf16 v[216:219], v[52:55], v[12:15], v[216:219]
    v_mfma_f32_16x16x32_bf16 v[248:251], v[60:63], v[12:15], v[248:251]
    v_mfma_f32_16x16x32_bf16 v[248:251], v[56:59], v[8:11], v[248:251]
    s_waitcnt lgkmcnt(2)
    v_mfma_f32_16x16x32_bf16 v[156:159], v[32:35], v[16:19], v[156:159]
    v_mfma_f32_16x16x32_bf16 v[156:159], v[36:39], v[20:23], v[156:159]
    s_waitcnt vmcnt(0)
    ds_read_b64_tr_b16 v[86:87], v4 offset:7168
    v_mfma_f32_16x16x32_bf16 v[188:191], v[44:47], v[20:23], v[188:191]
    ds_read_b64_tr_b16 v[94:95], v5 offset:7168
    v_mfma_f32_16x16x32_bf16 v[188:191], v[40:43], v[16:19], v[188:191]
    ds_read_b128 v[8:11], v2 offset:49152
    v_mfma_f32_16x16x32_bf16 v[220:223], v[48:51], v[16:19], v[220:223]
    ds_read_b128 v[12:15], v3 offset:49152
    v_mfma_f32_16x16x32_bf16 v[220:223], v[52:55], v[20:23], v[220:223]
    v_mfma_f32_16x16x32_bf16 v[252:255], v[60:63], v[20:23], v[252:255]
    v_mfma_f32_16x16x32_bf16 v[252:255], v[56:59], v[16:19], v[252:255]
    s_waitcnt lgkmcnt(2)
    v_mfma_f32_16x16x32_bf16 v[128:131], v[64:67], v[24:27], v[128:131]
    s_setprio 3
    v_mfma_f32_16x16x32_bf16 v[128:131], v[68:71], v[28:31], v[128:131]
    v_mfma_f32_16x16x32_bf16 v[160:163], v[76:79], v[28:31], v[160:163]
    v_mfma_f32_16x16x32_bf16 v[160:163], v[72:75], v[24:27], v[160:163]
    ds_read_b128 v[16:19], v0 offset:49408
    v_mfma_f32_16x16x32_bf16 v[192:195], v[80:83], v[24:27], v[192:195]
    ds_read_b128 v[20:23], v1 offset:49408
    v_mfma_f32_16x16x32_bf16 v[192:195], v[84:87], v[28:31], v[192:195]
    v_mfma_f32_16x16x32_bf16 v[224:227], v[92:95], v[28:31], v[224:227]
    v_mfma_f32_16x16x32_bf16 v[224:227], v[88:91], v[24:27], v[224:227]
    s_waitcnt lgkmcnt(2)
    v_mfma_f32_16x16x32_bf16 v[132:135], v[64:67], v[8:11], v[132:135]
    v_mfma_f32_16x16x32_bf16 v[132:135], v[68:71], v[12:15], v[132:135]
    v_mfma_f32_16x16x32_bf16 v[164:167], v[76:79], v[12:15], v[164:167]
    v_mfma_f32_16x16x32_bf16 v[164:167], v[72:75], v[8:11], v[164:167]
    ds_read_b128 v[24:27], v2 offset:49408
    v_mfma_f32_16x16x32_bf16 v[196:199], v[80:83], v[8:11], v[196:199]
    ds_read_b128 v[28:31], v3 offset:49408
    v_mfma_f32_16x16x32_bf16 v[196:199], v[84:87], v[12:15], v[196:199]
    v_mfma_f32_16x16x32_bf16 v[228:231], v[92:95], v[12:15], v[228:231]
    v_mfma_f32_16x16x32_bf16 v[228:231], v[88:91], v[8:11], v[228:231]
    s_waitcnt lgkmcnt(2)
    v_mfma_f32_16x16x32_bf16 v[136:139], v[64:67], v[16:19], v[136:139]
    v_mfma_f32_16x16x32_bf16 v[136:139], v[68:71], v[20:23], v[136:139]
    v_mfma_f32_16x16x32_bf16 v[168:171], v[76:79], v[20:23], v[168:171]
    v_mfma_f32_16x16x32_bf16 v[168:171], v[72:75], v[16:19], v[168:171]
    ds_read_b128 v[8:11], v0 offset:49664
    v_mfma_f32_16x16x32_bf16 v[200:203], v[80:83], v[16:19], v[200:203]
    ds_read_b128 v[12:15], v1 offset:49664
    v_mfma_f32_16x16x32_bf16 v[200:203], v[84:87], v[20:23], v[200:203]
    v_mfma_f32_16x16x32_bf16 v[232:235], v[92:95], v[20:23], v[232:235]
    v_mfma_f32_16x16x32_bf16 v[232:235], v[88:91], v[16:19], v[232:235]
    s_waitcnt lgkmcnt(2)
    v_mfma_f32_16x16x32_bf16 v[140:143], v[64:67], v[24:27], v[140:143]
    v_mfma_f32_16x16x32_bf16 v[140:143], v[68:71], v[28:31], v[140:143]
    v_mfma_f32_16x16x32_bf16 v[172:175], v[76:79], v[28:31], v[172:175]
    v_mfma_f32_16x16x32_bf16 v[172:175], v[72:75], v[24:27], v[172:175]
    ds_read_b128 v[16:19], v2 offset:49664
    v_mfma_f32_16x16x32_bf16 v[204:207], v[80:83], v[24:27], v[204:207]
    ds_read_b128 v[20:23], v3 offset:49664
    v_mfma_f32_16x16x32_bf16 v[204:207], v[84:87], v[28:31], v[204:207]
    v_mfma_f32_16x16x32_bf16 v[236:239], v[92:95], v[28:31], v[236:239]
    v_mfma_f32_16x16x32_bf16 v[236:239], v[88:91], v[24:27], v[236:239]
    s_waitcnt lgkmcnt(2)
    v_mfma_f32_16x16x32_bf16 v[144:147], v[64:67], v[8:11], v[144:147]
    v_mfma_f32_16x16x32_bf16 v[144:147], v[68:71], v[12:15], v[144:147]
    v_mfma_f32_16x16x32_bf16 v[176:179], v[76:79], v[12:15], v[176:179]
    v_mfma_f32_16x16x32_bf16 v[176:179], v[72:75], v[8:11], v[176:179]
    ds_read_b128 v[24:27], v0 offset:49920
    v_mfma_f32_16x16x32_bf16 v[208:211], v[80:83], v[8:11], v[208:211]
    ds_read_b128 v[28:31], v1 offset:49920
    v_mfma_f32_16x16x32_bf16 v[208:211], v[84:87], v[12:15], v[208:211]
    v_mfma_f32_16x16x32_bf16 v[240:243], v[92:95], v[12:15], v[240:243]
    v_mfma_f32_16x16x32_bf16 v[240:243], v[88:91], v[8:11], v[240:243]
    s_waitcnt lgkmcnt(2)
    v_mfma_f32_16x16x32_bf16 v[148:151], v[64:67], v[16:19], v[148:151]
    v_mfma_f32_16x16x32_bf16 v[148:151], v[68:71], v[20:23], v[148:151]
    v_mfma_f32_16x16x32_bf16 v[180:183], v[76:79], v[20:23], v[180:183]
    v_mfma_f32_16x16x32_bf16 v[180:183], v[72:75], v[16:19], v[180:183]
    ds_read_b128 v[8:11], v2 offset:49920
    v_mfma_f32_16x16x32_bf16 v[212:215], v[80:83], v[16:19], v[212:215]
    ds_read_b128 v[12:15], v3 offset:49920
    v_mfma_f32_16x16x32_bf16 v[212:215], v[84:87], v[20:23], v[212:215]
    v_mfma_f32_16x16x32_bf16 v[244:247], v[92:95], v[20:23], v[244:247]
    v_mfma_f32_16x16x32_bf16 v[244:247], v[88:91], v[16:19], v[244:247]
    s_waitcnt lgkmcnt(2)
    v_mfma_f32_16x16x32_bf16 v[152:155], v[64:67], v[24:27], v[152:155]
    v_mfma_f32_16x16x32_bf16 v[152:155], v[68:71], v[28:31], v[152:155]
    v_mfma_f32_16x16x32_bf16 v[184:187], v[76:79], v[28:31], v[184:187]
    v_mfma_f32_16x16x32_bf16 v[184:187], v[72:75], v[24:27], v[184:187]
    v_mfma_f32_16x16x32_bf16 v[216:219], v[80:83], v[24:27], v[216:219]
    v_mfma_f32_16x16x32_bf16 v[216:219], v[84:87], v[28:31], v[216:219]
    v_mfma_f32_16x16x32_bf16 v[248:251], v[92:95], v[28:31], v[248:251]
    v_mfma_f32_16x16x32_bf16 v[248:251], v[88:91], v[24:27], v[248:251]
    s_waitcnt lgkmcnt(0)
    v_mfma_f32_16x16x32_bf16 v[156:159], v[64:67], v[8:11], v[156:159]
    v_mfma_f32_16x16x32_bf16 v[156:159], v[68:71], v[12:15], v[156:159]
    v_mfma_f32_16x16x32_bf16 v[188:191], v[76:79], v[12:15], v[188:191]
    v_mfma_f32_16x16x32_bf16 v[188:191], v[72:75], v[8:11], v[188:191]
    v_mfma_f32_16x16x32_bf16 v[220:223], v[80:83], v[8:11], v[220:223]
    v_mfma_f32_16x16x32_bf16 v[220:223], v[84:87], v[12:15], v[220:223]
    v_mfma_f32_16x16x32_bf16 v[252:255], v[92:95], v[12:15], v[252:255]
    v_mfma_f32_16x16x32_bf16 v[252:255], v[88:91], v[8:11], v[252:255]
    s_setprio 0
    s_lshl_b32 s96, s50, 2
    s_add_u32 s96, s96, s34
    s_mul_i32 s96, s96, 2560
    s_min_u32 s96, s96, 259584
    s_add_u32 s96, s96, 1310720
    s_call_b64 s[42:43], L_E1
    s_lshl_b32 s96, s50, 2
    s_add_u32 s96, s96, s34
    s_mul_i32 s96, s96, 2560
    s_min_u32 s96, s96, 259584
    s_add_u32 s96, s96, 1835008
    s_add_u32 s54, s39, 4096
    s_mov_b32 s53, s51
    s_add_u32 s52, s53, 1024
    v_mbcnt_lo_u32_b32 v92, -1, 0
    v_mbcnt_hi_u32_b32 v92, -1, v92
    v_subrev_u32 v4, 0x10000, v4
    v_and_b32 v78, 15, v92
    v_lshlrev_b32 v78, 3, v78
    v_lshrrev_b32 v77, 5, v92
    v_lshl_add_u32 v77, v77, 11, v78
    v_mul_f32 v216, s40, v216
    v_mul_f32 v217, s40, v217
    v_mul_f32 v218, s40, v218
    s_buffer_load_dwordx2 s[94:95], s[24:27], s96 offset:60
    v_mul_f32 v219, s40, v219
    v_mul_f32 v248, s40, v248
    v_mul_f32 v249, s40, v249
    v_mul_f32 v250, s40, v250
    v_mul_f32 v251, s40, v251
    v_exp_f32 v216, v216
    v_exp_f32 v217, v217
    v_exp_f32 v218, v218
    v_exp_f32 v219, v219
    v_exp_f32 v248, v248
    buffer_load_ushort v64, v77, s[20:23], s39 offen offset:0
    v_exp_f32 v249, v249
    v_exp_f32 v250, v250
    v_exp_f32 v251, v251
    s_buffer_load_dwordx2 s[94:95], s[24:27], s96 offset:188
    v_fma_f32 v216, v216, s41, s41
    v_fma_f32 v217, v217, s41, s41
    v_fma_f32 v218, v218, s41, s41
    v_fma_f32 v219, v219, s41, s41
    v_fma_f32 v248, v248, s41, s41
    v_fma_f32 v249, v249, s41, s41
    v_fma_f32 v250, v250, s41, s41
    v_fma_f32 v251, v251, s41, s41
    v_rcp_f32 v216, v216
    v_rcp_f32 v217, v217
    v_rcp_f32 v218, v218
    v_rcp_f32 v219, v219
    v_rcp_f32 v248, v248
    v_rcp_f32 v249, v249
    s_buffer_load_dwordx2 s[94:95], s[24:27], s96 offset:316
    v_rcp_f32 v250, v250
    v_rcp_f32 v251, v251
    v_mul_f32 v216, v152, v216
    v_mul_f32 v217, v153, v217
    v_mul_f32 v218, v154, v218
    buffer_load_ushort v65, v77, s[20:23], s39 offen offset:1024
    v_mul_f32 v219, v155, v219
    v_mul_f32 v248, v184, v248
    v_mul_f32 v249, v185, v249
    v_mul_f32 v250, v186, v250
    v_mul_f32 v251, v187, v251
    v_mul_f32 v196, s40, v196
    v_mul_f32 v197, s40, v197
    v_mul_f32 v198, s40, v198
    v_mul_f32 v199, s40, v199
    v_mul_f32 v228, s40, v228
    v_mul_f32 v229, s40, v229
    v_mul_f32 v230, s40, v230
    s_buffer_load_dwordx2 s[94:95], s[24:27], s96 offset:444
    v_mul_f32 v231, s40, v231
    v_exp_f32 v196, v196
    v_exp_f32 v197, v197
    v_exp_f32 v198, v198
    v_exp_f32 v199, v199
    v_exp_f32 v228, v228
    v_exp_f32 v229, v229
    v_exp_f32 v230, v230
    v_exp_f32 v231, v231
    v_fma_f32 v196, v196, s41, s41
    v_fma_f32 v197, v197, s41, s41
    v_fma_f32 v198, v198, s41, s41
    s_buffer_load_dwordx2 s[94:95], s[24:27], s96 offset:572
    v_fma_f32 v199, v199, s41, s41
    v_fma_f32 v228, v228, s41, s41
    buffer_load_ushort v72, v78, s[20:23], s54 offen offset:0
    v_fma_f32 v229, v229, s41, s41
    v_fma_f32 v230, v230, s41, s41
    v_fma_f32 v231, v231, s41, s41
    v_rcp_f32 v196, v196
    v_rcp_f32 v197, v197
    v_rcp_f32 v198, v198
    v_rcp_f32 v199, v199
    v_rcp_f32 v228, v228
    v_rcp_f32 v229, v229
    v_rcp_f32 v230, v230
    v_rcp_f32 v231, v231
    s_buffer_load_dwordx2 s[94:95], s[24:27], s96 offset:700
    v_mul_f32 v196, v132, v196
    v_mul_f32 v197, v133, v197
    v_mul_f32 v198, v134, v198
    v_mul_f32 v199, v135, v199
    v_mul_f32 v228, v164, v228
    v_mul_f32 v229, v165, v229
    v_mul_f32 v230, v166, v230
    v_mul_f32 v231, v167, v231
    v_cvt_pk_bf16_f32 v154, v196, v197
    v_cvt_pk_bf16_f32 v155, v198, v199
    v_cvt_pk_bf16_f32 v186, v228, v229
    v_cvt_pk_bf16_f32 v187, v230, v231
    v_cvt_pk_bf16_f32 v164, v216, v217
    v_cvt_pk_bf16_f32 v165, v218, v219
    v_cvt_pk_bf16_f32 v196, v248, v249
    buffer_load_ushort v68, v77, s[20:23], s39 offen offset:2
    v_cvt_pk_bf16_f32 v197, v250, v251
    v_mul_f32 v220, s40, v220
    v_mul_f32 v221, s40, v221
    v_mul_f32 v222, s40, v222
    s_buffer_load_dwordx2 s[94:95], s[24:27], s96 offset:828
    v_mul_f32 v223, s40, v223
    v_mul_f32 v252, s40, v252
    v_mul_f32 v253, s40, v253
    v_mul_f32 v254, s40, v254
    v_mul_f32 v255, s40, v255
    v_exp_f32 v220, v220
    v_exp_f32 v221, v221
    v_exp_f32 v222, v222
    v_exp_f32 v223, v223
    v_exp_f32 v252, v252
    v_exp_f32 v253, v253
    v_exp_f32 v254, v254
    v_exp_f32 v255, v255
    s_buffer_load_dwordx2 s[94:95], s[24:27], s96 offset:956
    v_fma_f32 v220, v220, s41, s41
    v_fma_f32 v221, v221, s41, s41
    v_fma_f32 v222, v222, s41, s41
    v_fma_f32 v223, v223, s41, s41
    v_fma_f32 v252, v252, s41, s41
    v_fma_f32 v253, v253, s41, s41
    v_fma_f32 v254, v254, s41, s41
    v_fma_f32 v255, v255, s41, s41
    v_rcp_f32 v220, v220
    buffer_load_ushort v69, v77, s[20:23], s39 offen offset:1026
    v_rcp_f32 v221, v221
    v_rcp_f32 v222, v222
    v_rcp_f32 v223, v223
    v_rcp_f32 v252, v252
    v_rcp_f32 v253, v253
    s_buffer_load_dwordx2 s[94:95], s[24:27], s96 offset:1084
    v_rcp_f32 v254, v254
    v_rcp_f32 v255, v255
    v_mul_f32 v220, v156, v220
    v_mul_f32 v221, v157, v221
    v_mul_f32 v222, v158, v222
    v_mul_f32 v223, v159, v223
    v_mul_f32 v252, v188, v252
    v_mul_f32 v253, v189, v253
    v_mul_f32 v254, v190, v254
    v_mul_f32 v255, v191, v255
    v_cvt_pk_bf16_f32 v166, v220, v221
    v_cvt_pk_bf16_f32 v167, v222, v223
    v_cvt_pk_bf16_f32 v198, v252, v253
    v_cvt_pk_bf16_f32 v199, v254, v255
    v_mul_f32 v192, s40, v192
    v_mul_f32 v193, s40, v193
    v_mul_f32 v194, s40, v194
    s_buffer_load_dwordx2 s[94:95], s[24:27], s96 offset:1212
    v_mul_f32 v195, s40, v195
    v_mul_f32 v224, s40, v224
    v_mul_f32 v225, s40, v225
    v_mul_f32 v226, s40, v226
    buffer_load_ushort v74, v78, s[20:23], s54 offen offset:2
    v_mul_f32 v227, s40, v227
    v_exp_f32 v192, v192
    v_exp_f32 v193, v193
    v_exp_f32 v194, v194
    v_exp_f32 v195, v195
    v_exp_f32 v224, v224
    v_exp_f32 v225, v225
    v_exp_f32 v226, v226
    v_exp_f32 v227, v227
    s_buffer_load_dwordx2 s[94:95], s[24:27], s96 offset:1340
    v_fma_f32 v192, v192, s41, s41
    v_fma_f32 v193, v193, s41, s41
    v_fma_f32 v194, v194, s41, s41
    v_fma_f32 v195, v195, s41, s41
    v_fma_f32 v224, v224, s41, s41
    v_fma_f32 v225, v225, s41, s41
    v_fma_f32 v226, v226, s41, s41
    v_fma_f32 v227, v227, s41, s41
    v_rcp_f32 v192, v192
    v_rcp_f32 v193, v193
    v_rcp_f32 v194, v194
    v_rcp_f32 v195, v195
    v_rcp_f32 v224, v224
    v_rcp_f32 v225, v225
    s_buffer_load_dwordx2 s[94:95], s[24:27], s96 offset:1468
    s_barrier
    v_rcp_f32 v226, v226
    v_rcp_f32 v227, v227
    v_mul_f32 v192, v128, v192
    v_mul_f32 v193, v129, v193
    v_mul_f32 v194, v130, v194
    v_mul_f32 v195, v131, v195
    v_mul_f32 v224, v160, v224
    v_mul_f32 v225, v161, v225
    v_mul_f32 v226, v162, v226
    v_mul_f32 v227, v163, v227
    v_cvt_pk_bf16_f32 v152, v192, v193
    v_cvt_pk_bf16_f32 v153, v194, v195
    v_cvt_pk_bf16_f32 v184, v224, v225
    v_cvt_pk_bf16_f32 v185, v226, v227
    v_cndmask_b32 v84, v164, v152, s[44:45]
    v_cndmask_b32 v85, v165, v153, s[44:45]
    v_cndmask_b32 v86, v166, v154, s[44:45]
    s_buffer_load_dwordx2 s[94:95], s[24:27], s96 offset:1596
    v_cndmask_b32 v87, v167, v155, s[44:45]
    v_cndmask_b32 v88, v196, v184, s[44:45]
    v_cndmask_b32 v89, v197, v185, s[44:45]
    v_cndmask_b32 v90, v198, v186, s[44:45]
    v_cndmask_b32 v91, v199, v187, s[44:45]
    s_mov_b64 exec, s[48:49]
    buffer_store_dwordx4 v[84:87], v5, s[24:27], s52 offen offset:0 sc1
    buffer_store_dwordx4 v[88:91], v5, s[24:27], s52 offen offset:128 sc1
    s_mov_b64 exec, -1
    v_and_b32 v76, 3, v92
    v_mul_u32_u24 v76, 0x5555, v76
    v_lshlrev_b32 v79, 4, v92
    v_mul_f32 v212, s40, v212
    v_mul_f32 v213, s40, v213
    v_mul_f32 v214, s40, v214
    v_mul_f32 v215, s40, v215
    v_mul_f32 v244, s40, v244
    v_mul_f32 v245, s40, v245
    v_mul_f32 v246, s40, v246
    v_mul_f32 v247, s40, v247
    v_exp_f32 v212, v212
    v_exp_f32 v213, v213
    s_buffer_load_dwordx2 s[94:95], s[24:27], s96 offset:1724
    v_exp_f32 v214, v214
    v_exp_f32 v215, v215
    v_exp_f32 v244, v244
    v_exp_f32 v245, v245
    v_exp_f32 v246, v246
    v_exp_f32 v247, v247
    v_fma_f32 v212, v212, s41, s41
    v_fma_f32 v213, v213, s41, s41
    v_fma_f32 v214, v214, s41, s41
    v_fma_f32 v215, v215, s41, s41
    v_fma_f32 v244, v244, s41, s41
    v_fma_f32 v245, v245, s41, s41
    v_fma_f32 v246, v246, s41, s41
    v_fma_f32 v247, v247, s41, s41
    s_buffer_load_dwordx2 s[94:95], s[24:27], s96 offset:1852
    v_rcp_f32 v212, v212
    v_rcp_f32 v213, v213
    v_rcp_f32 v214, v214
    v_rcp_f32 v215, v215
    v_rcp_f32 v244, v244
    v_rcp_f32 v245, v245
    v_rcp_f32 v246, v246
    v_rcp_f32 v247, v247
    v_mul_f32 v212, v148, v212
    v_mul_f32 v213, v149, v213
    v_mul_f32 v214, v150, v214
    v_mul_f32 v215, v151, v215
    s_buffer_load_dwordx2 s[94:95], s[24:27], s96 offset:1980
    v_mul_f32 v244, v180, v244
    v_mul_f32 v245, v181, v245
    v_mul_f32 v246, v182, v246
    v_mul_f32 v247, v183, v247
    v_cvt_pk_bf16_f32 v162, v212, v213
    v_cvt_pk_bf16_f32 v163, v214, v215
    v_cvt_pk_bf16_f32 v194, v244, v245
    v_cvt_pk_bf16_f32 v195, v246, v247
    v_mul_f32 v208, s40, v208
    v_mul_f32 v209, s40, v209
    v_mul_f32 v210, s40, v210
    v_mul_f32 v211, s40, v211
    v_mul_f32 v240, s40, v240
    v_mul_f32 v241, s40, v241
    v_mul_f32 v242, s40, v242
    v_mul_f32 v243, s40, v243
    v_exp_f32 v208, v208
    v_exp_f32 v209, v209
    s_buffer_load_dwordx2 s[94:95], s[24:27], s96 offset:2108
    v_exp_f32 v210, v210
    v_exp_f32 v211, v211
    v_exp_f32 v240, v240
    v_exp_f32 v241, v241
    v_exp_f32 v242, v242
    v_exp_f32 v243, v243
    v_fma_f32 v208, v208, s41, s41
    v_fma_f32 v209, v209, s41, s41
    v_fma_f32 v210, v210, s41, s41
    v_fma_f32 v211, v211, s41, s41
    v_fma_f32 v240, v240, s41, s41
    v_fma_f32 v241, v241, s41, s41
    v_fma_f32 v242, v242, s41, s41
    v_fma_f32 v243, v243, s41, s41
    s_buffer_load_dwordx2 s[94:95], s[24:27], s96 offset:2236
    v_rcp_f32 v208, v208
    v_rcp_f32 v209, v209
    v_rcp_f32 v210, v210
    v_rcp_f32 v211, v211
    v_rcp_f32 v240, v240
    v_rcp_f32 v241, v241
    v_rcp_f32 v242, v242
    v_rcp_f32 v243, v243
    v_mul_f32 v208, v144, v208
    v_mul_f32 v209, v145, v209
    v_mul_f32 v210, v146, v210
    v_mul_f32 v211, v147, v211
    s_buffer_load_dwordx2 s[94:95], s[24:27], s96 offset:2364
    v_mul_f32 v240, v176, v240
    v_mul_f32 v241, v177, v241
    v_mul_f32 v242, v178, v242
    v_mul_f32 v243, v179, v243
    v_cvt_pk_bf16_f32 v160, v208, v209
    v_cvt_pk_bf16_f32 v161, v210, v211
    v_cvt_pk_bf16_f32 v192, v240, v241
    v_cvt_pk_bf16_f32 v193, v242, v243
    s_waitcnt vmcnt(2)
    v_lshlrev_b32 v72, v79, v72
    v_lshlrev_b32 v74, v79, v74
    s_mov_b32 s100, 0xf00000f0
    s_mov_b32 s101, 0xf00000f0
    v_cndmask_b32 v66, 0, v64, s[100:101]
    v_cndmask_b32 v67, 0, v65, s[100:101]
    v_cndmask_b32 v70, 0, v68, s[100:101]
    v_cndmask_b32 v71, 0, v69, s[100:101]
    s_mov_b32 s100, 0xf00000f
    s_mov_b32 s101, 0xf00000f
    v_cndmask_b32 v64, 0, v64, s[100:101]
    v_cndmask_b32 v65, 0, v65, s[100:101]
    v_cndmask_b32 v68, 0, v68, s[100:101]
    v_cndmask_b32 v69, 0, v69, s[100:101]
    s_mov_b32 s100, 0xc0000c
    s_mov_b32 s101, 0xc0000c00
    v_cndmask_b32 v73, 0, v72, s[100:101]
    v_cndmask_b32 v75, 0, v74, s[100:101]
    s_buffer_load_dwordx2 s[94:95], s[24:27], s96 offset:2492
    s_mov_b32 s100, 0x300003
    s_mov_b32 s101, 0x30000300
    v_cndmask_b32 v72, 0, v72, s[100:101]
    v_cndmask_b32 v74, 0, v74, s[100:101]
    v_mul_f32 v204, s40, v204
    v_mul_f32 v205, s40, v205
    v_mul_f32 v206, s40, v206
    v_mul_f32 v207, s40, v207
    v_mul_f32 v236, s40, v236
    v_mul_f32 v237, s40, v237
    v_mul_f32 v238, s40, v238
    v_mul_f32 v239, s40, v239
    v_exp_f32 v204, v204
    v_exp_f32 v205, v205
    v_exp_f32 v206, v206
    v_exp_f32 v207, v207
    v_exp_f32 v236, v236
    v_exp_f32 v237, v237
    v_exp_f32 v238, v238
    v_exp_f32 v239, v239
    v_fma_f32 v204, v204, s41, s41
    v_fma_f32 v205, v205, s41, s41
    v_fma_f32 v206, v206, s41, s41
    v_fma_f32 v207, v207, s41, s41
    v_fma_f32 v236, v236, s41, s41
    v_fma_f32 v237, v237, s41, s41
    v_fma_f32 v238, v238, s41, s41
    v_fma_f32 v239, v239, s41, s41
    v_rcp_f32 v204, v204
    v_rcp_f32 v205, v205
    v_rcp_f32 v206, v206
    v_rcp_f32 v207, v207
    v_rcp_f32 v236, v236
    v_rcp_f32 v237, v237
    v_rcp_f32 v238, v238
    v_rcp_f32 v239, v239
    v_mul_f32 v204, v140, v204
    v_mul_f32 v205, v141, v205
    v_mul_f32 v206, v142, v206
    v_mul_f32 v207, v143, v207
    v_mul_f32 v236, v172, v236
    v_mul_f32 v237, v173, v237
    v_mul_f32 v238, v174, v238
    v_mul_f32 v239, v175, v239
    v_cvt_pk_bf16_f32 v158, v204, v205
    v_cvt_pk_bf16_f32 v159, v206, v207
    v_cvt_pk_bf16_f32 v190, v236, v237
    v_cvt_pk_bf16_f32 v191, v238, v239
    v_mul_f32 v200, s40, v200
    v_mul_f32 v201, s40, v201
    v_mul_f32 v202, s40, v202
    v_mul_f32 v203, s40, v203
    v_mul_f32 v232, s40, v232
    v_mul_f32 v233, s40, v233
    v_mul_f32 v234, s40, v234
    v_mul_f32 v235, s40, v235
    v_exp_f32 v200, v200
    v_exp_f32 v201, v201
    v_exp_f32 v202, v202
    v_exp_f32 v203, v203
    v_exp_f32 v232, v232
    v_exp_f32 v233, v233
    v_exp_f32 v234, v234
    v_exp_f32 v235, v235
    s_setprio 3
    v_mfma_f32_16x16x16_bf16 v[128:131], v[72:73], v[166:167], 0
    v_fma_f32 v200, v200, s41, s41
    v_fma_f32 v201, v201, s41, s41
    v_fma_f32 v202, v202, s41, s41
    v_mfma_f32_16x16x16_bf16 v[132:135], v[74:75], v[198:199], 0
    s_setprio 0
    v_fma_f32 v203, v203, s41, s41
    v_fma_f32 v232, v232, s41, s41
    v_fma_f32 v233, v233, s41, s41
    v_fma_f32 v234, v234, s41, s41
    v_fma_f32 v235, v235, s41, s41
    v_rcp_f32 v200, v200
    v_rcp_f32 v201, v201
    v_rcp_f32 v202, v202
    v_rcp_f32 v203, v203
    v_rcp_f32 v232, v232
    v_rcp_f32 v233, v233
    v_rcp_f32 v234, v234
    v_rcp_f32 v235, v235
    s_setprio 3
    v_smfmac_f32_16x16x64_bf16 v[128:131], v[64:67], v[158:165], v76
    v_mul_f32 v200, v136, v200
    v_smfmac_f32_16x16x64_bf16 v[132:135], v[68:71], v[190:197], v76
    s_setprio 0
    v_mul_f32 v201, v137, v201
    v_mul_f32 v202, v138, v202
    v_mul_f32 v203, v139, v203
    v_mul_f32 v232, v168, v232
    v_mul_f32 v233, v169, v233
    v_mul_f32 v234, v170, v234
    v_mul_f32 v235, v171, v235
    v_cvt_pk_bf16_f32 v156, v200, v201
    v_cvt_pk_bf16_f32 v157, v202, v203
    v_cvt_pk_bf16_f32 v188, v232, v233
    v_cvt_pk_bf16_f32 v189, v234, v235
    v_exp_f32 v84, v128
    v_exp_f32 v85, v129
    v_exp_f32 v86, v130
    v_exp_f32 v87, v131
    v_exp_f32 v88, v132
    v_exp_f32 v89, v133
    v_exp_f32 v90, v134
    v_exp_f32 v91, v135
    s_setprio 3
    v_mfma_f32_16x16x16_bf16 v[136:139], v[72:73], v[164:165], 0
    v_fma_f32 v84, v84, s40, s40
    v_fma_f32 v85, v85, s40, s40
    v_fma_f32 v86, v86, s40, s40
    v_mfma_f32_16x16x16_bf16 v[140:143], v[74:75], v[196:197], 0
    s_setprio 1
    v_fma_f32 v87, v87, s40, s40
    v_fma_f32 v88, v88, s40, s40
    v_fma_f32 v89, v89, s40, s40
    v_fma_f32 v90, v90, s40, s40
    v_fma_f32 v91, v91, s40, s40
    v_rcp_f32 v84, v84
    v_rcp_f32 v85, v85
    v_rcp_f32 v86, v86
    v_rcp_f32 v87, v87
    v_rcp_f32 v88, v88
    v_rcp_f32 v89, v89
    v_rcp_f32 v90, v90
    v_rcp_f32 v91, v91
    s_setprio 3
    v_smfmac_f32_16x16x64_bf16 v[136:139], v[64:67], v[156:163], v76
    v_mul_f32 v84, v128, v84
    v_smfmac_f32_16x16x64_bf16 v[140:143], v[68:71], v[188:195], v76
    s_setprio 1
    v_mul_f32 v85, v129, v85
    v_mul_f32 v86, v130, v86
    v_mul_f32 v87, v131, v87
    v_mul_f32 v88, v132, v88
    v_mul_f32 v89, v133, v89
    v_mul_f32 v90, v134, v90
    v_mul_f32 v91, v135, v91
    s_mov_b64 exec, s[48:49]
    buffer_load_dwordx4 v[148:151], v6, s[24:27], s53 offen offset:0 sc1
    buffer_load_dwordx4 v[180:183], v6, s[24:27], s53 offen offset:128 sc1
    s_mov_b64 exec, -1
    v_cvt_pk_bf16_f32 v116, v84, v85
    v_cvt_pk_bf16_f32 v117, v86, v87
    v_cvt_pk_bf16_f32 v118, v88, v89
    v_cvt_pk_bf16_f32 v119, v90, v91
    v_exp_f32 v84, v136
    v_xor_b32 v4, 64, v4
    ds_write_b128 v4, v[116:119] offset:0
    v_exp_f32 v85, v137
    v_exp_f32 v86, v138
    v_exp_f32 v87, v139
    v_exp_f32 v88, v140
    v_exp_f32 v89, v141
    v_exp_f32 v90, v142
    v_exp_f32 v91, v143
    s_setprio 3
    v_mfma_f32_16x16x16_bf16 v[128:131], v[72:73], v[162:163], 0
    v_fma_f32 v84, v84, s40, s40
    v_fma_f32 v85, v85, s40, s40
    v_fma_f32 v86, v86, s40, s40
    v_mfma_f32_16x16x16_bf16 v[132:135], v[74:75], v[194:195], 0
    s_setprio 1
    v_fma_f32 v87, v87, s40, s40
    v_fma_f32 v88, v88, s40, s40
    v_fma_f32 v89, v89, s40, s40
    v_fma_f32 v90, v90, s40, s40
    v_fma_f32 v91, v91, s40, s40
    v_rcp_f32 v84, v84
    v_rcp_f32 v85, v85
    v_rcp_f32 v86, v86
    v_rcp_f32 v87, v87
    v_rcp_f32 v88, v88
    v_rcp_f32 v89, v89
    v_rcp_f32 v90, v90
    v_rcp_f32 v91, v91
    s_setprio 3
    v_smfmac_f32_16x16x64_bf16 v[128:131], v[64:67], v[154:161], v76
    v_mul_f32 v84, v136, v84
    v_smfmac_f32_16x16x64_bf16 v[132:135], v[68:71], v[186:193], v76
    s_setprio 1
    v_mul_f32 v85, v137, v85
    v_mul_f32 v86, v138, v86
    v_mul_f32 v87, v139, v87
    v_mul_f32 v88, v140, v88
    v_mul_f32 v89, v141, v89
    v_mul_f32 v90, v142, v90
    v_mul_f32 v91, v143, v91
    v_cvt_pk_bf16_f32 v112, v84, v85
    v_cvt_pk_bf16_f32 v113, v86, v87
    v_cvt_pk_bf16_f32 v114, v88, v89
    v_cvt_pk_bf16_f32 v115, v90, v91
    v_exp_f32 v84, v128
    v_xor_b32 v4, 16, v4
    ds_write_b128 v4, v[112:115] offset:0
    v_exp_f32 v85, v129
    v_exp_f32 v86, v130
    v_exp_f32 v87, v131
    v_exp_f32 v88, v132
    v_exp_f32 v89, v133
    v_exp_f32 v90, v134
    v_exp_f32 v91, v135
    s_setprio 3
    v_mfma_f32_16x16x16_bf16 v[136:139], v[72:73], v[160:161], 0
    v_fma_f32 v84, v84, s40, s40
    v_fma_f32 v85, v85, s40, s40
    v_fma_f32 v86, v86, s40, s40
    v_mfma_f32_16x16x16_bf16 v[140:143], v[74:75], v[192:193], 0
    s_setprio 1
    v_fma_f32 v87, v87, s40, s40
    v_fma_f32 v88, v88, s40, s40
    v_fma_f32 v89, v89, s40, s40
    v_fma_f32 v90, v90, s40, s40
    v_fma_f32 v91, v91, s40, s40
    v_rcp_f32 v84, v84
    v_rcp_f32 v85, v85
    v_rcp_f32 v86, v86
    v_rcp_f32 v87, v87
    v_rcp_f32 v88, v88
    v_rcp_f32 v89, v89
    v_rcp_f32 v90, v90
    v_rcp_f32 v91, v91
    s_setprio 3
    v_smfmac_f32_16x16x64_bf16 v[136:139], v[64:67], v[152:159], v76
    v_mul_f32 v84, v128, v84
    v_smfmac_f32_16x16x64_bf16 v[140:143], v[68:71], v[184:191], v76
    s_setprio 1
    v_mul_f32 v85, v129, v85
    v_mul_f32 v86, v130, v86
    v_mul_f32 v87, v131, v87
    v_mul_f32 v88, v132, v88
    v_mul_f32 v89, v133, v89
    v_mul_f32 v90, v134, v90
    v_mul_f32 v91, v135, v91
    v_cvt_pk_bf16_f32 v108, v84, v85
    v_cvt_pk_bf16_f32 v109, v86, v87
    v_cvt_pk_bf16_f32 v110, v88, v89
    v_cvt_pk_bf16_f32 v111, v90, v91
    s_waitcnt vmcnt(0)
    s_mov_b64 exec, s[48:49]
    s_mov_b32 s58, 0x8000
L_pollc:
    v_max3_u32 v82, v148, v149, v150
    v_max3_u32 v83, v180, v181, v182
    v_max3_u32 v82, v82, v151, v183
    v_max_u32 v82, v82, v83
    v_cmp_ne_u32 vcc, -1, v82
    s_nop 1
    s_cmp_eq_u64 vcc, exec
    s_cbranch_scc0 L_repollc
L_polledc:
    s_mov_b64 exec, -1
    s_mov_b64 vcc, s[46:47]
    v_cndmask_b32_dpp v168, v152, v148, vcc row_shl:1 row_mask:0xf bank_mask:0xf bound_ctrl:1
    v_cndmask_b32_dpp v169, v153, v149, vcc row_shl:1 row_mask:0xf bank_mask:0xf bound_ctrl:1
    v_xor_b32 v4, 112, v4
    ds_write_b128 v4, v[108:111] offset:0
    v_cndmask_b32_dpp v170, v154, v150, vcc row_shl:1 row_mask:0xf bank_mask:0xf bound_ctrl:1
    v_cndmask_b32_dpp v171, v155, v151, vcc row_shl:1 row_mask:0xf bank_mask:0xf bound_ctrl:1
    v_cndmask_b32_dpp v200, v184, v180, vcc row_shl:1 row_mask:0xf bank_mask:0xf bound_ctrl:1
    v_cndmask_b32_dpp v201, v185, v181, vcc row_shl:1 row_mask:0xf bank_mask:0xf bound_ctrl:1
    v_cndmask_b32_dpp v202, v186, v182, vcc row_shl:1 row_mask:0xf bank_mask:0xf bound_ctrl:1
    v_cndmask_b32_dpp v203, v187, v183, vcc row_shl:1 row_mask:0xf bank_mask:0xf bound_ctrl:1
    v_mov_b32_dpp v148, v164 row_shr:1 row_mask:0xf bank_mask:0xf
    v_mov_b32_dpp v149, v165 row_shr:1 row_mask:0xf bank_mask:0xf
    v_mov_b32_dpp v150, v166 row_shr:1 row_mask:0xf bank_mask:0xf
    v_mov_b32_dpp v151, v167 row_shr:1 row_mask:0xf bank_mask:0xf
    v_mov_b32_dpp v180, v196 row_shr:1 row_mask:0xf bank_mask:0xf
    v_mov_b32_dpp v181, v197 row_shr:1 row_mask:0xf bank_mask:0xf
    v_mov_b32_dpp v182, v198 row_shr:1 row_mask:0xf bank_mask:0xf
    v_mov_b32_dpp v183, v199 row_shr:1 row_mask:0xf bank_mask:0xf
    v_exp_f32 v84, v136
    v_exp_f32 v85, v137
    v_exp_f32 v86, v138
    v_exp_f32 v87, v139
    v_exp_f32 v88, v140
    v_exp_f32 v89, v141
    v_exp_f32 v90, v142
    v_exp_f32 v91, v143
    s_setprio 3
    v_mfma_f32_16x16x16_bf16 v[128:131], v[72:73], v[168:169], 0
    v_fma_f32 v84, v84, s40, s40
    v_fma_f32 v85, v85, s40, s40
    v_fma_f32 v86, v86, s40, s40
    v_mfma_f32_16x16x16_bf16 v[132:135], v[74:75], v[200:201], 0
    s_setprio 1
    v_fma_f32 v87, v87, s40, s40
    v_fma_f32 v88, v88, s40, s40
    v_fma_f32 v89, v89, s40, s40
    v_fma_f32 v90, v90, s40, s40
    v_fma_f32 v91, v91, s40, s40
    v_rcp_f32 v84, v84
    v_rcp_f32 v85, v85
    v_rcp_f32 v86, v86
    v_rcp_f32 v87, v87
    v_rcp_f32 v88, v88
    v_rcp_f32 v89, v89
    v_rcp_f32 v90, v90
    v_rcp_f32 v91, v91
    s_setprio 3
    v_smfmac_f32_16x16x64_bf16 v[128:131], v[64:67], v[160:167], v76
    v_mul_f32 v84, v136, v84
    v_smfmac_f32_16x16x64_bf16 v[132:135], v[68:71], v[192:199], v76
    s_setprio 1
    v_mul_f32 v85, v137, v85
    v_mul_f32 v86, v138, v86
    v_mul_f32 v87, v139, v87
    v_mul_f32 v88, v140, v88
    v_mul_f32 v89, v141, v89
    v_mul_f32 v90, v142, v90
    v_mul_f32 v91, v143, v91
    v_cvt_pk_bf16_f32 v104, v84, v85
    v_cvt_pk_bf16_f32 v105, v86, v87
    v_cvt_pk_bf16_f32 v106, v88, v89
    v_cvt_pk_bf16_f32 v107, v90, v91
    v_exp_f32 v84, v128
    v_xor_b32 v4, 16, v4
    ds_write_b128 v4, v[104:107] offset:0
    v_exp_f32 v85, v129
    v_exp_f32 v86, v130
    v_exp_f32 v87, v131
    v_exp_f32 v88, v132
    v_exp_f32 v89, v133
    v_exp_f32 v90, v134
    v_exp_f32 v91, v135
    s_setprio 3
    v_mfma_f32_16x16x16_bf16 v[136:139], v[72:73], v[170:171], 0
    v_fma_f32 v84, v84, s40, s40
    v_fma_f32 v85, v85, s40, s40
    v_fma_f32 v86, v86, s40, s40
    v_mfma_f32_16x16x16_bf16 v[140:143], v[74:75], v[202:203], 0
    s_setprio 1
    v_fma_f32 v87, v87, s40, s40
    v_fma_f32 v88, v88, s40, s40
    v_fma_f32 v89, v89, s40, s40
    v_fma_f32 v90, v90, s40, s40
    v_fma_f32 v91, v91, s40, s40
    v_rcp_f32 v84, v84
    v_rcp_f32 v85, v85
    v_rcp_f32 v86, v86
    v_rcp_f32 v87, v87
    v_rcp_f32 v88, v88
    v_rcp_f32 v89, v89
    v_rcp_f32 v90, v90
    v_rcp_f32 v91, v91
    s_setprio 3
    v_smfmac_f32_16x16x64_bf16 v[136:139], v[64:67], v[162:169], v76
    v_mul_f32 v84, v128, v84
    v_smfmac_f32_16x16x64_bf16 v[140:143], v[68:71], v[194:201], v76
    s_setprio 1
    v_mul_f32 v85, v129, v85
    v_mul_f32 v86, v130, v86
    v_mul_f32 v87, v131, v87
    v_mul_f32 v88, v132, v88
    v_mul_f32 v89, v133, v89
    v_mul_f32 v90, v134, v90
    v_mul_f32 v91, v135, v91
    v_cvt_pk_bf16_f32 v120, v84, v85
    v_cvt_pk_bf16_f32 v121, v86, v87
    v_cvt_pk_bf16_f32 v122, v88, v89
    v_cvt_pk_bf16_f32 v123, v90, v91
    v_exp_f32 v84, v136
    v_xor_b32 v4, 64, v4
    ds_write_b128 v4, v[120:123] offset:0
    v_exp_f32 v85, v137
    v_exp_f32 v86, v138
    v_exp_f32 v87, v139
    v_exp_f32 v88, v140
    v_exp_f32 v89, v141
    v_exp_f32 v90, v142
    v_exp_f32 v91, v143
    s_setprio 3
    v_mfma_f32_16x16x16_bf16 v[128:131], v[72:73], v[156:157], 0
    v_fma_f32 v84, v84, s40, s40
    v_fma_f32 v85, v85, s40, s40
    v_fma_f32 v86, v86, s40, s40
    v_mfma_f32_16x16x16_bf16 v[132:135], v[74:75], v[188:189], 0
    s_setprio 1
    v_fma_f32 v87, v87, s40, s40
    v_fma_f32 v88, v88, s40, s40
    v_fma_f32 v89, v89, s40, s40
    v_fma_f32 v90, v90, s40, s40
    v_fma_f32 v91, v91, s40, s40
    v_rcp_f32 v84, v84
    v_rcp_f32 v85, v85
    v_rcp_f32 v86, v86
    v_rcp_f32 v87, v87
    v_rcp_f32 v88, v88
    v_rcp_f32 v89, v89
    v_rcp_f32 v90, v90
    v_rcp_f32 v91, v91
    s_setprio 3
    v_smfmac_f32_16x16x64_bf16 v[128:131], v[64:67], v[148:155], v76
    v_mul_f32 v84, v136, v84
    v_smfmac_f32_16x16x64_bf16 v[132:135], v[68:71], v[180:187], v76
    s_setprio 1
    v_mul_f32 v85, v137, v85
    v_mul_f32 v86, v138, v86
    v_mul_f32 v87, v139, v87
    v_mul_f32 v88, v140, v88
    v_mul_f32 v89, v141, v89
    v_mul_f32 v90, v142, v90
    v_mul_f32 v91, v143, v91
    v_cvt_pk_bf16_f32 v124, v84, v85
    v_cvt_pk_bf16_f32 v125, v86, v87
    v_cvt_pk_bf16_f32 v126, v88, v89
    v_cvt_pk_bf16_f32 v127, v90, v91
    v_exp_f32 v84, v128
    v_xor_b32 v4, 16, v4
    ds_write_b128 v4, v[124:127] offset:0
    v_exp_f32 v85, v129
    v_exp_f32 v86, v130
    v_exp_f32 v87, v131
    v_exp_f32 v88, v132
    v_exp_f32 v89, v133
    v_exp_f32 v90, v134
    v_exp_f32 v91, v135
    s_setprio 3
    v_mfma_f32_16x16x16_bf16 v[136:139], v[72:73], v[158:159], 0
    v_fma_f32 v84, v84, s40, s40
    v_fma_f32 v85, v85, s40, s40
    v_fma_f32 v86, v86, s40, s40
    v_mfma_f32_16x16x16_bf16 v[140:143], v[74:75], v[190:191], 0
    s_setprio 1
    v_fma_f32 v87, v87, s40, s40
    v_fma_f32 v88, v88, s40, s40
    v_fma_f32 v89, v89, s40, s40
    v_fma_f32 v90, v90, s40, s40
    v_fma_f32 v91, v91, s40, s40
    v_rcp_f32 v84, v84
    v_rcp_f32 v85, v85
    v_rcp_f32 v86, v86
    v_rcp_f32 v87, v87
    v_rcp_f32 v88, v88
    v_rcp_f32 v89, v89
    v_rcp_f32 v90, v90
    v_rcp_f32 v91, v91
    s_setprio 3
    v_smfmac_f32_16x16x64_bf16 v[136:139], v[64:67], v[150:157], v76
    v_mul_f32 v84, v128, v84
    v_smfmac_f32_16x16x64_bf16 v[140:143], v[68:71], v[182:189], v76
    s_setprio 1
    v_mul_f32 v85, v129, v85
    v_mul_f32 v86, v130, v86
    v_mul_f32 v87, v131, v87
    v_mul_f32 v88, v132, v88
    v_mul_f32 v89, v133, v89
    v_mul_f32 v90, v134, v90
    v_mul_f32 v91, v135, v91
    v_cvt_pk_bf16_f32 v96, v84, v85
    v_cvt_pk_bf16_f32 v97, v86, v87
    v_cvt_pk_bf16_f32 v98, v88, v89
    v_cvt_pk_bf16_f32 v99, v90, v91
    v_exp_f32 v84, v136
    v_xor_b32 v4, 112, v4
    ds_write_b128 v4, v[96:99] offset:0
    v_exp_f32 v85, v137
    v_exp_f32 v86, v138
    v_exp_f32 v87, v139
    v_exp_f32 v88, v140
    v_exp_f32 v89, v141
    v_exp_f32 v90, v142
    v_exp_f32 v91, v143
    v_fma_f32 v84, v84, s40, s40
    v_fma_f32 v85, v85, s40, s40
    v_fma_f32 v86, v86, s40, s40
    v_fma_f32 v87, v87, s40, s40
    v_fma_f32 v88, v88, s40, s40
    v_fma_f32 v89, v89, s40, s40
    v_fma_f32 v90, v90, s40, s40
    v_fma_f32 v91, v91, s40, s40
    v_rcp_f32 v84, v84
    v_rcp_f32 v85, v85
    v_rcp_f32 v86, v86
    v_rcp_f32 v87, v87
    v_rcp_f32 v88, v88
    v_rcp_f32 v89, v89
    v_rcp_f32 v90, v90
    v_rcp_f32 v91, v91
    v_mul_f32 v84, v136, v84
    v_mul_f32 v85, v137, v85
    v_mul_f32 v86, v138, v86
    v_mul_f32 v87, v139, v87
    v_mul_f32 v88, v140, v88
    v_mul_f32 v89, v141, v89
    v_mul_f32 v90, v142, v90
    v_mul_f32 v91, v143, v91
    v_cvt_pk_bf16_f32 v100, v84, v85
    v_cvt_pk_bf16_f32 v101, v86, v87
    v_cvt_pk_bf16_f32 v102, v88, v89
    v_cvt_pk_bf16_f32 v103, v90, v91
    v_xor_b32 v4, 16, v4
    ds_write_b128 v4, v[100:103] offset:0
    s_waitcnt lgkmcnt(0)
    s_barrier
    s_setprio 0
    s_lshl_b32 s38, s32, 16
    s_add_u32 s38, s38, 1572864
    buffer_load_dwordx4 v[32:35], v7, s[24:27], s38 offen offset:0 sc1
    buffer_load_dwordx4 v[36:39], v7, s[24:27], s38 offen offset:1024 sc1
    buffer_load_dwordx4 v[40:43], v7, s[24:27], s38 offen offset:2048 sc1
    buffer_load_dwordx4 v[44:47], v7, s[24:27], s38 offen offset:3072 sc1
    s_add_u32 s38, s38, 4096
    buffer_load_dwordx4 v[48:51], v7, s[24:27], s38 offen offset:0 sc1
    buffer_load_dwordx4 v[52:55], v7, s[24:27], s38 offen offset:1024 sc1
    buffer_load_dwordx4 v[56:59], v7, s[24:27], s38 offen offset:2048 sc1
    buffer_load_dwordx4 v[60:63], v7, s[24:27], s38 offen offset:3072 sc1
    s_add_u32 s38, s38, 4096
    s_mov_b32 s100, 131072
    v_bfe_u32 v0, v92, 2, 2
    v_and_or_b32 v0, v92, 48, v0
    v_and_b32 v1, 3, v92
    v_lshl_add_u32 v0, v1, 2, v0
    v_bfe_u32 v1, v92, 1, 1
    v_xor_b32 v0, v1, v0
    v_lshl_add_u32 v0, v0, 4, s100
    v_xor_b32 v1, 32, v0
    v_xor_b32 v2, 64, v0
    v_xor_b32 v3, 96, v0
    v_and_b32 v6, 15, v92
    v_lshlrev_b32 v6, 3, v6
    v_lshrrev_b32 v4, 4, v92
    v_lshl_add_u32 v6, v4, 10, v6
    s_lshl_b32 s52, s32, 7
    s_add_u32 s52, s52, s37
    s_sub_u32 s53, s35, 32768
    v_add_u32 v5, s53, v7
    s_mov_b64 vcc, 0
    ds_read_b128 v[8:11], v0 offset:0
    ds_read_b128 v[12:15], v0 offset:8192
    ds_read_b128 v[16:19], v1 offset:1024
    ds_read_b128 v[20:23], v1 offset:9216
L_G2:
    s_setprio 1
    s_waitcnt vmcnt(0)
    s_waitcnt lgkmcnt(2)
    v_mfma_f32_16x16x32_bf16 v[128:131], v[8:11], v[32:35], 0
    buffer_load_dwordx4 v[96:99], v7, s[24:27], s38 offen offset:0 sc1
    v_mfma_f32_16x16x32_bf16 v[128:131], v[12:15], v[36:39], v[128:131]
    ds_read_b128 v[24:27], v2 offset:2048
    v_mfma_f32_16x16x32_bf16 v[132:135], v[12:15], v[44:47], 0
    ds_read_b128 v[28:31], v2 offset:10240
    v_mfma_f32_16x16x32_bf16 v[132:135], v[8:11], v[40:43], v[132:135]
    v_mfma_f32_16x16x32_bf16 v[136:139], v[8:11], v[48:51], 0
    buffer_load_dwordx4 v[100:103], v7, s[24:27], s38 offen offset:1024 sc1
    v_mfma_f32_16x16x32_bf16 v[136:139], v[12:15], v[52:55], v[136:139]
    v_mfma_f32_16x16x32_bf16 v[140:143], v[12:15], v[60:63], 0
    v_mfma_f32_16x16x32_bf16 v[140:143], v[8:11], v[56:59], v[140:143]
    s_waitcnt lgkmcnt(2)
    v_mfma_f32_16x16x32_bf16 v[144:147], v[16:19], v[32:35], 0
    buffer_load_dwordx4 v[104:107], v7, s[24:27], s38 offen offset:2048 sc1
    v_mfma_f32_16x16x32_bf16 v[144:147], v[20:23], v[36:39], v[144:147]
    ds_read_b128 v[8:11], v3 offset:3072
    v_mfma_f32_16x16x32_bf16 v[148:151], v[20:23], v[44:47], 0
    ds_read_b128 v[12:15], v3 offset:11264
    v_mfma_f32_16x16x32_bf16 v[148:151], v[16:19], v[40:43], v[148:151]
    v_mfma_f32_16x16x32_bf16 v[152:155], v[16:19], v[48:51], 0
    buffer_load_dwordx4 v[108:111], v7, s[24:27], s38 offen offset:3072 sc1
    s_add_u32 s38, s38, 4096
    v_mfma_f32_16x16x32_bf16 v[152:155], v[20:23], v[52:55], v[152:155]
    v_mfma_f32_16x16x32_bf16 v[156:159], v[20:23], v[60:63], 0
    v_mfma_f32_16x16x32_bf16 v[156:159], v[16:19], v[56:59], v[156:159]
    s_waitcnt lgkmcnt(2)
    v_mfma_f32_16x16x32_bf16 v[160:163], v[24:27], v[32:35], 0
    buffer_load_dwordx4 v[112:115], v7, s[24:27], s38 offen offset:0 sc1
    v_mfma_f32_16x16x32_bf16 v[160:163], v[28:31], v[36:39], v[160:163]
    ds_read_b128 v[16:19], v0 offset:4096
    v_mfma_f32_16x16x32_bf16 v[164:167], v[28:31], v[44:47], 0
    ds_read_b128 v[20:23], v0 offset:12288
    v_mfma_f32_16x16x32_bf16 v[164:167], v[24:27], v[40:43], v[164:167]
    v_mfma_f32_16x16x32_bf16 v[168:171], v[24:27], v[48:51], 0
    buffer_load_dwordx4 v[116:119], v7, s[24:27], s38 offen offset:1024 sc1
    v_mfma_f32_16x16x32_bf16 v[168:171], v[28:31], v[52:55], v[168:171]
    v_mfma_f32_16x16x32_bf16 v[172:175], v[28:31], v[60:63], 0
    v_mfma_f32_16x16x32_bf16 v[172:175], v[24:27], v[56:59], v[172:175]
    s_waitcnt lgkmcnt(2)
    v_mfma_f32_16x16x32_bf16 v[176:179], v[8:11], v[32:35], 0
    buffer_load_dwordx4 v[120:123], v7, s[24:27], s38 offen offset:2048 sc1
    v_mfma_f32_16x16x32_bf16 v[176:179], v[12:15], v[36:39], v[176:179]
    ds_read_b128 v[24:27], v1 offset:5120
    v_mfma_f32_16x16x32_bf16 v[180:183], v[12:15], v[44:47], 0
    ds_read_b128 v[28:31], v1 offset:13312
    v_mfma_f32_16x16x32_bf16 v[180:183], v[8:11], v[40:43], v[180:183]
    v_mfma_f32_16x16x32_bf16 v[184:187], v[8:11], v[48:51], 0
    buffer_load_dwordx4 v[124:127], v7, s[24:27], s38 offen offset:3072 sc1
    s_add_u32 s38, s38, 4096
    v_mfma_f32_16x16x32_bf16 v[184:187], v[12:15], v[52:55], v[184:187]
    v_mfma_f32_16x16x32_bf16 v[188:191], v[12:15], v[60:63], 0
    v_mfma_f32_16x16x32_bf16 v[188:191], v[8:11], v[56:59], v[188:191]
    s_waitcnt lgkmcnt(2)
    v_mfma_f32_16x16x32_bf16 v[192:195], v[16:19], v[32:35], 0
    buffer_load_dwordx4 v[64:67], v7, s[24:27], s38 offen offset:0 sc1
    v_mfma_f32_16x16x32_bf16 v[192:195], v[20:23], v[36:39], v[192:195]
    ds_read_b128 v[8:11], v2 offset:6144
    v_mfma_f32_16x16x32_bf16 v[196:199], v[20:23], v[44:47], 0
    ds_read_b128 v[12:15], v2 offset:14336
    v_mfma_f32_16x16x32_bf16 v[196:199], v[16:19], v[40:43], v[196:199]
    v_mfma_f32_16x16x32_bf16 v[200:203], v[16:19], v[48:51], 0
    buffer_load_dwordx4 v[68:71], v7, s[24:27], s38 offen offset:1024 sc1
    v_mfma_f32_16x16x32_bf16 v[200:203], v[20:23], v[52:55], v[200:203]
    v_mfma_f32_16x16x32_bf16 v[204:207], v[20:23], v[60:63], 0
    v_mfma_f32_16x16x32_bf16 v[204:207], v[16:19], v[56:59], v[204:207]
    s_waitcnt lgkmcnt(2)
    v_mfma_f32_16x16x32_bf16 v[208:211], v[24:27], v[32:35], 0
    buffer_load_dwordx4 v[72:75], v7, s[24:27], s38 offen offset:2048 sc1
    v_mfma_f32_16x16x32_bf16 v[208:211], v[28:31], v[36:39], v[208:211]
    ds_read_b128 v[16:19], v3 offset:7168
    v_mfma_f32_16x16x32_bf16 v[212:215], v[28:31], v[44:47], 0
    ds_read_b128 v[20:23], v3 offset:15360
    v_mfma_f32_16x16x32_bf16 v[212:215], v[24:27], v[40:43], v[212:215]
    v_mfma_f32_16x16x32_bf16 v[216:219], v[24:27], v[48:51], 0
    buffer_load_dwordx4 v[76:79], v7, s[24:27], s38 offen offset:3072 sc1
    s_add_u32 s38, s38, 4096
    v_mfma_f32_16x16x32_bf16 v[216:219], v[28:31], v[52:55], v[216:219]
    v_mfma_f32_16x16x32_bf16 v[220:223], v[28:31], v[60:63], 0
    v_mfma_f32_16x16x32_bf16 v[220:223], v[24:27], v[56:59], v[220:223]
    s_waitcnt lgkmcnt(2)
    v_mfma_f32_16x16x32_bf16 v[224:227], v[8:11], v[32:35], 0
    buffer_load_dwordx4 v[80:83], v7, s[24:27], s38 offen offset:0 sc1
    v_mfma_f32_16x16x32_bf16 v[224:227], v[12:15], v[36:39], v[224:227]
    ds_read_b128 v[24:27], v0 offset:16384
    v_mfma_f32_16x16x32_bf16 v[228:231], v[12:15], v[44:47], 0
    ds_read_b128 v[28:31], v0 offset:24576
    v_mfma_f32_16x16x32_bf16 v[228:231], v[8:11], v[40:43], v[228:231]
    v_mfma_f32_16x16x32_bf16 v[232:235], v[8:11], v[48:51], 0
    buffer_load_dwordx4 v[84:87], v7, s[24:27], s38 offen offset:1024 sc1
    v_mfma_f32_16x16x32_bf16 v[232:235], v[12:15], v[52:55], v[232:235]
    v_mfma_f32_16x16x32_bf16 v[236:239], v[12:15], v[60:63], 0
    v_mfma_f32_16x16x32_bf16 v[236:239], v[8:11], v[56:59], v[236:239]
    s_waitcnt lgkmcnt(2)
    v_mfma_f32_16x16x32_bf16 v[240:243], v[16:19], v[32:35], 0
    buffer_load_dwordx4 v[88:91], v7, s[24:27], s38 offen offset:2048 sc1
    v_mfma_f32_16x16x32_bf16 v[240:243], v[20:23], v[36:39], v[240:243]
    ds_read_b128 v[8:11], v1 offset:17408
    v_mfma_f32_16x16x32_bf16 v[244:247], v[20:23], v[44:47], 0
    ds_read_b128 v[12:15], v1 offset:25600
    v_mfma_f32_16x16x32_bf16 v[244:247], v[16:19], v[40:43], v[244:247]
    v_mfma_f32_16x16x32_bf16 v[248:251], v[16:19], v[48:51], 0
    buffer_load_dwordx4 v[92:95], v7, s[24:27], s38 offen offset:3072 sc1
    s_add_u32 s38, s38, 4096
    v_mfma_f32_16x16x32_bf16 v[248:251], v[20:23], v[52:55], v[248:251]
    v_mfma_f32_16x16x32_bf16 v[252:255], v[20:23], v[60:63], 0
    v_mfma_f32_16x16x32_bf16 v[252:255], v[16:19], v[56:59], v[252:255]
    s_waitcnt vmcnt(8)
    s_waitcnt lgkmcnt(2)
    v_mfma_f32_16x16x32_bf16 v[128:131], v[24:27], v[96:99], v[128:131]
    buffer_load_dwordx4 v[32:35], v7, s[24:27], s38 offen offset:0 sc1
    v_mfma_f32_16x16x32_bf16 v[128:131], v[28:31], v[100:103], v[128:131]
    s_setprio 2
    ds_read_b128 v[16:19], v2 offset:18432
    v_mfma_f32_16x16x32_bf16 v[132:135], v[28:31], v[108:111], v[132:135]
    ds_read_b128 v[20:23], v2 offset:26624
    v_mfma_f32_16x16x32_bf16 v[132:135], v[24:27], v[104:107], v[132:135]
    v_mfma_f32_16x16x32_bf16 v[136:139], v[24:27], v[112:115], v[136:139]
    v_mfma_f32_16x16x32_bf16 v[136:139], v[28:31], v[116:119], v[136:139]
    v_mfma_f32_16x16x32_bf16 v[140:143], v[28:31], v[124:127], v[140:143]
    v_mfma_f32_16x16x32_bf16 v[140:143], v[24:27], v[120:123], v[140:143]
    s_waitcnt lgkmcnt(2)
    v_mfma_f32_16x16x32_bf16 v[144:147], v[8:11], v[96:99], v[144:147]
    buffer_load_dwordx4 v[36:39], v7, s[24:27], s38 offen offset:1024 sc1
    v_mfma_f32_16x16x32_bf16 v[144:147], v[12:15], v[100:103], v[144:147]
    ds_read_b128 v[24:27], v3 offset:19456
    v_mfma_f32_16x16x32_bf16 v[148:151], v[12:15], v[108:111], v[148:151]
    ds_read_b128 v[28:31], v3 offset:27648
    v_mfma_f32_16x16x32_bf16 v[148:151], v[8:11], v[104:107], v[148:151]
    v_mfma_f32_16x16x32_bf16 v[152:155], v[8:11], v[112:115], v[152:155]
    v_mfma_f32_16x16x32_bf16 v[152:155], v[12:15], v[116:119], v[152:155]
    v_mfma_f32_16x16x32_bf16 v[156:159], v[12:15], v[124:127], v[156:159]
    v_mfma_f32_16x16x32_bf16 v[156:159], v[8:11], v[120:123], v[156:159]
    s_waitcnt lgkmcnt(2)
    v_mfma_f32_16x16x32_bf16 v[160:163], v[16:19], v[96:99], v[160:163]
    buffer_load_dwordx4 v[40:43], v7, s[24:27], s38 offen offset:2048 sc1
    v_mfma_f32_16x16x32_bf16 v[160:163], v[20:23], v[100:103], v[160:163]
    ds_read_b128 v[8:11], v0 offset:20480
    v_mfma_f32_16x16x32_bf16 v[164:167], v[20:23], v[108:111], v[164:167]
    ds_read_b128 v[12:15], v0 offset:28672
    v_mfma_f32_16x16x32_bf16 v[164:167], v[16:19], v[104:107], v[164:167]
    v_mfma_f32_16x16x32_bf16 v[168:171], v[16:19], v[112:115], v[168:171]
    v_mfma_f32_16x16x32_bf16 v[168:171], v[20:23], v[116:119], v[168:171]
    v_mfma_f32_16x16x32_bf16 v[172:175], v[20:23], v[124:127], v[172:175]
    v_mfma_f32_16x16x32_bf16 v[172:175], v[16:19], v[120:123], v[172:175]
    s_waitcnt lgkmcnt(2)
    v_mfma_f32_16x16x32_bf16 v[176:179], v[24:27], v[96:99], v[176:179]
    buffer_load_dwordx4 v[44:47], v7, s[24:27], s38 offen offset:3072 sc1
    s_add_u32 s38, s38, 4096
    v_mfma_f32_16x16x32_bf16 v[176:179], v[28:31], v[100:103], v[176:179]
    ds_read_b128 v[16:19], v1 offset:21504
    v_mfma_f32_16x16x32_bf16 v[180:183], v[28:31], v[108:111], v[180:183]
    ds_read_b128 v[20:23], v1 offset:29696
    v_mfma_f32_16x16x32_bf16 v[180:183], v[24:27], v[104:107], v[180:183]
    v_mfma_f32_16x16x32_bf16 v[184:187], v[24:27], v[112:115], v[184:187]
    v_mfma_f32_16x16x32_bf16 v[184:187], v[28:31], v[116:119], v[184:187]
    v_mfma_f32_16x16x32_bf16 v[188:191], v[28:31], v[124:127], v[188:191]
    v_mfma_f32_16x16x32_bf16 v[188:191], v[24:27], v[120:123], v[188:191]
    s_waitcnt lgkmcnt(2)
    v_mfma_f32_16x16x32_bf16 v[192:195], v[8:11], v[96:99], v[192:195]
    buffer_load_dwordx4 v[48:51], v7, s[24:27], s38 offen offset:0 sc1
    v_mfma_f32_16x16x32_bf16 v[192:195], v[12:15], v[100:103], v[192:195]
    s_cbranch_vccnz L_bar_s1
L_barret_s1:
    ds_read_b128 v[24:27], v2 offset:22528
    v_mfma_f32_16x16x32_bf16 v[196:199], v[12:15], v[108:111], v[196:199]
    ds_read_b128 v[28:31], v2 offset:30720
    v_mfma_f32_16x16x32_bf16 v[196:199], v[8:11], v[104:107], v[196:199]
    v_mfma_f32_16x16x32_bf16 v[200:203], v[8:11], v[112:115], v[200:203]
    v_mfma_f32_16x16x32_bf16 v[200:203], v[12:15], v[116:119], v[200:203]
    v_mfma_f32_16x16x32_bf16 v[204:207], v[12:15], v[124:127], v[204:207]
    v_mfma_f32_16x16x32_bf16 v[204:207], v[8:11], v[120:123], v[204:207]
    s_waitcnt lgkmcnt(2)
    v_mfma_f32_16x16x32_bf16 v[208:211], v[16:19], v[96:99], v[208:211]
    buffer_load_dwordx4 v[52:55], v7, s[24:27], s38 offen offset:1024 sc1
    v_mfma_f32_16x16x32_bf16 v[208:211], v[20:23], v[100:103], v[208:211]
    ds_read_b128 v[8:11], v3 offset:23552
    v_mfma_f32_16x16x32_bf16 v[212:215], v[20:23], v[108:111], v[212:215]
    ds_read_b128 v[12:15], v3 offset:31744
    v_mfma_f32_16x16x32_bf16 v[212:215], v[16:19], v[104:107], v[212:215]
    v_mfma_f32_16x16x32_bf16 v[216:219], v[16:19], v[112:115], v[216:219]
    v_mfma_f32_16x16x32_bf16 v[216:219], v[20:23], v[116:119], v[216:219]
    v_mfma_f32_16x16x32_bf16 v[220:223], v[20:23], v[124:127], v[220:223]
    v_mfma_f32_16x16x32_bf16 v[220:223], v[16:19], v[120:123], v[220:223]
    s_waitcnt lgkmcnt(2)
    v_mfma_f32_16x16x32_bf16 v[224:227], v[24:27], v[96:99], v[224:227]
    buffer_load_dwordx4 v[56:59], v7, s[24:27], s38 offen offset:2048 sc1
    v_mfma_f32_16x16x32_bf16 v[224:227], v[28:31], v[100:103], v[224:227]
    v_subrev_u32 v0, 0x20000, v0
    v_subrev_u32 v1, 0x20000, v1
    ds_read_b128 v[16:19], v0 offset:0
    v_mfma_f32_16x16x32_bf16 v[228:231], v[28:31], v[108:111], v[228:231]
    ds_read_b128 v[20:23], v0 offset:8192
    v_mfma_f32_16x16x32_bf16 v[228:231], v[24:27], v[104:107], v[228:231]
    v_mfma_f32_16x16x32_bf16 v[232:235], v[24:27], v[112:115], v[232:235]
    v_mfma_f32_16x16x32_bf16 v[232:235], v[28:31], v[116:119], v[232:235]
    v_mfma_f32_16x16x32_bf16 v[236:239], v[28:31], v[124:127], v[236:239]
    v_mfma_f32_16x16x32_bf16 v[236:239], v[24:27], v[120:123], v[236:239]
    s_waitcnt lgkmcnt(2)
    v_mfma_f32_16x16x32_bf16 v[240:243], v[8:11], v[96:99], v[240:243]
    buffer_load_dwordx4 v[60:63], v7, s[24:27], s38 offen offset:3072 sc1
    s_add_u32 s38, s38, 4096
    v_mfma_f32_16x16x32_bf16 v[240:243], v[12:15], v[100:103], v[240:243]
    v_subrev_u32 v2, 0x20000, v2
    v_subrev_u32 v3, 0x20000, v3
    ds_read_b128 v[24:27], v1 offset:1024
    v_mfma_f32_16x16x32_bf16 v[244:247], v[12:15], v[108:111], v[244:247]
    ds_read_b128 v[28:31], v1 offset:9216
    v_mfma_f32_16x16x32_bf16 v[244:247], v[8:11], v[104:107], v[244:247]
    v_mfma_f32_16x16x32_bf16 v[248:251], v[8:11], v[112:115], v[248:251]
    v_mfma_f32_16x16x32_bf16 v[248:251], v[12:15], v[116:119], v[248:251]
    v_mfma_f32_16x16x32_bf16 v[252:255], v[12:15], v[124:127], v[252:255]
    v_mfma_f32_16x16x32_bf16 v[252:255], v[8:11], v[120:123], v[252:255]
    s_waitcnt vmcnt(8)
    s_waitcnt lgkmcnt(2)
    v_mfma_f32_16x16x32_bf16 v[128:131], v[16:19], v[64:67], v[128:131]
    buffer_load_dwordx4 v[96:99], v7, s[24:27], s38 offen offset:0 sc1
    v_mfma_f32_16x16x32_bf16 v[128:131], v[20:23], v[68:71], v[128:131]
    ds_read_b128 v[8:11], v2 offset:2048
    v_mfma_f32_16x16x32_bf16 v[132:135], v[20:23], v[76:79], v[132:135]
    ds_read_b128 v[12:15], v2 offset:10240
    v_mfma_f32_16x16x32_bf16 v[132:135], v[16:19], v[72:75], v[132:135]
    v_mfma_f32_16x16x32_bf16 v[136:139], v[16:19], v[80:83], v[136:139]
    v_mfma_f32_16x16x32_bf16 v[136:139], v[20:23], v[84:87], v[136:139]
    v_mfma_f32_16x16x32_bf16 v[140:143], v[20:23], v[92:95], v[140:143]
    v_mfma_f32_16x16x32_bf16 v[140:143], v[16:19], v[88:91], v[140:143]
    s_waitcnt lgkmcnt(2)
    v_mfma_f32_16x16x32_bf16 v[144:147], v[24:27], v[64:67], v[144:147]
    buffer_load_dwordx4 v[100:103], v7, s[24:27], s38 offen offset:1024 sc1
    v_mfma_f32_16x16x32_bf16 v[144:147], v[28:31], v[68:71], v[144:147]
    ds_read_b128 v[16:19], v3 offset:3072
    v_mfma_f32_16x16x32_bf16 v[148:151], v[28:31], v[76:79], v[148:151]
    ds_read_b128 v[20:23], v3 offset:11264
    v_mfma_f32_16x16x32_bf16 v[148:151], v[24:27], v[72:75], v[148:151]
    v_mfma_f32_16x16x32_bf16 v[152:155], v[24:27], v[80:83], v[152:155]
    v_mfma_f32_16x16x32_bf16 v[152:155], v[28:31], v[84:87], v[152:155]
    v_mfma_f32_16x16x32_bf16 v[156:159], v[28:31], v[92:95], v[156:159]
    v_mfma_f32_16x16x32_bf16 v[156:159], v[24:27], v[88:91], v[156:159]
    s_waitcnt lgkmcnt(2)
    v_mfma_f32_16x16x32_bf16 v[160:163], v[8:11], v[64:67], v[160:163]
    buffer_load_dwordx4 v[104:107], v7, s[24:27], s38 offen offset:2048 sc1
    v_mfma_f32_16x16x32_bf16 v[160:163], v[12:15], v[68:71], v[160:163]
    ds_read_b128 v[24:27], v0 offset:4096
    v_mfma_f32_16x16x32_bf16 v[164:167], v[12:15], v[76:79], v[164:167]
    ds_read_b128 v[28:31], v0 offset:12288
    v_mfma_f32_16x16x32_bf16 v[164:167], v[8:11], v[72:75], v[164:167]
    v_mfma_f32_16x16x32_bf16 v[168:171], v[8:11], v[80:83], v[168:171]
    v_mfma_f32_16x16x32_bf16 v[168:171], v[12:15], v[84:87], v[168:171]
    v_mfma_f32_16x16x32_bf16 v[172:175], v[12:15], v[92:95], v[172:175]
    v_mfma_f32_16x16x32_bf16 v[172:175], v[8:11], v[88:91], v[172:175]
    s_waitcnt lgkmcnt(2)
    v_mfma_f32_16x16x32_bf16 v[176:179], v[16:19], v[64:67], v[176:179]
    buffer_load_dwordx4 v[108:111], v7, s[24:27], s38 offen offset:3072 sc1
    s_add_u32 s38, s38, 4096
    v_mfma_f32_16x16x32_bf16 v[176:179], v[20:23], v[68:71], v[176:179]
    ds_read_b128 v[8:11], v1 offset:5120
    v_mfma_f32_16x16x32_bf16 v[180:183], v[20:23], v[76:79], v[180:183]
    ds_read_b128 v[12:15], v1 offset:13312
    v_mfma_f32_16x16x32_bf16 v[180:183], v[16:19], v[72:75], v[180:183]
    v_mfma_f32_16x16x32_bf16 v[184:187], v[16:19], v[80:83], v[184:187]
    v_mfma_f32_16x16x32_bf16 v[184:187], v[20:23], v[84:87], v[184:187]
    v_mfma_f32_16x16x32_bf16 v[188:191], v[20:23], v[92:95], v[188:191]
    v_mfma_f32_16x16x32_bf16 v[188:191], v[16:19], v[88:91], v[188:191]
    s_waitcnt lgkmcnt(2)
    v_mfma_f32_16x16x32_bf16 v[192:195], v[24:27], v[64:67], v[192:195]
    buffer_load_dwordx4 v[112:115], v7, s[24:27], s38 offen offset:0 sc1
    v_mfma_f32_16x16x32_bf16 v[192:195], v[28:31], v[68:71], v[192:195]
    ds_read_b128 v[16:19], v2 offset:6144
    v_mfma_f32_16x16x32_bf16 v[196:199], v[28:31], v[76:79], v[196:199]
    ds_read_b128 v[20:23], v2 offset:14336
    v_mfma_f32_16x16x32_bf16 v[196:199], v[24:27], v[72:75], v[196:199]
    v_mfma_f32_16x16x32_bf16 v[200:203], v[24:27], v[80:83], v[200:203]
    v_mfma_f32_16x16x32_bf16 v[200:203], v[28:31], v[84:87], v[200:203]
    v_mfma_f32_16x16x32_bf16 v[204:207], v[28:31], v[92:95], v[204:207]
    v_mfma_f32_16x16x32_bf16 v[204:207], v[24:27], v[88:91], v[204:207]
    s_waitcnt lgkmcnt(2)
    v_mfma_f32_16x16x32_bf16 v[208:211], v[8:11], v[64:67], v[208:211]
    buffer_load_dwordx4 v[116:119], v7, s[24:27], s38 offen offset:1024 sc1
    v_mfma_f32_16x16x32_bf16 v[208:211], v[12:15], v[68:71], v[208:211]
    ds_read_b128 v[24:27], v3 offset:7168
    v_mfma_f32_16x16x32_bf16 v[212:215], v[12:15], v[76:79], v[212:215]
    ds_read_b128 v[28:31], v3 offset:15360
    v_mfma_f32_16x16x32_bf16 v[212:215], v[8:11], v[72:75], v[212:215]
    v_mfma_f32_16x16x32_bf16 v[216:219], v[8:11], v[80:83], v[216:219]
    v_mfma_f32_16x16x32_bf16 v[216:219], v[12:15], v[84:87], v[216:219]
    v_mfma_f32_16x16x32_bf16 v[220:223], v[12:15], v[92:95], v[220:223]
    v_mfma_f32_16x16x32_bf16 v[220:223], v[8:11], v[88:91], v[220:223]
    s_waitcnt lgkmcnt(2)
    v_mfma_f32_16x16x32_bf16 v[224:227], v[16:19], v[64:67], v[224:227]
    buffer_load_dwordx4 v[120:123], v7, s[24:27], s38 offen offset:2048 sc1
    v_mfma_f32_16x16x32_bf16 v[224:227], v[20:23], v[68:71], v[224:227]
    ds_read_b128 v[8:11], v0 offset:16384
    v_mfma_f32_16x16x32_bf16 v[228:231], v[20:23], v[76:79], v[228:231]
    ds_read_b128 v[12:15], v0 offset:24576
    v_mfma_f32_16x16x32_bf16 v[228:231], v[16:19], v[72:75], v[228:231]
    v_mfma_f32_16x16x32_bf16 v[232:235], v[16:19], v[80:83], v[232:235]
    v_mfma_f32_16x16x32_bf16 v[232:235], v[20:23], v[84:87], v[232:235]
    v_mfma_f32_16x16x32_bf16 v[236:239], v[20:23], v[92:95], v[236:239]
    v_mfma_f32_16x16x32_bf16 v[236:239], v[16:19], v[88:91], v[236:239]
    s_waitcnt lgkmcnt(2)
    v_mfma_f32_16x16x32_bf16 v[240:243], v[24:27], v[64:67], v[240:243]
    buffer_load_dwordx4 v[124:127], v7, s[24:27], s38 offen offset:3072 sc1
    s_add_u32 s38, s38, 4096
    v_mfma_f32_16x16x32_bf16 v[240:243], v[28:31], v[68:71], v[240:243]
    ds_read_b128 v[16:19], v1 offset:17408
    v_mfma_f32_16x16x32_bf16 v[244:247], v[28:31], v[76:79], v[244:247]
    ds_read_b128 v[20:23], v1 offset:25600
    v_mfma_f32_16x16x32_bf16 v[244:247], v[24:27], v[72:75], v[244:247]
    v_mfma_f32_16x16x32_bf16 v[248:251], v[24:27], v[80:83], v[248:251]
    v_mfma_f32_16x16x32_bf16 v[248:251], v[28:31], v[84:87], v[248:251]
    v_mfma_f32_16x16x32_bf16 v[252:255], v[28:31], v[92:95], v[252:255]
    v_mfma_f32_16x16x32_bf16 v[252:255], v[24:27], v[88:91], v[252:255]
    s_waitcnt vmcnt(8)
    s_waitcnt lgkmcnt(2)
    v_mfma_f32_16x16x32_bf16 v[128:131], v[8:11], v[32:35], v[128:131]
    buffer_load_dwordx4 v[64:67], v7, s[24:27], s38 offen offset:0 sc1
    v_mfma_f32_16x16x32_bf16 v[128:131], v[12:15], v[36:39], v[128:131]
    ds_read_b128 v[24:27], v2 offset:18432
    v_mfma_f32_16x16x32_bf16 v[132:135], v[12:15], v[44:47], v[132:135]
    ds_read_b128 v[28:31], v2 offset:26624
    v_mfma_f32_16x16x32_bf16 v[132:135], v[8:11], v[40:43], v[132:135]
    v_mfma_f32_16x16x32_bf16 v[136:139], v[8:11], v[48:51], v[136:139]
    v_mfma_f32_16x16x32_bf16 v[136:139], v[12:15], v[52:55], v[136:139]
    v_mfma_f32_16x16x32_bf16 v[140:143], v[12:15], v[60:63], v[140:143]
    v_mfma_f32_16x16x32_bf16 v[140:143], v[8:11], v[56:59], v[140:143]
    s_waitcnt lgkmcnt(2)
    v_mfma_f32_16x16x32_bf16 v[144:147], v[16:19], v[32:35], v[144:147]
    buffer_load_dwordx4 v[68:71], v7, s[24:27], s38 offen offset:1024 sc1
    v_mfma_f32_16x16x32_bf16 v[144:147], v[20:23], v[36:39], v[144:147]
    ds_read_b128 v[8:11], v3 offset:19456
    v_mfma_f32_16x16x32_bf16 v[148:151], v[20:23], v[44:47], v[148:151]
    ds_read_b128 v[12:15], v3 offset:27648
    v_mfma_f32_16x16x32_bf16 v[148:151], v[16:19], v[40:43], v[148:151]
    v_mfma_f32_16x16x32_bf16 v[152:155], v[16:19], v[48:51], v[152:155]
    v_mfma_f32_16x16x32_bf16 v[152:155], v[20:23], v[52:55], v[152:155]
    v_mfma_f32_16x16x32_bf16 v[156:159], v[20:23], v[60:63], v[156:159]
    v_mfma_f32_16x16x32_bf16 v[156:159], v[16:19], v[56:59], v[156:159]
    s_waitcnt lgkmcnt(2)
    v_mfma_f32_16x16x32_bf16 v[160:163], v[24:27], v[32:35], v[160:163]
    buffer_load_dwordx4 v[72:75], v7, s[24:27], s38 offen offset:2048 sc1
    v_mfma_f32_16x16x32_bf16 v[160:163], v[28:31], v[36:39], v[160:163]
    ds_read_b128 v[16:19], v0 offset:20480
    v_mfma_f32_16x16x32_bf16 v[164:167], v[28:31], v[44:47], v[164:167]
    ds_read_b128 v[20:23], v0 offset:28672
    v_mfma_f32_16x16x32_bf16 v[164:167], v[24:27], v[40:43], v[164:167]
    v_mfma_f32_16x16x32_bf16 v[168:171], v[24:27], v[48:51], v[168:171]
    v_mfma_f32_16x16x32_bf16 v[168:171], v[28:31], v[52:55], v[168:171]
    v_mfma_f32_16x16x32_bf16 v[172:175], v[28:31], v[60:63], v[172:175]
    v_mfma_f32_16x16x32_bf16 v[172:175], v[24:27], v[56:59], v[172:175]
    s_waitcnt lgkmcnt(2)
    v_mfma_f32_16x16x32_bf16 v[176:179], v[8:11], v[32:35], v[176:179]
    buffer_load_dwordx4 v[76:79], v7, s[24:27], s38 offen offset:3072 sc1
    s_add_u32 s38, s38, 4096
    v_mfma_f32_16x16x32_bf16 v[176:179], v[12:15], v[36:39], v[176:179]
    ds_read_b128 v[24:27], v1 offset:21504
    v_mfma_f32_16x16x32_bf16 v[180:183], v[12:15], v[44:47], v[180:183]
    ds_read_b128 v[28:31], v1 offset:29696
    v_mfma_f32_16x16x32_bf16 v[180:183], v[8:11], v[40:43], v[180:183]
    v_mfma_f32_16x16x32_bf16 v[184:187], v[8:11], v[48:51], v[184:187]
    v_mfma_f32_16x16x32_bf16 v[184:187], v[12:15], v[52:55], v[184:187]
    v_mfma_f32_16x16x32_bf16 v[188:191], v[12:15], v[60:63], v[188:191]
    v_mfma_f32_16x16x32_bf16 v[188:191], v[8:11], v[56:59], v[188:191]
    s_waitcnt lgkmcnt(2)
    v_mfma_f32_16x16x32_bf16 v[192:195], v[16:19], v[32:35], v[192:195]
    buffer_load_dwordx4 v[80:83], v7, s[24:27], s38 offen offset:0 sc1
    v_mfma_f32_16x16x32_bf16 v[192:195], v[20:23], v[36:39], v[192:195]
    ds_read_b128 v[8:11], v2 offset:22528
    v_mfma_f32_16x16x32_bf16 v[196:199], v[20:23], v[44:47], v[196:199]
    ds_read_b128 v[12:15], v2 offset:30720
    v_mfma_f32_16x16x32_bf16 v[196:199], v[16:19], v[40:43], v[196:199]
    v_mfma_f32_16x16x32_bf16 v[200:203], v[16:19], v[48:51], v[200:203]
    v_mfma_f32_16x16x32_bf16 v[200:203], v[20:23], v[52:55], v[200:203]
    v_mfma_f32_16x16x32_bf16 v[204:207], v[20:23], v[60:63], v[204:207]
    v_mfma_f32_16x16x32_bf16 v[204:207], v[16:19], v[56:59], v[204:207]
    s_waitcnt lgkmcnt(2)
    v_mfma_f32_16x16x32_bf16 v[208:211], v[24:27], v[32:35], v[208:211]
    buffer_load_dwordx4 v[84:87], v7, s[24:27], s38 offen offset:1024 sc1
    v_mfma_f32_16x16x32_bf16 v[208:211], v[28:31], v[36:39], v[208:211]
    ds_read_b128 v[16:19], v3 offset:23552
    v_mfma_f32_16x16x32_bf16 v[212:215], v[28:31], v[44:47], v[212:215]
    ds_read_b128 v[20:23], v3 offset:31744
    v_mfma_f32_16x16x32_bf16 v[212:215], v[24:27], v[40:43], v[212:215]
    v_mfma_f32_16x16x32_bf16 v[216:219], v[24:27], v[48:51], v[216:219]
    v_mfma_f32_16x16x32_bf16 v[216:219], v[28:31], v[52:55], v[216:219]
    v_mfma_f32_16x16x32_bf16 v[220:223], v[28:31], v[60:63], v[220:223]
    v_mfma_f32_16x16x32_bf16 v[220:223], v[24:27], v[56:59], v[220:223]
    s_waitcnt lgkmcnt(2)
    v_mfma_f32_16x16x32_bf16 v[224:227], v[8:11], v[32:35], v[224:227]
    buffer_load_dwordx4 v[88:91], v7, s[24:27], s38 offen offset:2048 sc1
    v_mfma_f32_16x16x32_bf16 v[224:227], v[12:15], v[36:39], v[224:227]
    v_add_u32 v0, 0x8000, v0
    v_add_u32 v1, 0x8000, v1
    ds_read_b128 v[24:27], v0 offset:0
    v_mfma_f32_16x16x32_bf16 v[228:231], v[12:15], v[44:47], v[228:231]
    ds_read_b128 v[28:31], v0 offset:8192
    v_mfma_f32_16x16x32_bf16 v[228:231], v[8:11], v[40:43], v[228:231]
    v_mfma_f32_16x16x32_bf16 v[232:235], v[8:11], v[48:51], v[232:235]
    v_mfma_f32_16x16x32_bf16 v[232:235], v[12:15], v[52:55], v[232:235]
    v_mfma_f32_16x16x32_bf16 v[236:239], v[12:15], v[60:63], v[236:239]
    v_mfma_f32_16x16x32_bf16 v[236:239], v[8:11], v[56:59], v[236:239]
    s_waitcnt lgkmcnt(2)
    v_mfma_f32_16x16x32_bf16 v[240:243], v[16:19], v[32:35], v[240:243]
    buffer_load_dwordx4 v[92:95], v7, s[24:27], s38 offen offset:3072 sc1
    s_add_u32 s38, s38, 4096
    v_mfma_f32_16x16x32_bf16 v[240:243], v[20:23], v[36:39], v[240:243]
    v_add_u32 v2, 0x8000, v2
    v_add_u32 v3, 0x8000, v3
    ds_read_b128 v[8:11], v1 offset:1024
    v_mfma_f32_16x16x32_bf16 v[244:247], v[20:23], v[44:47], v[244:247]
    ds_read_b128 v[12:15], v1 offset:9216
    v_mfma_f32_16x16x32_bf16 v[244:247], v[16:19], v[40:43], v[244:247]
    v_mfma_f32_16x16x32_bf16 v[248:251], v[16:19], v[48:51], v[248:251]
    v_mfma_f32_16x16x32_bf16 v[248:251], v[20:23], v[52:55], v[248:251]
    v_mfma_f32_16x16x32_bf16 v[252:255], v[20:23], v[60:63], v[252:255]
    v_mfma_f32_16x16x32_bf16 v[252:255], v[16:19], v[56:59], v[252:255]
    s_waitcnt vmcnt(8)
    s_waitcnt lgkmcnt(2)
    v_mfma_f32_16x16x32_bf16 v[128:131], v[24:27], v[96:99], v[128:131]
    buffer_load_dwordx4 v[32:35], v7, s[24:27], s38 offen offset:0 sc1
    v_mfma_f32_16x16x32_bf16 v[128:131], v[28:31], v[100:103], v[128:131]
    ds_read_b128 v[16:19], v2 offset:2048
    v_mfma_f32_16x16x32_bf16 v[132:135], v[28:31], v[108:111], v[132:135]
    ds_read_b128 v[20:23], v2 offset:10240
    v_mfma_f32_16x16x32_bf16 v[132:135], v[24:27], v[104:107], v[132:135]
    v_mfma_f32_16x16x32_bf16 v[136:139], v[24:27], v[112:115], v[136:139]
    buffer_load_dwordx4 v[36:39], v7, s[24:27], s38 offen offset:1024 sc1
    v_mfma_f32_16x16x32_bf16 v[136:139], v[28:31], v[116:119], v[136:139]
    v_mfma_f32_16x16x32_bf16 v[140:143], v[28:31], v[124:127], v[140:143]
    v_mfma_f32_16x16x32_bf16 v[140:143], v[24:27], v[120:123], v[140:143]
    s_waitcnt lgkmcnt(2)
    v_mfma_f32_16x16x32_bf16 v[144:147], v[8:11], v[96:99], v[144:147]
    buffer_load_dwordx4 v[40:43], v7, s[24:27], s38 offen offset:2048 sc1
    v_mfma_f32_16x16x32_bf16 v[144:147], v[12:15], v[100:103], v[144:147]
    ds_read_b128 v[24:27], v3 offset:3072
    v_mfma_f32_16x16x32_bf16 v[148:151], v[12:15], v[108:111], v[148:151]
    ds_read_b128 v[28:31], v3 offset:11264
    v_mfma_f32_16x16x32_bf16 v[148:151], v[8:11], v[104:107], v[148:151]
    v_mfma_f32_16x16x32_bf16 v[152:155], v[8:11], v[112:115], v[152:155]
    buffer_load_dwordx4 v[44:47], v7, s[24:27], s38 offen offset:3072 sc1
    s_add_u32 s38, s38, 4096
    v_mfma_f32_16x16x32_bf16 v[152:155], v[12:15], v[116:119], v[152:155]
    v_mfma_f32_16x16x32_bf16 v[156:159], v[12:15], v[124:127], v[156:159]
    v_mfma_f32_16x16x32_bf16 v[156:159], v[8:11], v[120:123], v[156:159]
    s_waitcnt lgkmcnt(2)
    v_mfma_f32_16x16x32_bf16 v[160:163], v[16:19], v[96:99], v[160:163]
    buffer_load_dwordx4 v[48:51], v7, s[24:27], s38 offen offset:0 sc1
    v_mfma_f32_16x16x32_bf16 v[160:163], v[20:23], v[100:103], v[160:163]
    ds_read_b128 v[8:11], v0 offset:4096
    v_mfma_f32_16x16x32_bf16 v[164:167], v[20:23], v[108:111], v[164:167]
    ds_read_b128 v[12:15], v0 offset:12288
    v_mfma_f32_16x16x32_bf16 v[164:167], v[16:19], v[104:107], v[164:167]
    v_mfma_f32_16x16x32_bf16 v[168:171], v[16:19], v[112:115], v[168:171]
    buffer_load_dwordx4 v[52:55], v7, s[24:27], s38 offen offset:1024 sc1
    v_mfma_f32_16x16x32_bf16 v[168:171], v[20:23], v[116:119], v[168:171]
    v_mfma_f32_16x16x32_bf16 v[172:175], v[20:23], v[124:127], v[172:175]
    v_mfma_f32_16x16x32_bf16 v[172:175], v[16:19], v[120:123], v[172:175]
    s_waitcnt lgkmcnt(2)
    v_mfma_f32_16x16x32_bf16 v[176:179], v[24:27], v[96:99], v[176:179]
    buffer_load_dwordx4 v[56:59], v7, s[24:27], s38 offen offset:2048 sc1
    v_mfma_f32_16x16x32_bf16 v[176:179], v[28:31], v[100:103], v[176:179]
    ds_read_b128 v[16:19], v1 offset:5120
    v_mfma_f32_16x16x32_bf16 v[180:183], v[28:31], v[108:111], v[180:183]
    ds_read_b128 v[20:23], v1 offset:13312
    v_mfma_f32_16x16x32_bf16 v[180:183], v[24:27], v[104:107], v[180:183]
    v_mfma_f32_16x16x32_bf16 v[184:187], v[24:27], v[112:115], v[184:187]
    buffer_load_dwordx4 v[60:63], v7, s[24:27], s38 offen offset:3072 sc1
    s_add_u32 s38, s38, 4096
    v_mfma_f32_16x16x32_bf16 v[184:187], v[28:31], v[116:119], v[184:187]
    v_mfma_f32_16x16x32_bf16 v[188:191], v[28:31], v[124:127], v[188:191]
    v_mfma_f32_16x16x32_bf16 v[188:191], v[24:27], v[120:123], v[188:191]
    s_waitcnt lgkmcnt(2)
    v_mfma_f32_16x16x32_bf16 v[192:195], v[8:11], v[96:99], v[192:195]
    v_mfma_f32_16x16x32_bf16 v[192:195], v[12:15], v[100:103], v[192:195]
    ds_read_b128 v[24:27], v2 offset:6144
    v_mfma_f32_16x16x32_bf16 v[196:199], v[12:15], v[108:111], v[196:199]
    ds_read_b128 v[28:31], v2 offset:14336
    v_mfma_f32_16x16x32_bf16 v[196:199], v[8:11], v[104:107], v[196:199]
    v_mfma_f32_16x16x32_bf16 v[200:203], v[8:11], v[112:115], v[200:203]
    v_mfma_f32_16x16x32_bf16 v[200:203], v[12:15], v[116:119], v[200:203]
    v_mfma_f32_16x16x32_bf16 v[204:207], v[12:15], v[124:127], v[204:207]
    v_mfma_f32_16x16x32_bf16 v[204:207], v[8:11], v[120:123], v[204:207]
    s_waitcnt lgkmcnt(2)
    v_mfma_f32_16x16x32_bf16 v[208:211], v[16:19], v[96:99], v[208:211]
    v_mfma_f32_16x16x32_bf16 v[208:211], v[20:23], v[100:103], v[208:211]
    ds_read_b128 v[8:11], v3 offset:7168
    v_mfma_f32_16x16x32_bf16 v[212:215], v[20:23], v[108:111], v[212:215]
    ds_read_b128 v[12:15], v3 offset:15360
    v_mfma_f32_16x16x32_bf16 v[212:215], v[16:19], v[104:107], v[212:215]
    v_mfma_f32_16x16x32_bf16 v[216:219], v[16:19], v[112:115], v[216:219]
    v_mfma_f32_16x16x32_bf16 v[216:219], v[20:23], v[116:119], v[216:219]
    v_mfma_f32_16x16x32_bf16 v[220:223], v[20:23], v[124:127], v[220:223]
    v_mfma_f32_16x16x32_bf16 v[220:223], v[16:19], v[120:123], v[220:223]
    s_cbranch_vccz L_G2_B
    s_waitcnt lgkmcnt(2)
    v_mfma_f32_16x16x32_bf16 v[224:227], v[24:27], v[96:99], v[224:227]
    v_mfma_f32_16x16x32_bf16 v[224:227], v[28:31], v[100:103], v[224:227]
    ds_read_b128 v[16:19], v0 offset:16384
    v_mfma_f32_16x16x32_bf16 v[228:231], v[28:31], v[108:111], v[228:231]
    ds_read_b128 v[20:23], v0 offset:24576
    v_mfma_f32_16x16x32_bf16 v[228:231], v[24:27], v[104:107], v[228:231]
    v_mfma_f32_16x16x32_bf16 v[232:235], v[24:27], v[112:115], v[232:235]
    v_mfma_f32_16x16x32_bf16 v[232:235], v[28:31], v[116:119], v[232:235]
    v_mfma_f32_16x16x32_bf16 v[236:239], v[28:31], v[124:127], v[236:239]
    v_mfma_f32_16x16x32_bf16 v[236:239], v[24:27], v[120:123], v[236:239]
    s_waitcnt lgkmcnt(2)
    v_mfma_f32_16x16x32_bf16 v[240:243], v[8:11], v[96:99], v[240:243]
    v_mfma_f32_16x16x32_bf16 v[240:243], v[12:15], v[100:103], v[240:243]
    ds_read_b128 v[24:27], v1 offset:17408
    v_mfma_f32_16x16x32_bf16 v[244:247], v[12:15], v[108:111], v[244:247]
    ds_read_b128 v[28:31], v1 offset:25600
    v_mfma_f32_16x16x32_bf16 v[244:247], v[8:11], v[104:107], v[244:247]
    v_mfma_f32_16x16x32_bf16 v[248:251], v[8:11], v[112:115], v[248:251]
    v_mfma_f32_16x16x32_bf16 v[248:251], v[12:15], v[116:119], v[248:251]
    v_mfma_f32_16x16x32_bf16 v[252:255], v[12:15], v[124:127], v[252:255]
    v_mfma_f32_16x16x32_bf16 v[252:255], v[8:11], v[120:123], v[252:255]
    s_waitcnt vmcnt(8)
    s_waitcnt lgkmcnt(2)
    v_mfma_f32_16x16x32_bf16 v[128:131], v[16:19], v[64:67], v[128:131]
    buffer_load_dwordx4 v[96:99], v7, s[24:27], s38 offen offset:0 sc1
    v_mfma_f32_16x16x32_bf16 v[128:131], v[20:23], v[68:71], v[128:131]
    ds_read_b128 v[8:11], v2 offset:18432
    v_mfma_f32_16x16x32_bf16 v[132:135], v[20:23], v[76:79], v[132:135]
    ds_read_b128 v[12:15], v2 offset:26624
    v_mfma_f32_16x16x32_bf16 v[132:135], v[16:19], v[72:75], v[132:135]
    v_mfma_f32_16x16x32_bf16 v[136:139], v[16:19], v[80:83], v[136:139]
    buffer_load_dwordx4 v[100:103], v7, s[24:27], s38 offen offset:1024 sc1
    v_mfma_f32_16x16x32_bf16 v[136:139], v[20:23], v[84:87], v[136:139]
    v_mfma_f32_16x16x32_bf16 v[140:143], v[20:23], v[92:95], v[140:143]
    v_mfma_f32_16x16x32_bf16 v[140:143], v[16:19], v[88:91], v[140:143]
    s_waitcnt lgkmcnt(2)
    v_mfma_f32_16x16x32_bf16 v[144:147], v[24:27], v[64:67], v[144:147]
    buffer_load_dwordx4 v[104:107], v7, s[24:27], s38 offen offset:2048 sc1
    v_mfma_f32_16x16x32_bf16 v[144:147], v[28:31], v[68:71], v[144:147]
    ds_read_b128 v[16:19], v3 offset:19456
    v_mfma_f32_16x16x32_bf16 v[148:151], v[28:31], v[76:79], v[148:151]
    ds_read_b128 v[20:23], v3 offset:27648
    v_mfma_f32_16x16x32_bf16 v[148:151], v[24:27], v[72:75], v[148:151]
    v_mfma_f32_16x16x32_bf16 v[152:155], v[24:27], v[80:83], v[152:155]
    buffer_load_dwordx4 v[108:111], v7, s[24:27], s38 offen offset:3072 sc1
    s_add_u32 s38, s38, 4096
    v_mfma_f32_16x16x32_bf16 v[152:155], v[28:31], v[84:87], v[152:155]
    v_mfma_f32_16x16x32_bf16 v[156:159], v[28:31], v[92:95], v[156:159]
    v_mfma_f32_16x16x32_bf16 v[156:159], v[24:27], v[88:91], v[156:159]
    s_waitcnt lgkmcnt(2)
    v_mfma_f32_16x16x32_bf16 v[160:163], v[8:11], v[64:67], v[160:163]
    buffer_load_dwordx4 v[112:115], v7, s[24:27], s38 offen offset:0 sc1
    v_mfma_f32_16x16x32_bf16 v[160:163], v[12:15], v[68:71], v[160:163]
    ds_read_b128 v[24:27], v0 offset:20480
    v_mfma_f32_16x16x32_bf16 v[164:167], v[12:15], v[76:79], v[164:167]
    ds_read_b128 v[28:31], v0 offset:28672
    v_mfma_f32_16x16x32_bf16 v[164:167], v[8:11], v[72:75], v[164:167]
    v_mfma_f32_16x16x32_bf16 v[168:171], v[8:11], v[80:83], v[168:171]
    buffer_load_dwordx4 v[116:119], v7, s[24:27], s38 offen offset:1024 sc1
    v_mfma_f32_16x16x32_bf16 v[168:171], v[12:15], v[84:87], v[168:171]
    v_mfma_f32_16x16x32_bf16 v[172:175], v[12:15], v[92:95], v[172:175]
    v_mfma_f32_16x16x32_bf16 v[172:175], v[8:11], v[88:91], v[172:175]
    s_waitcnt lgkmcnt(2)
    v_mfma_f32_16x16x32_bf16 v[176:179], v[16:19], v[64:67], v[176:179]
    buffer_load_dwordx4 v[120:123], v7, s[24:27], s38 offen offset:2048 sc1
    v_mfma_f32_16x16x32_bf16 v[176:179], v[20:23], v[68:71], v[176:179]
    ds_read_b128 v[8:11], v1 offset:21504
    v_mfma_f32_16x16x32_bf16 v[180:183], v[20:23], v[76:79], v[180:183]
    ds_read_b128 v[12:15], v1 offset:29696
    v_mfma_f32_16x16x32_bf16 v[180:183], v[16:19], v[72:75], v[180:183]
    v_mfma_f32_16x16x32_bf16 v[184:187], v[16:19], v[80:83], v[184:187]
    buffer_load_dwordx4 v[124:127], v7, s[24:27], s38 offen offset:3072 sc1
    s_add_u32 s38, s38, 4096
    v_mfma_f32_16x16x32_bf16 v[184:187], v[20:23], v[84:87], v[184:187]
    v_mfma_f32_16x16x32_bf16 v[188:191], v[20:23], v[92:95], v[188:191]
    v_mfma_f32_16x16x32_bf16 v[188:191], v[16:19], v[88:91], v[188:191]
    s_waitcnt lgkmcnt(2)
    v_mfma_f32_16x16x32_bf16 v[192:195], v[24:27], v[64:67], v[192:195]
    v_mfma_f32_16x16x32_bf16 v[192:195], v[28:31], v[68:71], v[192:195]
    ds_read_b128 v[16:19], v2 offset:22528
    v_mfma_f32_16x16x32_bf16 v[196:199], v[28:31], v[76:79], v[196:199]
    ds_read_b128 v[20:23], v2 offset:30720
    v_mfma_f32_16x16x32_bf16 v[196:199], v[24:27], v[72:75], v[196:199]
    v_mfma_f32_16x16x32_bf16 v[200:203], v[24:27], v[80:83], v[200:203]
    v_mfma_f32_16x16x32_bf16 v[200:203], v[28:31], v[84:87], v[200:203]
    v_mfma_f32_16x16x32_bf16 v[204:207], v[28:31], v[92:95], v[204:207]
    v_mfma_f32_16x16x32_bf16 v[204:207], v[24:27], v[88:91], v[204:207]
    s_waitcnt lgkmcnt(2)
    v_mfma_f32_16x16x32_bf16 v[208:211], v[8:11], v[64:67], v[208:211]
    v_mfma_f32_16x16x32_bf16 v[208:211], v[12:15], v[68:71], v[208:211]
    ds_read_b128 v[24:27], v3 offset:23552
    v_mfma_f32_16x16x32_bf16 v[212:215], v[12:15], v[76:79], v[212:215]
    ds_read_b128 v[28:31], v3 offset:31744
    v_mfma_f32_16x16x32_bf16 v[212:215], v[8:11], v[72:75], v[212:215]
    v_mfma_f32_16x16x32_bf16 v[216:219], v[8:11], v[80:83], v[216:219]
    v_mfma_f32_16x16x32_bf16 v[216:219], v[12:15], v[84:87], v[216:219]
    v_mfma_f32_16x16x32_bf16 v[220:223], v[12:15], v[92:95], v[220:223]
    v_mfma_f32_16x16x32_bf16 v[220:223], v[8:11], v[88:91], v[220:223]
    s_waitcnt lgkmcnt(2)
    v_mfma_f32_16x16x32_bf16 v[224:227], v[16:19], v[64:67], v[224:227]
    v_mfma_f32_16x16x32_bf16 v[224:227], v[20:23], v[68:71], v[224:227]
    s_sub_u32 m0, s35, 32768
    s_add_u32 s53, s38, 253952
    buffer_load_dwordx4 v7, s[24:27], s53 offen offset:0 sc1 lds
    buffer_load_dwordx4 v7, s[24:27], s53 offen offset:1024 sc1 lds
    buffer_load_dwordx4 v7, s[24:27], s53 offen offset:2048 sc1 lds
    buffer_load_dwordx4 v7, s[24:27], s53 offen offset:3072 sc1 lds
    s_sub_u32 m0, s35, 28672
    s_add_u32 s53, s38, 258048
    buffer_load_dwordx4 v7, s[24:27], s53 offen offset:0 sc1 lds
    buffer_load_dwordx4 v7, s[24:27], s53 offen offset:1024 sc1 lds
    buffer_load_dwordx4 v7, s[24:27], s53 offen offset:2048 sc1 lds
    buffer_load_dwordx4 v7, s[24:27], s53 offen offset:3072 sc1 lds
    s_waitcnt vmcnt(0)
    s_setprio 3
    s_barrier
    ds_read_b128 v[8:11], v0 offset:32768
    v_mfma_f32_16x16x32_bf16 v[228:231], v[20:23], v[76:79], v[228:231]
    ds_read_b128 v[12:15], v0 offset:40960
    v_mfma_f32_16x16x32_bf16 v[228:231], v[16:19], v[72:75], v[228:231]
    v_mfma_f32_16x16x32_bf16 v[232:235], v[16:19], v[80:83], v[232:235]
    v_mfma_f32_16x16x32_bf16 v[232:235], v[20:23], v[84:87], v[232:235]
    v_mfma_f32_16x16x32_bf16 v[236:239], v[20:23], v[92:95], v[236:239]
    v_mfma_f32_16x16x32_bf16 v[236:239], v[16:19], v[88:91], v[236:239]
    s_waitcnt lgkmcnt(2)
    v_mfma_f32_16x16x32_bf16 v[240:243], v[24:27], v[64:67], v[240:243]
    v_mfma_f32_16x16x32_bf16 v[240:243], v[28:31], v[68:71], v[240:243]
    ds_read_b128 v[16:19], v0 offset:49152
    v_mfma_f32_16x16x32_bf16 v[244:247], v[28:31], v[76:79], v[244:247]
    ds_read_b128 v[20:23], v0 offset:57344
    v_mfma_f32_16x16x32_bf16 v[244:247], v[24:27], v[72:75], v[244:247]
    v_mfma_f32_16x16x32_bf16 v[248:251], v[24:27], v[80:83], v[248:251]
    v_mfma_f32_16x16x32_bf16 v[248:251], v[28:31], v[84:87], v[248:251]
    v_mfma_f32_16x16x32_bf16 v[252:255], v[28:31], v[92:95], v[252:255]
    v_mfma_f32_16x16x32_bf16 v[252:255], v[24:27], v[88:91], v[252:255]
    s_waitcnt lgkmcnt(2)
    v_mfma_f32_16x16x32_bf16 v[128:131], v[8:11], v[32:35], v[128:131]
    v_mfma_f32_16x16x32_bf16 v[128:131], v[12:15], v[36:39], v[128:131]
    ds_read_b128 v[24:27], v1 offset:33792
    v_mfma_f32_16x16x32_bf16 v[132:135], v[12:15], v[44:47], v[132:135]
    ds_read_b128 v[28:31], v1 offset:41984
    v_mfma_f32_16x16x32_bf16 v[132:135], v[8:11], v[40:43], v[132:135]
    v_mfma_f32_16x16x32_bf16 v[136:139], v[8:11], v[48:51], v[136:139]
    v_mfma_f32_16x16x32_bf16 v[136:139], v[12:15], v[52:55], v[136:139]
    v_mfma_f32_16x16x32_bf16 v[140:143], v[12:15], v[60:63], v[140:143]
    v_mfma_f32_16x16x32_bf16 v[140:143], v[8:11], v[56:59], v[140:143]
    s_waitcnt lgkmcnt(2)
    v_mfma_f32_16x16x32_bf16 v[128:131], v[16:19], v[96:99], v[128:131]
    v_mfma_f32_16x16x32_bf16 v[128:131], v[20:23], v[100:103], v[128:131]
    ds_read_b128 v[8:11], v1 offset:50176
    v_mfma_f32_16x16x32_bf16 v[132:135], v[20:23], v[108:111], v[132:135]
    ds_read_b128 v[12:15], v1 offset:58368
    v_mfma_f32_16x16x32_bf16 v[132:135], v[16:19], v[104:107], v[132:135]
    v_mfma_f32_16x16x32_bf16 v[136:139], v[16:19], v[112:115], v[136:139]
    v_mfma_f32_16x16x32_bf16 v[136:139], v[20:23], v[116:119], v[136:139]
    v_mfma_f32_16x16x32_bf16 v[140:143], v[20:23], v[124:127], v[140:143]
    v_mfma_f32_16x16x32_bf16 v[140:143], v[16:19], v[120:123], v[140:143]
    s_waitcnt lgkmcnt(2)
    v_mfma_f32_16x16x32_bf16 v[144:147], v[24:27], v[32:35], v[144:147]
    v_mfma_f32_16x16x32_bf16 v[144:147], v[28:31], v[36:39], v[144:147]
    ds_read_b128 v[16:19], v2 offset:34816
    v_mfma_f32_16x16x32_bf16 v[148:151], v[28:31], v[44:47], v[148:151]
    ds_read_b128 v[20:23], v2 offset:43008
    v_mfma_f32_16x16x32_bf16 v[148:151], v[24:27], v[40:43], v[148:151]
    v_mfma_f32_16x16x32_bf16 v[152:155], v[24:27], v[48:51], v[152:155]
    v_mfma_f32_16x16x32_bf16 v[152:155], v[28:31], v[52:55], v[152:155]
    v_mfma_f32_16x16x32_bf16 v[156:159], v[28:31], v[60:63], v[156:159]
    v_mfma_f32_16x16x32_bf16 v[156:159], v[24:27], v[56:59], v[156:159]
    s_waitcnt lgkmcnt(2)
    v_mfma_f32_16x16x32_bf16 v[144:147], v[8:11], v[96:99], v[144:147]
    v_mfma_f32_16x16x32_bf16 v[144:147], v[12:15], v[100:103], v[144:147]
    ds_read_b128 v[24:27], v2 offset:51200
    v_mfma_f32_16x16x32_bf16 v[148:151], v[12:15], v[108:111], v[148:151]
    ds_read_b128 v[28:31], v2 offset:59392
    v_mfma_f32_16x16x32_bf16 v[148:151], v[8:11], v[104:107], v[148:151]
    v_mfma_f32_16x16x32_bf16 v[152:155], v[8:11], v[112:115], v[152:155]
    v_mfma_f32_16x16x32_bf16 v[152:155], v[12:15], v[116:119], v[152:155]
    v_mfma_f32_16x16x32_bf16 v[156:159], v[12:15], v[124:127], v[156:159]
    v_mfma_f32_16x16x32_bf16 v[156:159], v[8:11], v[120:123], v[156:159]
    v_mbcnt_lo_u32_b32 v92, -1, 0
    v_mbcnt_hi_u32_b32 v92, -1, v92
    v_and_b32 v6, 15, v92
    v_lshlrev_b32 v6, 3, v6
    v_lshrrev_b32 v4, 4, v92
    v_lshl_add_u32 v6, v4, 10, v6
    s_lshl_b32 s52, s32, 7
    s_add_u32 s52, s52, s37
    s_setprio 0
    v_cvt_pk_bf16_f32 v128, v128, v132
    v_cvt_pk_bf16_f32 v132, v129, v133
    v_cvt_pk_bf16_f32 v130, v130, v134
    v_cvt_pk_bf16_f32 v134, v131, v135
    v_cvt_pk_bf16_f32 v129, v136, v140
    v_cvt_pk_bf16_f32 v133, v137, v141
    v_cvt_pk_bf16_f32 v131, v138, v142
    v_cvt_pk_bf16_f32 v135, v139, v143
    s_waitcnt vmcnt(3)
    buffer_store_dwordx2 v[128:129], v6, s[16:19], s52 offen offset:0 sc1
    s_add_u32 s52, s52, 4096
    s_waitcnt vmcnt(3)
    buffer_store_dwordx2 v[132:133], v6, s[16:19], s52 offen offset:0 sc1
    s_add_u32 s52, s52, 4096
    s_waitcnt vmcnt(3)
    buffer_store_dwordx2 v[130:131], v6, s[16:19], s52 offen offset:0 sc1
    s_add_u32 s52, s52, 4096
    s_waitcnt vmcnt(3)
    buffer_store_dwordx2 v[134:135], v6, s[16:19], s52 offen offset:0 sc1
    s_add_u32 s52, s52, 4096
    s_setprio 3
    s_waitcnt lgkmcnt(2)
    v_mfma_f32_16x16x32_bf16 v[160:163], v[16:19], v[32:35], v[160:163]
    v_mfma_f32_16x16x32_bf16 v[160:163], v[20:23], v[36:39], v[160:163]
    ds_read_b128 v[8:11], v3 offset:35840
    v_mfma_f32_16x16x32_bf16 v[164:167], v[20:23], v[44:47], v[164:167]
    ds_read_b128 v[12:15], v3 offset:44032
    v_mfma_f32_16x16x32_bf16 v[164:167], v[16:19], v[40:43], v[164:167]
    v_mfma_f32_16x16x32_bf16 v[168:171], v[16:19], v[48:51], v[168:171]
    v_mfma_f32_16x16x32_bf16 v[168:171], v[20:23], v[52:55], v[168:171]
    v_mfma_f32_16x16x32_bf16 v[172:175], v[20:23], v[60:63], v[172:175]
    v_mfma_f32_16x16x32_bf16 v[172:175], v[16:19], v[56:59], v[172:175]
    s_waitcnt lgkmcnt(2)
    v_mfma_f32_16x16x32_bf16 v[160:163], v[24:27], v[96:99], v[160:163]
    v_mfma_f32_16x16x32_bf16 v[160:163], v[28:31], v[100:103], v[160:163]
    ds_read_b128 v[16:19], v3 offset:52224
    v_mfma_f32_16x16x32_bf16 v[164:167], v[28:31], v[108:111], v[164:167]
    ds_read_b128 v[20:23], v3 offset:60416
    v_mfma_f32_16x16x32_bf16 v[164:167], v[24:27], v[104:107], v[164:167]
    v_mfma_f32_16x16x32_bf16 v[168:171], v[24:27], v[112:115], v[168:171]
    v_mfma_f32_16x16x32_bf16 v[168:171], v[28:31], v[116:119], v[168:171]
    v_mfma_f32_16x16x32_bf16 v[172:175], v[28:31], v[124:127], v[172:175]
    v_mfma_f32_16x16x32_bf16 v[172:175], v[24:27], v[120:123], v[172:175]
    s_setprio 0
    v_cvt_pk_bf16_f32 v144, v144, v148
    v_cvt_pk_bf16_f32 v148, v145, v149
    v_cvt_pk_bf16_f32 v146, v146, v150
    v_cvt_pk_bf16_f32 v150, v147, v151
    v_cvt_pk_bf16_f32 v145, v152, v156
    v_cvt_pk_bf16_f32 v149, v153, v157
    v_cvt_pk_bf16_f32 v147, v154, v158
    v_cvt_pk_bf16_f32 v151, v155, v159
    s_waitcnt vmcnt(3)
    buffer_store_dwordx2 v[144:145], v6, s[16:19], s52 offen offset:0 sc1
    s_add_u32 s52, s52, 4096
    s_waitcnt vmcnt(3)
    buffer_store_dwordx2 v[148:149], v6, s[16:19], s52 offen offset:0 sc1
    s_add_u32 s52, s52, 4096
    s_waitcnt vmcnt(3)
    buffer_store_dwordx2 v[146:147], v6, s[16:19], s52 offen offset:0 sc1
    s_add_u32 s52, s52, 4096
    s_waitcnt vmcnt(3)
    buffer_store_dwordx2 v[150:151], v6, s[16:19], s52 offen offset:0 sc1
    s_add_u32 s52, s52, 4096
    s_setprio 3
    s_waitcnt lgkmcnt(2)
    v_mfma_f32_16x16x32_bf16 v[176:179], v[8:11], v[32:35], v[176:179]
    v_mfma_f32_16x16x32_bf16 v[176:179], v[12:15], v[36:39], v[176:179]
    ds_read_b128 v[24:27], v0 offset:36864
    v_mfma_f32_16x16x32_bf16 v[180:183], v[12:15], v[44:47], v[180:183]
    ds_read_b128 v[28:31], v0 offset:45056
    v_mfma_f32_16x16x32_bf16 v[180:183], v[8:11], v[40:43], v[180:183]
    v_mfma_f32_16x16x32_bf16 v[184:187], v[8:11], v[48:51], v[184:187]
    v_mfma_f32_16x16x32_bf16 v[184:187], v[12:15], v[52:55], v[184:187]
    v_mfma_f32_16x16x32_bf16 v[188:191], v[12:15], v[60:63], v[188:191]
    v_mfma_f32_16x16x32_bf16 v[188:191], v[8:11], v[56:59], v[188:191]
    s_waitcnt lgkmcnt(2)
    v_mfma_f32_16x16x32_bf16 v[176:179], v[16:19], v[96:99], v[176:179]
    v_mfma_f32_16x16x32_bf16 v[176:179], v[20:23], v[100:103], v[176:179]
    ds_read_b128 v[8:11], v0 offset:53248
    v_mfma_f32_16x16x32_bf16 v[180:183], v[20:23], v[108:111], v[180:183]
    ds_read_b128 v[12:15], v0 offset:61440
    v_mfma_f32_16x16x32_bf16 v[180:183], v[16:19], v[104:107], v[180:183]
    v_mfma_f32_16x16x32_bf16 v[184:187], v[16:19], v[112:115], v[184:187]
    v_mfma_f32_16x16x32_bf16 v[184:187], v[20:23], v[116:119], v[184:187]
    v_mfma_f32_16x16x32_bf16 v[188:191], v[20:23], v[124:127], v[188:191]
    v_mfma_f32_16x16x32_bf16 v[188:191], v[16:19], v[120:123], v[188:191]
    s_setprio 0
    v_cvt_pk_bf16_f32 v160, v160, v164
    v_cvt_pk_bf16_f32 v164, v161, v165
    v_cvt_pk_bf16_f32 v162, v162, v166
    v_cvt_pk_bf16_f32 v166, v163, v167
    v_cvt_pk_bf16_f32 v161, v168, v172
    v_cvt_pk_bf16_f32 v165, v169, v173
    v_cvt_pk_bf16_f32 v163, v170, v174
    v_cvt_pk_bf16_f32 v167, v171, v175
    s_waitcnt vmcnt(3)
    buffer_store_dwordx2 v[160:161], v6, s[16:19], s52 offen offset:0 sc1
    s_add_u32 s52, s52, 4096
    s_waitcnt vmcnt(3)
    buffer_store_dwordx2 v[164:165], v6, s[16:19], s52 offen offset:0 sc1
    s_add_u32 s52, s52, 4096
    s_waitcnt vmcnt(3)
    buffer_store_dwordx2 v[162:163], v6, s[16:19], s52 offen offset:0 sc1
    s_add_u32 s52, s52, 4096
    s_waitcnt vmcnt(3)
    buffer_store_dwordx2 v[166:167], v6, s[16:19], s52 offen offset:0 sc1
    s_add_u32 s52, s52, 4096
    s_setprio 3
    s_waitcnt lgkmcnt(2)
    v_mfma_f32_16x16x32_bf16 v[192:195], v[24:27], v[32:35], v[192:195]
    v_mfma_f32_16x16x32_bf16 v[192:195], v[28:31], v[36:39], v[192:195]
    ds_read_b128 v[16:19], v1 offset:37888
    v_mfma_f32_16x16x32_bf16 v[196:199], v[28:31], v[44:47], v[196:199]
    ds_read_b128 v[20:23], v1 offset:46080
    v_mfma_f32_16x16x32_bf16 v[196:199], v[24:27], v[40:43], v[196:199]
    v_mfma_f32_16x16x32_bf16 v[200:203], v[24:27], v[48:51], v[200:203]
    v_mfma_f32_16x16x32_bf16 v[200:203], v[28:31], v[52:55], v[200:203]
    v_mfma_f32_16x16x32_bf16 v[204:207], v[28:31], v[60:63], v[204:207]
    v_mfma_f32_16x16x32_bf16 v[204:207], v[24:27], v[56:59], v[204:207]
    s_waitcnt lgkmcnt(2)
    v_mfma_f32_16x16x32_bf16 v[192:195], v[8:11], v[96:99], v[192:195]
    v_mfma_f32_16x16x32_bf16 v[192:195], v[12:15], v[100:103], v[192:195]
    ds_read_b128 v[24:27], v1 offset:54272
    v_mfma_f32_16x16x32_bf16 v[196:199], v[12:15], v[108:111], v[196:199]
    ds_read_b128 v[28:31], v1 offset:62464
    v_mfma_f32_16x16x32_bf16 v[196:199], v[8:11], v[104:107], v[196:199]
    v_mfma_f32_16x16x32_bf16 v[200:203], v[8:11], v[112:115], v[200:203]
    v_mfma_f32_16x16x32_bf16 v[200:203], v[12:15], v[116:119], v[200:203]
    v_mfma_f32_16x16x32_bf16 v[204:207], v[12:15], v[124:127], v[204:207]
    v_mfma_f32_16x16x32_bf16 v[204:207], v[8:11], v[120:123], v[204:207]
    s_setprio 0
    v_cvt_pk_bf16_f32 v176, v176, v180
    v_cvt_pk_bf16_f32 v180, v177, v181
    v_cvt_pk_bf16_f32 v178, v178, v182
    v_cvt_pk_bf16_f32 v182, v179, v183
    v_cvt_pk_bf16_f32 v177, v184, v188
    v_cvt_pk_bf16_f32 v181, v185, v189
    v_cvt_pk_bf16_f32 v179, v186, v190
    v_cvt_pk_bf16_f32 v183, v187, v191
    s_waitcnt vmcnt(3)
    buffer_store_dwordx2 v[176:177], v6, s[16:19], s52 offen offset:0 sc1
    s_add_u32 s52, s52, 4096
    s_waitcnt vmcnt(3)
    buffer_store_dwordx2 v[180:181], v6, s[16:19], s52 offen offset:0 sc1
    s_add_u32 s52, s52, 4096
    s_waitcnt vmcnt(3)
    buffer_store_dwordx2 v[178:179], v6, s[16:19], s52 offen offset:0 sc1
    s_add_u32 s52, s52, 4096
    s_waitcnt vmcnt(3)
    buffer_store_dwordx2 v[182:183], v6, s[16:19], s52 offen offset:0 sc1
    s_add_u32 s52, s52, 4096
    s_setprio 3
    s_waitcnt lgkmcnt(2)
    v_mfma_f32_16x16x32_bf16 v[208:211], v[16:19], v[32:35], v[208:211]
    v_mfma_f32_16x16x32_bf16 v[208:211], v[20:23], v[36:39], v[208:211]
    ds_read_b128 v[8:11], v2 offset:38912
    v_mfma_f32_16x16x32_bf16 v[212:215], v[20:23], v[44:47], v[212:215]
    ds_read_b128 v[12:15], v2 offset:47104
    v_mfma_f32_16x16x32_bf16 v[212:215], v[16:19], v[40:43], v[212:215]
    v_mfma_f32_16x16x32_bf16 v[216:219], v[16:19], v[48:51], v[216:219]
    v_mfma_f32_16x16x32_bf16 v[216:219], v[20:23], v[52:55], v[216:219]
    v_mfma_f32_16x16x32_bf16 v[220:223], v[20:23], v[60:63], v[220:223]
    v_mfma_f32_16x16x32_bf16 v[220:223], v[16:19], v[56:59], v[220:223]
    s_waitcnt lgkmcnt(2)
    v_mfma_f32_16x16x32_bf16 v[208:211], v[24:27], v[96:99], v[208:211]
    v_mfma_f32_16x16x32_bf16 v[208:211], v[28:31], v[100:103], v[208:211]
    ds_read_b128 v[16:19], v2 offset:55296
    v_mfma_f32_16x16x32_bf16 v[212:215], v[28:31], v[108:111], v[212:215]
    ds_read_b128 v[20:23], v2 offset:63488
    v_mfma_f32_16x16x32_bf16 v[212:215], v[24:27], v[104:107], v[212:215]
    v_mfma_f32_16x16x32_bf16 v[216:219], v[24:27], v[112:115], v[216:219]
    v_mfma_f32_16x16x32_bf16 v[216:219], v[28:31], v[116:119], v[216:219]
    v_mfma_f32_16x16x32_bf16 v[220:223], v[28:31], v[124:127], v[220:223]
    v_mfma_f32_16x16x32_bf16 v[220:223], v[24:27], v[120:123], v[220:223]
    s_setprio 0
    v_cvt_pk_bf16_f32 v192, v192, v196
    v_cvt_pk_bf16_f32 v196, v193, v197
    v_cvt_pk_bf16_f32 v194, v194, v198
    v_cvt_pk_bf16_f32 v198, v195, v199
    v_cvt_pk_bf16_f32 v193, v200, v204
    v_cvt_pk_bf16_f32 v197, v201, v205
    v_cvt_pk_bf16_f32 v195, v202, v206
    v_cvt_pk_bf16_f32 v199, v203, v207
    s_waitcnt vmcnt(3)
    buffer_store_dwordx2 v[192:193], v6, s[16:19], s52 offen offset:0 sc1
    s_add_u32 s52, s52, 4096
    s_waitcnt vmcnt(3)
    buffer_store_dwordx2 v[196:197], v6, s[16:19], s52 offen offset:0 sc1
    s_add_u32 s52, s52, 4096
    s_waitcnt vmcnt(3)
    buffer_store_dwordx2 v[194:195], v6, s[16:19], s52 offen offset:0 sc1
    s_add_u32 s52, s52, 4096
    s_waitcnt vmcnt(3)
    buffer_store_dwordx2 v[198:199], v6, s[16:19], s52 offen offset:0 sc1
    s_add_u32 s52, s52, 4096
    s_setprio 3
    s_waitcnt lgkmcnt(2)
    v_mfma_f32_16x16x32_bf16 v[224:227], v[8:11], v[32:35], v[224:227]
    v_mfma_f32_16x16x32_bf16 v[224:227], v[12:15], v[36:39], v[224:227]
    ds_read_b128 v[24:27], v3 offset:39936
    v_mfma_f32_16x16x32_bf16 v[228:231], v[12:15], v[44:47], v[228:231]
    ds_read_b128 v[28:31], v3 offset:48128
    v_mfma_f32_16x16x32_bf16 v[228:231], v[8:11], v[40:43], v[228:231]
    v_mfma_f32_16x16x32_bf16 v[232:235], v[8:11], v[48:51], v[232:235]
    v_mfma_f32_16x16x32_bf16 v[232:235], v[12:15], v[52:55], v[232:235]
    v_mfma_f32_16x16x32_bf16 v[236:239], v[12:15], v[60:63], v[236:239]
    v_mfma_f32_16x16x32_bf16 v[236:239], v[8:11], v[56:59], v[236:239]
    s_waitcnt lgkmcnt(2)
    v_mfma_f32_16x16x32_bf16 v[224:227], v[16:19], v[96:99], v[224:227]
    v_mfma_f32_16x16x32_bf16 v[224:227], v[20:23], v[100:103], v[224:227]
    ds_read_b128 v[8:11], v3 offset:56320
    v_mfma_f32_16x16x32_bf16 v[228:231], v[20:23], v[108:111], v[228:231]
    ds_read_b128 v[12:15], v3 offset:64512
    v_mfma_f32_16x16x32_bf16 v[228:231], v[16:19], v[104:107], v[228:231]
    v_mfma_f32_16x16x32_bf16 v[232:235], v[16:19], v[112:115], v[232:235]
    v_mfma_f32_16x16x32_bf16 v[232:235], v[20:23], v[116:119], v[232:235]
    v_mfma_f32_16x16x32_bf16 v[236:239], v[20:23], v[124:127], v[236:239]
    v_mfma_f32_16x16x32_bf16 v[236:239], v[16:19], v[120:123], v[236:239]
    s_setprio 0
    v_cvt_pk_bf16_f32 v208, v208, v212
    v_cvt_pk_bf16_f32 v212, v209, v213
    v_cvt_pk_bf16_f32 v210, v210, v214
    v_cvt_pk_bf16_f32 v214, v211, v215
    v_cvt_pk_bf16_f32 v209, v216, v220
    v_cvt_pk_bf16_f32 v213, v217, v221
    v_cvt_pk_bf16_f32 v211, v218, v222
    v_cvt_pk_bf16_f32 v215, v219, v223
    s_waitcnt vmcnt(3)
    buffer_store_dwordx2 v[208:209], v6, s[16:19], s52 offen offset:0 sc1
    s_add_u32 s52, s52, 4096
    s_waitcnt vmcnt(3)
    buffer_store_dwordx2 v[212:213], v6, s[16:19], s52 offen offset:0 sc1
    s_add_u32 s52, s52, 4096
    s_waitcnt vmcnt(3)
    buffer_store_dwordx2 v[210:211], v6, s[16:19], s52 offen offset:0 sc1
    s_add_u32 s52, s52, 4096
    s_waitcnt vmcnt(3)
    buffer_store_dwordx2 v[214:215], v6, s[16:19], s52 offen offset:0 sc1
    s_add_u32 s52, s52, 4096
    s_setprio 3
    s_waitcnt lgkmcnt(2)
    v_mfma_f32_16x16x32_bf16 v[240:243], v[24:27], v[32:35], v[240:243]
    v_mfma_f32_16x16x32_bf16 v[240:243], v[28:31], v[36:39], v[240:243]
    v_mfma_f32_16x16x32_bf16 v[244:247], v[28:31], v[44:47], v[244:247]
    v_mfma_f32_16x16x32_bf16 v[244:247], v[24:27], v[40:43], v[244:247]
    v_mfma_f32_16x16x32_bf16 v[248:251], v[24:27], v[48:51], v[248:251]
    v_mfma_f32_16x16x32_bf16 v[248:251], v[28:31], v[52:55], v[248:251]
    v_mfma_f32_16x16x32_bf16 v[252:255], v[28:31], v[60:63], v[252:255]
    v_mfma_f32_16x16x32_bf16 v[252:255], v[24:27], v[56:59], v[252:255]
    s_waitcnt lgkmcnt(0)
    v_mfma_f32_16x16x32_bf16 v[240:243], v[8:11], v[96:99], v[240:243]
    v_mfma_f32_16x16x32_bf16 v[240:243], v[12:15], v[100:103], v[240:243]
    v_mfma_f32_16x16x32_bf16 v[244:247], v[12:15], v[108:111], v[244:247]
    v_mfma_f32_16x16x32_bf16 v[244:247], v[8:11], v[104:107], v[244:247]
    v_mfma_f32_16x16x32_bf16 v[248:251], v[8:11], v[112:115], v[248:251]
    v_mfma_f32_16x16x32_bf16 v[248:251], v[12:15], v[116:119], v[248:251]
    v_mfma_f32_16x16x32_bf16 v[252:255], v[12:15], v[124:127], v[252:255]
    v_mfma_f32_16x16x32_bf16 v[252:255], v[8:11], v[120:123], v[252:255]
    s_setprio 0
    s_setprio 0
    v_cvt_pk_bf16_f32 v224, v224, v228
    v_cvt_pk_bf16_f32 v228, v225, v229
    v_cvt_pk_bf16_f32 v226, v226, v230
    v_cvt_pk_bf16_f32 v230, v227, v231
    v_cvt_pk_bf16_f32 v225, v232, v236
    v_cvt_pk_bf16_f32 v229, v233, v237
    v_cvt_pk_bf16_f32 v227, v234, v238
    v_cvt_pk_bf16_f32 v231, v235, v239
    s_waitcnt vmcnt(3)
    buffer_store_dwordx2 v[224:225], v6, s[16:19], s52 offen offset:0 sc1
    s_add_u32 s52, s52, 4096
    s_waitcnt vmcnt(3)
    buffer_store_dwordx2 v[228:229], v6, s[16:19], s52 offen offset:0 sc1
    s_add_u32 s52, s52, 4096
    s_waitcnt vmcnt(3)
    buffer_store_dwordx2 v[226:227], v6, s[16:19], s52 offen offset:0 sc1
    s_add_u32 s52, s52, 4096
    s_waitcnt vmcnt(3)
    buffer_store_dwordx2 v[230:231], v6, s[16:19], s52 offen offset:0 sc1
    s_add_u32 s52, s52, 4096
    s_setprio 3
    s_setprio 0
    v_cvt_pk_bf16_f32 v240, v240, v244
    v_cvt_pk_bf16_f32 v244, v241, v245
    v_cvt_pk_bf16_f32 v242, v242, v246
    v_cvt_pk_bf16_f32 v246, v243, v247
    v_cvt_pk_bf16_f32 v241, v248, v252
    v_cvt_pk_bf16_f32 v245, v249, v253
    v_cvt_pk_bf16_f32 v243, v250, v254
    v_cvt_pk_bf16_f32 v247, v251, v255
    s_waitcnt vmcnt(3)
    buffer_store_dwordx2 v[240:241], v6, s[16:19], s52 offen offset:0 sc1
    s_add_u32 s52, s52, 4096
    s_waitcnt vmcnt(3)
    buffer_store_dwordx2 v[244:245], v6, s[16:19], s52 offen offset:0 sc1
    s_add_u32 s52, s52, 4096
    s_waitcnt vmcnt(3)
    buffer_store_dwordx2 v[242:243], v6, s[16:19], s52 offen offset:0 sc1
    s_add_u32 s52, s52, 4096
    s_waitcnt vmcnt(3)
    buffer_store_dwordx2 v[246:247], v6, s[16:19], s52 offen offset:0 sc1
    s_setprio 3
    s_branch L_end
L_G2_B:
    s_waitcnt lgkmcnt(2)
    v_mfma_f32_16x16x32_bf16 v[224:227], v[24:27], v[96:99], v[224:227]
    v_mfma_f32_16x16x32_bf16 v[224:227], v[28:31], v[100:103], v[224:227]
    ds_read_b128 v[16:19], v0 offset:16384
    v_mfma_f32_16x16x32_bf16 v[228:231], v[28:31], v[108:111], v[228:231]
    ds_read_b128 v[20:23], v0 offset:24576
    v_mfma_f32_16x16x32_bf16 v[228:231], v[24:27], v[104:107], v[228:231]
    v_mfma_f32_16x16x32_bf16 v[232:235], v[24:27], v[112:115], v[232:235]
    v_mfma_f32_16x16x32_bf16 v[232:235], v[28:31], v[116:119], v[232:235]
    v_mfma_f32_16x16x32_bf16 v[236:239], v[28:31], v[124:127], v[236:239]
    v_mfma_f32_16x16x32_bf16 v[236:239], v[24:27], v[120:123], v[236:239]
    s_waitcnt lgkmcnt(2)
    v_mfma_f32_16x16x32_bf16 v[240:243], v[8:11], v[96:99], v[240:243]
    v_mfma_f32_16x16x32_bf16 v[240:243], v[12:15], v[100:103], v[240:243]
    ds_read_b128 v[24:27], v0 offset:32768
    v_mfma_f32_16x16x32_bf16 v[244:247], v[12:15], v[108:111], v[244:247]
    ds_read_b128 v[28:31], v0 offset:40960
    v_mfma_f32_16x16x32_bf16 v[244:247], v[8:11], v[104:107], v[244:247]
    v_mfma_f32_16x16x32_bf16 v[248:251], v[8:11], v[112:115], v[248:251]
    v_mfma_f32_16x16x32_bf16 v[248:251], v[12:15], v[116:119], v[248:251]
    v_mfma_f32_16x16x32_bf16 v[252:255], v[12:15], v[124:127], v[252:255]
    v_mfma_f32_16x16x32_bf16 v[252:255], v[8:11], v[120:123], v[252:255]
    s_waitcnt vmcnt(8)
    s_waitcnt lgkmcnt(2)
    v_mfma_f32_16x16x32_bf16 v[128:131], v[16:19], v[64:67], v[128:131]
    ds_read_b128 v[96:99], v5 offset:0
    v_mfma_f32_16x16x32_bf16 v[128:131], v[20:23], v[68:71], v[128:131]
    ds_read_b128 v[8:11], v0 offset:49152
    v_mfma_f32_16x16x32_bf16 v[132:135], v[20:23], v[76:79], v[132:135]
    ds_read_b128 v[12:15], v0 offset:57344
    v_mfma_f32_16x16x32_bf16 v[132:135], v[16:19], v[72:75], v[132:135]
    ds_read_b128 v[100:103], v5 offset:1024
    v_mfma_f32_16x16x32_bf16 v[136:139], v[16:19], v[80:83], v[136:139]
    ds_read_b128 v[104:107], v5 offset:2048
    v_mfma_f32_16x16x32_bf16 v[136:139], v[20:23], v[84:87], v[136:139]
    ds_read_b128 v[108:111], v5 offset:3072
    v_mfma_f32_16x16x32_bf16 v[140:143], v[20:23], v[92:95], v[140:143]
    v_mfma_f32_16x16x32_bf16 v[140:143], v[16:19], v[88:91], v[140:143]
    s_waitcnt vmcnt(0)
    s_waitcnt lgkmcnt(6)
    v_mfma_f32_16x16x32_bf16 v[128:131], v[24:27], v[32:35], v[128:131]
    ds_read_b128 v[112:115], v5 offset:4096
    v_mfma_f32_16x16x32_bf16 v[128:131], v[28:31], v[36:39], v[128:131]
    ds_read_b128 v[16:19], v1 offset:17408
    v_mfma_f32_16x16x32_bf16 v[132:135], v[28:31], v[44:47], v[132:135]
    ds_read_b128 v[20:23], v1 offset:25600
    v_mfma_f32_16x16x32_bf16 v[132:135], v[24:27], v[40:43], v[132:135]
    ds_read_b128 v[116:119], v5 offset:5120
    v_mfma_f32_16x16x32_bf16 v[136:139], v[24:27], v[48:51], v[136:139]
    ds_read_b128 v[120:123], v5 offset:6144
    v_mfma_f32_16x16x32_bf16 v[136:139], v[28:31], v[52:55], v[136:139]
    ds_read_b128 v[124:127], v5 offset:7168
    v_mfma_f32_16x16x32_bf16 v[140:143], v[28:31], v[60:63], v[140:143]
    v_mfma_f32_16x16x32_bf16 v[140:143], v[24:27], v[56:59], v[140:143]
    s_waitcnt lgkmcnt(9)
    s_waitcnt lgkmcnt(0)
    v_mfma_f32_16x16x32_bf16 v[128:131], v[8:11], v[96:99], v[128:131]
    v_mfma_f32_16x16x32_bf16 v[128:131], v[12:15], v[100:103], v[128:131]
    ds_read_b128 v[24:27], v1 offset:33792
    v_mfma_f32_16x16x32_bf16 v[132:135], v[12:15], v[108:111], v[132:135]
    ds_read_b128 v[28:31], v1 offset:41984
    v_mfma_f32_16x16x32_bf16 v[132:135], v[8:11], v[104:107], v[132:135]
    v_mfma_f32_16x16x32_bf16 v[136:139], v[8:11], v[112:115], v[136:139]
    v_mfma_f32_16x16x32_bf16 v[136:139], v[12:15], v[116:119], v[136:139]
    v_mfma_f32_16x16x32_bf16 v[140:143], v[12:15], v[124:127], v[140:143]
    v_mfma_f32_16x16x32_bf16 v[140:143], v[8:11], v[120:123], v[140:143]
    v_mfma_f32_16x16x32_bf16 v[144:147], v[16:19], v[64:67], v[144:147]
    v_mfma_f32_16x16x32_bf16 v[144:147], v[20:23], v[68:71], v[144:147]
    ds_read_b128 v[8:11], v1 offset:50176
    v_mfma_f32_16x16x32_bf16 v[148:151], v[20:23], v[76:79], v[148:151]
    ds_read_b128 v[12:15], v1 offset:58368
    v_cvt_pk_bf16_f32 v128, v128, v132
    v_cvt_pk_bf16_f32 v132, v129, v133
    v_mfma_f32_16x16x32_bf16 v[148:151], v[16:19], v[72:75], v[148:151]
    v_cvt_pk_bf16_f32 v130, v130, v134
    v_cvt_pk_bf16_f32 v134, v131, v135
    v_mfma_f32_16x16x32_bf16 v[152:155], v[16:19], v[80:83], v[152:155]
    v_cvt_pk_bf16_f32 v129, v136, v140
    v_cvt_pk_bf16_f32 v133, v137, v141
    v_mfma_f32_16x16x32_bf16 v[152:155], v[20:23], v[84:87], v[152:155]
    buffer_store_dwordx2 v[128:129], v6, s[16:19], s52 offen offset:0 sc1
    s_add_u32 s52, s52, 4096
    v_mfma_f32_16x16x32_bf16 v[156:159], v[20:23], v[92:95], v[156:159]
    v_cvt_pk_bf16_f32 v131, v138, v142
    v_cvt_pk_bf16_f32 v135, v139, v143
    v_mfma_f32_16x16x32_bf16 v[156:159], v[16:19], v[88:91], v[156:159]
    buffer_store_dwordx2 v[132:133], v6, s[16:19], s52 offen offset:0 sc1
    s_add_u32 s52, s52, 4096
    s_waitcnt lgkmcnt(2)
    v_mfma_f32_16x16x32_bf16 v[144:147], v[24:27], v[32:35], v[144:147]
    v_mfma_f32_16x16x32_bf16 v[144:147], v[28:31], v[36:39], v[144:147]
    ds_read_b128 v[16:19], v2 offset:18432
    v_mfma_f32_16x16x32_bf16 v[148:151], v[28:31], v[44:47], v[148:151]
    ds_read_b128 v[20:23], v2 offset:26624
    buffer_store_dwordx2 v[130:131], v6, s[16:19], s52 offen offset:0 sc1
    s_add_u32 s52, s52, 4096
    v_mfma_f32_16x16x32_bf16 v[148:151], v[24:27], v[40:43], v[148:151]
    buffer_store_dwordx2 v[134:135], v6, s[16:19], s52 offen offset:0 sc1
    s_add_u32 s52, s52, 4096
    v_mfma_f32_16x16x32_bf16 v[152:155], v[24:27], v[48:51], v[152:155]
    v_mfma_f32_16x16x32_bf16 v[152:155], v[28:31], v[52:55], v[152:155]
    v_mfma_f32_16x16x32_bf16 v[156:159], v[28:31], v[60:63], v[156:159]
    v_mfma_f32_16x16x32_bf16 v[156:159], v[24:27], v[56:59], v[156:159]
    s_waitcnt lgkmcnt(2)
    v_mfma_f32_16x16x32_bf16 v[144:147], v[8:11], v[96:99], v[144:147]
    v_mfma_f32_16x16x32_bf16 v[144:147], v[12:15], v[100:103], v[144:147]
    ds_read_b128 v[24:27], v2 offset:34816
    v_mfma_f32_16x16x32_bf16 v[148:151], v[12:15], v[108:111], v[148:151]
    ds_read_b128 v[28:31], v2 offset:43008
    v_mfma_f32_16x16x32_bf16 v[148:151], v[8:11], v[104:107], v[148:151]
    v_mfma_f32_16x16x32_bf16 v[152:155], v[8:11], v[112:115], v[152:155]
    v_mfma_f32_16x16x32_bf16 v[152:155], v[12:15], v[116:119], v[152:155]
    v_mfma_f32_16x16x32_bf16 v[156:159], v[12:15], v[124:127], v[156:159]
    v_mfma_f32_16x16x32_bf16 v[156:159], v[8:11], v[120:123], v[156:159]
    s_waitcnt lgkmcnt(2)
    v_mfma_f32_16x16x32_bf16 v[160:163], v[16:19], v[64:67], v[160:163]
    v_mfma_f32_16x16x32_bf16 v[160:163], v[20:23], v[68:71], v[160:163]
    ds_read_b128 v[8:11], v2 offset:51200
    v_mfma_f32_16x16x32_bf16 v[164:167], v[20:23], v[76:79], v[164:167]
    ds_read_b128 v[12:15], v2 offset:59392
    v_cvt_pk_bf16_f32 v144, v144, v148
    v_cvt_pk_bf16_f32 v148, v145, v149
    v_mfma_f32_16x16x32_bf16 v[164:167], v[16:19], v[72:75], v[164:167]
    v_cvt_pk_bf16_f32 v146, v146, v150
    v_cvt_pk_bf16_f32 v150, v147, v151
    v_mfma_f32_16x16x32_bf16 v[168:171], v[16:19], v[80:83], v[168:171]
    v_cvt_pk_bf16_f32 v145, v152, v156
    v_cvt_pk_bf16_f32 v149, v153, v157
    v_mfma_f32_16x16x32_bf16 v[168:171], v[20:23], v[84:87], v[168:171]
    buffer_store_dwordx2 v[144:145], v6, s[16:19], s52 offen offset:0 sc1
    s_add_u32 s52, s52, 4096
    v_mfma_f32_16x16x32_bf16 v[172:175], v[20:23], v[92:95], v[172:175]
    v_cvt_pk_bf16_f32 v147, v154, v158
    v_cvt_pk_bf16_f32 v151, v155, v159
    v_mfma_f32_16x16x32_bf16 v[172:175], v[16:19], v[88:91], v[172:175]
    buffer_store_dwordx2 v[148:149], v6, s[16:19], s52 offen offset:0 sc1
    s_add_u32 s52, s52, 4096
    s_waitcnt lgkmcnt(2)
    v_mfma_f32_16x16x32_bf16 v[160:163], v[24:27], v[32:35], v[160:163]
    v_mfma_f32_16x16x32_bf16 v[160:163], v[28:31], v[36:39], v[160:163]
    ds_read_b128 v[16:19], v3 offset:19456
    v_mfma_f32_16x16x32_bf16 v[164:167], v[28:31], v[44:47], v[164:167]
    ds_read_b128 v[20:23], v3 offset:27648
    buffer_store_dwordx2 v[146:147], v6, s[16:19], s52 offen offset:0 sc1
    s_add_u32 s52, s52, 4096
    v_mfma_f32_16x16x32_bf16 v[164:167], v[24:27], v[40:43], v[164:167]
    buffer_store_dwordx2 v[150:151], v6, s[16:19], s52 offen offset:0 sc1
    s_add_u32 s52, s52, 4096
    v_mfma_f32_16x16x32_bf16 v[168:171], v[24:27], v[48:51], v[168:171]
    v_mfma_f32_16x16x32_bf16 v[168:171], v[28:31], v[52:55], v[168:171]
    v_mfma_f32_16x16x32_bf16 v[172:175], v[28:31], v[60:63], v[172:175]
    v_mfma_f32_16x16x32_bf16 v[172:175], v[24:27], v[56:59], v[172:175]
    s_waitcnt lgkmcnt(2)
    v_mfma_f32_16x16x32_bf16 v[160:163], v[8:11], v[96:99], v[160:163]
    v_mfma_f32_16x16x32_bf16 v[160:163], v[12:15], v[100:103], v[160:163]
    ds_read_b128 v[24:27], v3 offset:35840
    v_mfma_f32_16x16x32_bf16 v[164:167], v[12:15], v[108:111], v[164:167]
    ds_read_b128 v[28:31], v3 offset:44032
    v_mfma_f32_16x16x32_bf16 v[164:167], v[8:11], v[104:107], v[164:167]
    v_mfma_f32_16x16x32_bf16 v[168:171], v[8:11], v[112:115], v[168:171]
    v_mfma_f32_16x16x32_bf16 v[168:171], v[12:15], v[116:119], v[168:171]
    v_mfma_f32_16x16x32_bf16 v[172:175], v[12:15], v[124:127], v[172:175]
    v_mfma_f32_16x16x32_bf16 v[172:175], v[8:11], v[120:123], v[172:175]
    s_waitcnt lgkmcnt(2)
    v_mfma_f32_16x16x32_bf16 v[176:179], v[16:19], v[64:67], v[176:179]
    v_mfma_f32_16x16x32_bf16 v[176:179], v[20:23], v[68:71], v[176:179]
    ds_read_b128 v[8:11], v3 offset:52224
    v_mfma_f32_16x16x32_bf16 v[180:183], v[20:23], v[76:79], v[180:183]
    ds_read_b128 v[12:15], v3 offset:60416
    v_cvt_pk_bf16_f32 v160, v160, v164
    v_cvt_pk_bf16_f32 v164, v161, v165
    v_mfma_f32_16x16x32_bf16 v[180:183], v[16:19], v[72:75], v[180:183]
    v_cvt_pk_bf16_f32 v162, v162, v166
    v_cvt_pk_bf16_f32 v166, v163, v167
    v_mfma_f32_16x16x32_bf16 v[184:187], v[16:19], v[80:83], v[184:187]
    v_cvt_pk_bf16_f32 v161, v168, v172
    v_cvt_pk_bf16_f32 v165, v169, v173
    v_mfma_f32_16x16x32_bf16 v[184:187], v[20:23], v[84:87], v[184:187]
    buffer_store_dwordx2 v[160:161], v6, s[16:19], s52 offen offset:0 sc1
    s_add_u32 s52, s52, 4096
    v_mfma_f32_16x16x32_bf16 v[188:191], v[20:23], v[92:95], v[188:191]
    v_cvt_pk_bf16_f32 v163, v170, v174
    v_cvt_pk_bf16_f32 v167, v171, v175
    v_mfma_f32_16x16x32_bf16 v[188:191], v[16:19], v[88:91], v[188:191]
    buffer_store_dwordx2 v[164:165], v6, s[16:19], s52 offen offset:0 sc1
    s_add_u32 s52, s52, 4096
    s_waitcnt lgkmcnt(2)
    v_mfma_f32_16x16x32_bf16 v[176:179], v[24:27], v[32:35], v[176:179]
    v_mfma_f32_16x16x32_bf16 v[176:179], v[28:31], v[36:39], v[176:179]
    ds_read_b128 v[16:19], v0 offset:20480
    v_mfma_f32_16x16x32_bf16 v[180:183], v[28:31], v[44:47], v[180:183]
    ds_read_b128 v[20:23], v0 offset:28672
    buffer_store_dwordx2 v[162:163], v6, s[16:19], s52 offen offset:0 sc1
    s_add_u32 s52, s52, 4096
    v_mfma_f32_16x16x32_bf16 v[180:183], v[24:27], v[40:43], v[180:183]
    buffer_store_dwordx2 v[166:167], v6, s[16:19], s52 offen offset:0 sc1
    s_add_u32 s52, s52, 4096
    v_mfma_f32_16x16x32_bf16 v[184:187], v[24:27], v[48:51], v[184:187]
    v_mfma_f32_16x16x32_bf16 v[184:187], v[28:31], v[52:55], v[184:187]
    v_mfma_f32_16x16x32_bf16 v[188:191], v[28:31], v[60:63], v[188:191]
    v_mfma_f32_16x16x32_bf16 v[188:191], v[24:27], v[56:59], v[188:191]
    s_waitcnt lgkmcnt(2)
    v_mfma_f32_16x16x32_bf16 v[176:179], v[8:11], v[96:99], v[176:179]
    v_mfma_f32_16x16x32_bf16 v[176:179], v[12:15], v[100:103], v[176:179]
    ds_read_b128 v[24:27], v0 offset:36864
    v_mfma_f32_16x16x32_bf16 v[180:183], v[12:15], v[108:111], v[180:183]
    ds_read_b128 v[28:31], v0 offset:45056
    v_mfma_f32_16x16x32_bf16 v[180:183], v[8:11], v[104:107], v[180:183]
    v_mfma_f32_16x16x32_bf16 v[184:187], v[8:11], v[112:115], v[184:187]
    v_mfma_f32_16x16x32_bf16 v[184:187], v[12:15], v[116:119], v[184:187]
    v_mfma_f32_16x16x32_bf16 v[188:191], v[12:15], v[124:127], v[188:191]
    v_mfma_f32_16x16x32_bf16 v[188:191], v[8:11], v[120:123], v[188:191]
    s_waitcnt lgkmcnt(2)
    v_mfma_f32_16x16x32_bf16 v[192:195], v[16:19], v[64:67], v[192:195]
    v_mfma_f32_16x16x32_bf16 v[192:195], v[20:23], v[68:71], v[192:195]
    ds_read_b128 v[8:11], v0 offset:53248
    v_mfma_f32_16x16x32_bf16 v[196:199], v[20:23], v[76:79], v[196:199]
    ds_read_b128 v[12:15], v0 offset:61440
    v_cvt_pk_bf16_f32 v176, v176, v180
    v_cvt_pk_bf16_f32 v180, v177, v181
    v_mfma_f32_16x16x32_bf16 v[196:199], v[16:19], v[72:75], v[196:199]
    v_cvt_pk_bf16_f32 v178, v178, v182
    v_cvt_pk_bf16_f32 v182, v179, v183
    v_mfma_f32_16x16x32_bf16 v[200:203], v[16:19], v[80:83], v[200:203]
    v_cvt_pk_bf16_f32 v177, v184, v188
    v_cvt_pk_bf16_f32 v181, v185, v189
    v_mfma_f32_16x16x32_bf16 v[200:203], v[20:23], v[84:87], v[200:203]
    buffer_store_dwordx2 v[176:177], v6, s[16:19], s52 offen offset:0 sc1
    s_add_u32 s52, s52, 4096
    v_mfma_f32_16x16x32_bf16 v[204:207], v[20:23], v[92:95], v[204:207]
    v_cvt_pk_bf16_f32 v179, v186, v190
    v_cvt_pk_bf16_f32 v183, v187, v191
    v_mfma_f32_16x16x32_bf16 v[204:207], v[16:19], v[88:91], v[204:207]
    buffer_store_dwordx2 v[180:181], v6, s[16:19], s52 offen offset:0 sc1
    s_add_u32 s52, s52, 4096
    s_waitcnt lgkmcnt(2)
    v_mfma_f32_16x16x32_bf16 v[192:195], v[24:27], v[32:35], v[192:195]
    v_mfma_f32_16x16x32_bf16 v[192:195], v[28:31], v[36:39], v[192:195]
    ds_read_b128 v[16:19], v1 offset:21504
    v_mfma_f32_16x16x32_bf16 v[196:199], v[28:31], v[44:47], v[196:199]
    ds_read_b128 v[20:23], v1 offset:29696
    buffer_store_dwordx2 v[178:179], v6, s[16:19], s52 offen offset:0 sc1
    s_add_u32 s52, s52, 4096
    v_mfma_f32_16x16x32_bf16 v[196:199], v[24:27], v[40:43], v[196:199]
    buffer_store_dwordx2 v[182:183], v6, s[16:19], s52 offen offset:0 sc1
    s_add_u32 s52, s52, 4096
    v_mfma_f32_16x16x32_bf16 v[200:203], v[24:27], v[48:51], v[200:203]
    v_mfma_f32_16x16x32_bf16 v[200:203], v[28:31], v[52:55], v[200:203]
    v_mfma_f32_16x16x32_bf16 v[204:207], v[28:31], v[60:63], v[204:207]
    v_mfma_f32_16x16x32_bf16 v[204:207], v[24:27], v[56:59], v[204:207]
    s_waitcnt lgkmcnt(2)
    v_mfma_f32_16x16x32_bf16 v[192:195], v[8:11], v[96:99], v[192:195]
    v_mfma_f32_16x16x32_bf16 v[192:195], v[12:15], v[100:103], v[192:195]
    ds_read_b128 v[24:27], v1 offset:37888
    v_mfma_f32_16x16x32_bf16 v[196:199], v[12:15], v[108:111], v[196:199]
    ds_read_b128 v[28:31], v1 offset:46080
    v_mfma_f32_16x16x32_bf16 v[196:199], v[8:11], v[104:107], v[196:199]
    v_mfma_f32_16x16x32_bf16 v[200:203], v[8:11], v[112:115], v[200:203]
    v_mfma_f32_16x16x32_bf16 v[200:203], v[12:15], v[116:119], v[200:203]
    v_mfma_f32_16x16x32_bf16 v[204:207], v[12:15], v[124:127], v[204:207]
    v_mfma_f32_16x16x32_bf16 v[204:207], v[8:11], v[120:123], v[204:207]
    s_waitcnt lgkmcnt(2)
    v_mfma_f32_16x16x32_bf16 v[208:211], v[16:19], v[64:67], v[208:211]
    v_mfma_f32_16x16x32_bf16 v[208:211], v[20:23], v[68:71], v[208:211]
    ds_read_b128 v[8:11], v1 offset:54272
    v_mfma_f32_16x16x32_bf16 v[212:215], v[20:23], v[76:79], v[212:215]
    ds_read_b128 v[12:15], v1 offset:62464
    v_cvt_pk_bf16_f32 v192, v192, v196
    v_cvt_pk_bf16_f32 v196, v193, v197
    v_mfma_f32_16x16x32_bf16 v[212:215], v[16:19], v[72:75], v[212:215]
    v_cvt_pk_bf16_f32 v194, v194, v198
    v_cvt_pk_bf16_f32 v198, v195, v199
    v_mfma_f32_16x16x32_bf16 v[216:219], v[16:19], v[80:83], v[216:219]
    v_cvt_pk_bf16_f32 v193, v200, v204
    v_cvt_pk_bf16_f32 v197, v201, v205
    v_mfma_f32_16x16x32_bf16 v[216:219], v[20:23], v[84:87], v[216:219]
    buffer_store_dwordx2 v[192:193], v6, s[16:19], s52 offen offset:0 sc1
    s_add_u32 s52, s52, 4096
    v_mfma_f32_16x16x32_bf16 v[220:223], v[20:23], v[92:95], v[220:223]
    v_cvt_pk_bf16_f32 v195, v202, v206
    v_cvt_pk_bf16_f32 v199, v203, v207
    v_mfma_f32_16x16x32_bf16 v[220:223], v[16:19], v[88:91], v[220:223]
    buffer_store_dwordx2 v[196:197], v6, s[16:19], s52 offen offset:0 sc1
    s_add_u32 s52, s52, 4096
    s_waitcnt lgkmcnt(2)
    v_mfma_f32_16x16x32_bf16 v[208:211], v[24:27], v[32:35], v[208:211]
    v_mfma_f32_16x16x32_bf16 v[208:211], v[28:31], v[36:39], v[208:211]
    ds_read_b128 v[16:19], v2 offset:22528
    v_mfma_f32_16x16x32_bf16 v[212:215], v[28:31], v[44:47], v[212:215]
    ds_read_b128 v[20:23], v2 offset:30720
    buffer_store_dwordx2 v[194:195], v6, s[16:19], s52 offen offset:0 sc1
    s_add_u32 s52, s52, 4096
    v_mfma_f32_16x16x32_bf16 v[212:215], v[24:27], v[40:43], v[212:215]
    buffer_store_dwordx2 v[198:199], v6, s[16:19], s52 offen offset:0 sc1
    s_add_u32 s52, s52, 4096
    v_mfma_f32_16x16x32_bf16 v[216:219], v[24:27], v[48:51], v[216:219]
    v_mfma_f32_16x16x32_bf16 v[216:219], v[28:31], v[52:55], v[216:219]
    v_mfma_f32_16x16x32_bf16 v[220:223], v[28:31], v[60:63], v[220:223]
    v_mfma_f32_16x16x32_bf16 v[220:223], v[24:27], v[56:59], v[220:223]
    s_waitcnt lgkmcnt(2)
    v_mfma_f32_16x16x32_bf16 v[208:211], v[8:11], v[96:99], v[208:211]
    v_mfma_f32_16x16x32_bf16 v[208:211], v[12:15], v[100:103], v[208:211]
    ds_read_b128 v[24:27], v2 offset:38912
    v_mfma_f32_16x16x32_bf16 v[212:215], v[12:15], v[108:111], v[212:215]
    ds_read_b128 v[28:31], v2 offset:47104
    v_mfma_f32_16x16x32_bf16 v[212:215], v[8:11], v[104:107], v[212:215]
    v_mfma_f32_16x16x32_bf16 v[216:219], v[8:11], v[112:115], v[216:219]
    v_mfma_f32_16x16x32_bf16 v[216:219], v[12:15], v[116:119], v[216:219]
    v_mfma_f32_16x16x32_bf16 v[220:223], v[12:15], v[124:127], v[220:223]
    v_mfma_f32_16x16x32_bf16 v[220:223], v[8:11], v[120:123], v[220:223]
    s_waitcnt lgkmcnt(2)
    v_mfma_f32_16x16x32_bf16 v[224:227], v[16:19], v[64:67], v[224:227]
    v_mfma_f32_16x16x32_bf16 v[224:227], v[20:23], v[68:71], v[224:227]
    ds_read_b128 v[8:11], v2 offset:55296
    v_mfma_f32_16x16x32_bf16 v[228:231], v[20:23], v[76:79], v[228:231]
    ds_read_b128 v[12:15], v2 offset:63488
    v_cvt_pk_bf16_f32 v208, v208, v212
    v_cvt_pk_bf16_f32 v212, v209, v213
    v_mfma_f32_16x16x32_bf16 v[228:231], v[16:19], v[72:75], v[228:231]
    v_cvt_pk_bf16_f32 v210, v210, v214
    v_cvt_pk_bf16_f32 v214, v211, v215
    v_mfma_f32_16x16x32_bf16 v[232:235], v[16:19], v[80:83], v[232:235]
    v_cvt_pk_bf16_f32 v209, v216, v220
    v_cvt_pk_bf16_f32 v213, v217, v221
    v_mfma_f32_16x16x32_bf16 v[232:235], v[20:23], v[84:87], v[232:235]
    buffer_store_dwordx2 v[208:209], v6, s[16:19], s52 offen offset:0 sc1
    s_add_u32 s52, s52, 4096
    v_mfma_f32_16x16x32_bf16 v[236:239], v[20:23], v[92:95], v[236:239]
    v_cvt_pk_bf16_f32 v211, v218, v222
    v_cvt_pk_bf16_f32 v215, v219, v223
    v_mfma_f32_16x16x32_bf16 v[236:239], v[16:19], v[88:91], v[236:239]
    buffer_store_dwordx2 v[212:213], v6, s[16:19], s52 offen offset:0 sc1
    s_add_u32 s52, s52, 4096
    s_waitcnt lgkmcnt(2)
    v_mfma_f32_16x16x32_bf16 v[224:227], v[24:27], v[32:35], v[224:227]
    v_mfma_f32_16x16x32_bf16 v[224:227], v[28:31], v[36:39], v[224:227]
    ds_read_b128 v[16:19], v3 offset:23552
    v_mfma_f32_16x16x32_bf16 v[228:231], v[28:31], v[44:47], v[228:231]
    ds_read_b128 v[20:23], v3 offset:31744
    buffer_store_dwordx2 v[210:211], v6, s[16:19], s52 offen offset:0 sc1
    s_add_u32 s52, s52, 4096
    v_mfma_f32_16x16x32_bf16 v[228:231], v[24:27], v[40:43], v[228:231]
    buffer_store_dwordx2 v[214:215], v6, s[16:19], s52 offen offset:0 sc1
    s_add_u32 s52, s52, 4096
    v_mfma_f32_16x16x32_bf16 v[232:235], v[24:27], v[48:51], v[232:235]
    v_mfma_f32_16x16x32_bf16 v[232:235], v[28:31], v[52:55], v[232:235]
    v_mfma_f32_16x16x32_bf16 v[236:239], v[28:31], v[60:63], v[236:239]
    v_mfma_f32_16x16x32_bf16 v[236:239], v[24:27], v[56:59], v[236:239]
    s_waitcnt lgkmcnt(2)
    v_mfma_f32_16x16x32_bf16 v[224:227], v[8:11], v[96:99], v[224:227]
    v_mfma_f32_16x16x32_bf16 v[224:227], v[12:15], v[100:103], v[224:227]
    ds_read_b128 v[24:27], v3 offset:39936
    v_mfma_f32_16x16x32_bf16 v[228:231], v[12:15], v[108:111], v[228:231]
    ds_read_b128 v[28:31], v3 offset:48128
    v_mfma_f32_16x16x32_bf16 v[228:231], v[8:11], v[104:107], v[228:231]
    v_mfma_f32_16x16x32_bf16 v[232:235], v[8:11], v[112:115], v[232:235]
    v_mfma_f32_16x16x32_bf16 v[232:235], v[12:15], v[116:119], v[232:235]
    v_mfma_f32_16x16x32_bf16 v[236:239], v[12:15], v[124:127], v[236:239]
    v_mfma_f32_16x16x32_bf16 v[236:239], v[8:11], v[120:123], v[236:239]
    s_waitcnt lgkmcnt(2)
    v_mfma_f32_16x16x32_bf16 v[240:243], v[16:19], v[64:67], v[240:243]
    v_mfma_f32_16x16x32_bf16 v[240:243], v[20:23], v[68:71], v[240:243]
    ds_read_b128 v[8:11], v3 offset:56320
    v_mfma_f32_16x16x32_bf16 v[244:247], v[20:23], v[76:79], v[244:247]
    ds_read_b128 v[12:15], v3 offset:64512
    v_cvt_pk_bf16_f32 v224, v224, v228
    v_cvt_pk_bf16_f32 v228, v225, v229
    v_mfma_f32_16x16x32_bf16 v[244:247], v[16:19], v[72:75], v[244:247]
    v_cvt_pk_bf16_f32 v226, v226, v230
    v_cvt_pk_bf16_f32 v230, v227, v231
    v_mfma_f32_16x16x32_bf16 v[248:251], v[16:19], v[80:83], v[248:251]
    v_cvt_pk_bf16_f32 v225, v232, v236
    v_cvt_pk_bf16_f32 v229, v233, v237
    v_mfma_f32_16x16x32_bf16 v[248:251], v[20:23], v[84:87], v[248:251]
    buffer_store_dwordx2 v[224:225], v6, s[16:19], s52 offen offset:0 sc1
    s_add_u32 s52, s52, 4096
    v_mfma_f32_16x16x32_bf16 v[252:255], v[20:23], v[92:95], v[252:255]
    v_cvt_pk_bf16_f32 v227, v234, v238
    v_cvt_pk_bf16_f32 v231, v235, v239
    v_mfma_f32_16x16x32_bf16 v[252:255], v[16:19], v[88:91], v[252:255]
    buffer_store_dwordx2 v[228:229], v6, s[16:19], s52 offen offset:0 sc1
    s_add_u32 s52, s52, 4096
    s_waitcnt lgkmcnt(2)
    v_mfma_f32_16x16x32_bf16 v[240:243], v[24:27], v[32:35], v[240:243]
    v_mfma_f32_16x16x32_bf16 v[240:243], v[28:31], v[36:39], v[240:243]
    v_mfma_f32_16x16x32_bf16 v[244:247], v[28:31], v[44:47], v[244:247]
    buffer_store_dwordx2 v[226:227], v6, s[16:19], s52 offen offset:0 sc1
    s_add_u32 s52, s52, 4096
    v_mfma_f32_16x16x32_bf16 v[244:247], v[24:27], v[40:43], v[244:247]
    buffer_store_dwordx2 v[230:231], v6, s[16:19], s52 offen offset:0 sc1
    s_add_u32 s52, s52, 4096
    v_mfma_f32_16x16x32_bf16 v[248:251], v[24:27], v[48:51], v[248:251]
    v_mfma_f32_16x16x32_bf16 v[248:251], v[28:31], v[52:55], v[248:251]
    v_mfma_f32_16x16x32_bf16 v[252:255], v[28:31], v[60:63], v[252:255]
    v_mfma_f32_16x16x32_bf16 v[252:255], v[24:27], v[56:59], v[252:255]
    s_waitcnt lgkmcnt(0)
    v_mfma_f32_16x16x32_bf16 v[240:243], v[8:11], v[96:99], v[240:243]
    v_mfma_f32_16x16x32_bf16 v[240:243], v[12:15], v[100:103], v[240:243]
    v_mfma_f32_16x16x32_bf16 v[244:247], v[12:15], v[108:111], v[244:247]
    v_mfma_f32_16x16x32_bf16 v[244:247], v[8:11], v[104:107], v[244:247]
    v_mfma_f32_16x16x32_bf16 v[248:251], v[8:11], v[112:115], v[248:251]
    v_mfma_f32_16x16x32_bf16 v[248:251], v[12:15], v[116:119], v[248:251]
    v_mfma_f32_16x16x32_bf16 v[252:255], v[12:15], v[124:127], v[252:255]
    v_mfma_f32_16x16x32_bf16 v[252:255], v[8:11], v[120:123], v[252:255]
    s_setprio 0
    s_nop 2
    v_cvt_pk_bf16_f32 v240, v240, v244
    v_cvt_pk_bf16_f32 v244, v241, v245
    v_cvt_pk_bf16_f32 v242, v242, v246
    v_cvt_pk_bf16_f32 v246, v243, v247
    v_cvt_pk_bf16_f32 v241, v248, v252
    v_cvt_pk_bf16_f32 v245, v249, v253
    v_cvt_pk_bf16_f32 v243, v250, v254
    v_cvt_pk_bf16_f32 v247, v251, v255
    buffer_store_dwordx2 v[240:241], v6, s[16:19], s52 offen offset:0 sc1
    s_add_u32 s52, s52, 4096
    buffer_store_dwordx2 v[244:245], v6, s[16:19], s52 offen offset:0 sc1
    s_add_u32 s52, s52, 4096
    buffer_store_dwordx2 v[242:243], v6, s[16:19], s52 offen offset:0 sc1
    s_add_u32 s52, s52, 4096
    buffer_store_dwordx2 v[246:247], v6, s[16:19], s52 offen offset:0 sc1
L_end:
    s_endpgm
L_E1:
    s_add_u32 s54, s39, 4096
    s_mov_b32 s53, s51
    s_add_u32 s52, s53, 1024
    v_mbcnt_lo_u32_b32 v92, -1, 0
    v_mbcnt_hi_u32_b32 v92, -1, v92
    s_lshl_b32 s100, s33, 4
    s_add_u32 s100, s100, s34
    s_lshl_b32 s100, s100, 13
    v_and_b32 v4, 55, v92
    v_lshl_add_u32 v4, v4, 4, s100
    v_bfe_u32 v93, v92, 1, 3
    v_lshl_add_u32 v4, v93, 10, v4
    v_and_b32 v93, 1, v92
    v_lshl_add_u32 v4, v93, 7, v4
    v_subrev_u32 v0, 0x10000, v0
    v_subrev_u32 v1, 0x10000, v1
    v_subrev_u32 v2, 0x10000, v2
    v_subrev_u32 v3, 0x10000, v3
    v_and_b32 v78, 15, v92
    v_lshlrev_b32 v78, 1, v78
    v_lshrrev_b32 v77, 5, v92
    v_lshl_add_u32 v77, v77, 11, v78
    v_mul_f32 v216, s40, v216
    v_mul_f32 v217, s40, v217
    v_mul_f32 v218, s40, v218
    v_mul_f32 v219, s40, v219
    v_mul_f32 v248, s40, v248
    v_mul_f32 v249, s40, v249
    v_mul_f32 v250, s40, v250
    v_mul_f32 v251, s40, v251
    buffer_load_ushort v64, v77, s[20:23], s39 offen offset:0
    v_exp_f32 v216, v216
    v_exp_f32 v217, v217
    v_exp_f32 v218, v218
    v_exp_f32 v219, v219
    v_exp_f32 v248, v248
    v_exp_f32 v249, v249
    v_exp_f32 v250, v250
    v_exp_f32 v251, v251
    v_fma_f32 v216, v216, s41, s41
    v_fma_f32 v217, v217, s41, s41
    v_fma_f32 v218, v218, s41, s41
    v_fma_f32 v219, v219, s41, s41
    v_fma_f32 v248, v248, s41, s41
    v_fma_f32 v249, v249, s41, s41
    v_fma_f32 v250, v250, s41, s41
    v_fma_f32 v251, v251, s41, s41
    v_rcp_f32 v216, v216
    v_rcp_f32 v217, v217
    v_rcp_f32 v218, v218
    v_rcp_f32 v219, v219
    v_rcp_f32 v248, v248
    buffer_load_ushort v65, v77, s[20:23], s39 offen offset:1024
    v_rcp_f32 v249, v249
    v_rcp_f32 v250, v250
    v_rcp_f32 v251, v251
    v_mul_f32 v216, v152, v216
    v_mul_f32 v217, v153, v217
    v_mul_f32 v218, v154, v218
    v_mul_f32 v219, v155, v219
    v_mul_f32 v248, v184, v248
    v_mul_f32 v249, v185, v249
    v_mul_f32 v250, v186, v250
    v_mul_f32 v251, v187, v251
    v_mul_f32 v196, s40, v196
    v_mul_f32 v197, s40, v197
    v_mul_f32 v198, s40, v198
    v_mul_f32 v199, s40, v199
    v_mul_f32 v228, s40, v228
    v_mul_f32 v229, s40, v229
    v_mul_f32 v230, s40, v230
    v_mul_f32 v231, s40, v231
    v_exp_f32 v196, v196
    v_exp_f32 v197, v197
    v_exp_f32 v198, v198
    v_exp_f32 v199, v199
    v_exp_f32 v228, v228
    v_exp_f32 v229, v229
    buffer_load_ushort v72, v78, s[20:23], s54 offen offset:0
    v_exp_f32 v230, v230
    v_exp_f32 v231, v231
    v_fma_f32 v196, v196, s41, s41
    v_fma_f32 v197, v197, s41, s41
    v_fma_f32 v198, v198, s41, s41
    v_fma_f32 v199, v199, s41, s41
    v_fma_f32 v228, v228, s41, s41
    v_fma_f32 v229, v229, s41, s41
    v_fma_f32 v230, v230, s41, s41
    v_fma_f32 v231, v231, s41, s41
    v_rcp_f32 v196, v196
    v_rcp_f32 v197, v197
    v_rcp_f32 v198, v198
    v_rcp_f32 v199, v199
    v_rcp_f32 v228, v228
    v_rcp_f32 v229, v229
    v_rcp_f32 v230, v230
    v_rcp_f32 v231, v231
    v_mul_f32 v196, v132, v196
    v_mul_f32 v197, v133, v197
    v_mul_f32 v198, v134, v198
    v_mul_f32 v199, v135, v199
    v_mul_f32 v228, v164, v228
    v_mul_f32 v229, v165, v229
    buffer_load_ushort v68, v77, s[20:23], s39 offen offset:32
    v_mul_f32 v230, v166, v230
    v_mul_f32 v231, v167, v231
    v_cvt_pk_bf16_f32 v154, v196, v197
    v_cvt_pk_bf16_f32 v155, v198, v199
    v_cvt_pk_bf16_f32 v186, v228, v229
    v_cvt_pk_bf16_f32 v187, v230, v231
    v_cvt_pk_bf16_f32 v164, v216, v217
    v_cvt_pk_bf16_f32 v165, v218, v219
    v_cvt_pk_bf16_f32 v196, v248, v249
    v_cvt_pk_bf16_f32 v197, v250, v251
    v_mul_f32 v220, s40, v220
    v_mul_f32 v221, s40, v221
    v_mul_f32 v222, s40, v222
    v_mul_f32 v223, s40, v223
    v_mul_f32 v252, s40, v252
    v_mul_f32 v253, s40, v253
    v_mul_f32 v254, s40, v254
    v_mul_f32 v255, s40, v255
    v_exp_f32 v220, v220
    v_exp_f32 v221, v221
    v_exp_f32 v222, v222
    v_exp_f32 v223, v223
    s_mul_i32 s99, s33, 128
    s_buffer_load_dword s98, s[28:31], s99 offset:0
    v_exp_f32 v252, v252
    v_exp_f32 v253, v253
    v_exp_f32 v254, v254
    v_exp_f32 v255, v255
    buffer_load_ushort v69, v77, s[20:23], s39 offen offset:1056
    v_fma_f32 v220, v220, s41, s41
    v_fma_f32 v221, v221, s41, s41
    v_fma_f32 v222, v222, s41, s41
    v_fma_f32 v223, v223, s41, s41
    v_fma_f32 v252, v252, s41, s41
    v_fma_f32 v253, v253, s41, s41
    v_fma_f32 v254, v254, s41, s41
    v_fma_f32 v255, v255, s41, s41
    v_rcp_f32 v220, v220
    v_rcp_f32 v221, v221
    v_rcp_f32 v222, v222
    v_rcp_f32 v223, v223
    v_rcp_f32 v252, v252
    v_rcp_f32 v253, v253
    v_rcp_f32 v254, v254
    v_rcp_f32 v255, v255
    v_mul_f32 v220, v156, v220
    v_mul_f32 v221, v157, v221
    v_mul_f32 v222, v158, v222
    v_mul_f32 v223, v159, v223
    v_mul_f32 v252, v188, v252
    v_mul_f32 v253, v189, v253
    v_mul_f32 v254, v190, v254
    v_mul_f32 v255, v191, v255
    v_cvt_pk_bf16_f32 v166, v220, v221
    v_cvt_pk_bf16_f32 v167, v222, v223
    buffer_load_ushort v74, v78, s[20:23], s54 offen offset:32
    v_cvt_pk_bf16_f32 v198, v252, v253
    v_cvt_pk_bf16_f32 v199, v254, v255
    v_and_b32 v82, 8, v92
    v_lshlrev_b32 v82, 3, v82
    v_and_or_b32 v5, v92, 48, v82
    v_mov_b32 v82, s97
    v_mul_f32 v192, s40, v192
    v_mul_f32 v193, s40, v193
    v_mul_f32 v194, s40, v194
    v_mul_f32 v195, s40, v195
    v_mul_f32 v224, s40, v224
    v_mul_f32 v225, s40, v225
    v_mul_f32 v226, s40, v226
    v_mul_f32 v227, s40, v227
    v_exp_f32 v192, v192
    v_exp_f32 v193, v193
    v_exp_f32 v194, v194
    v_exp_f32 v195, v195
    v_exp_f32 v224, v224
    v_exp_f32 v225, v225
    v_exp_f32 v226, v226
    v_exp_f32 v227, v227
    v_fma_f32 v192, v192, s41, s41
    v_fma_f32 v193, v193, s41, s41
    v_fma_f32 v194, v194, s41, s41
    v_fma_f32 v195, v195, s41, s41
    v_fma_f32 v224, v224, s41, s41
    v_fma_f32 v225, v225, s41, s41
    v_fma_f32 v226, v226, s41, s41
    v_fma_f32 v227, v227, s41, s41
    v_rcp_f32 v192, v192
    v_rcp_f32 v193, v193
    v_rcp_f32 v194, v194
    v_rcp_f32 v195, v195
    v_rcp_f32 v224, v224
    v_rcp_f32 v225, v225
    v_rcp_f32 v226, v226
    v_rcp_f32 v227, v227
    v_mul_f32 v192, v128, v192
    v_mul_f32 v193, v129, v193
    v_mul_f32 v194, v130, v194
    v_mul_f32 v195, v131, v195
    v_mul_f32 v224, v160, v224
    v_mul_f32 v225, v161, v225
    v_mul_f32 v226, v162, v226
    v_mul_f32 v227, v163, v227
    v_cvt_pk_bf16_f32 v152, v192, v193
    v_cvt_pk_bf16_f32 v153, v194, v195
    v_cvt_pk_bf16_f32 v184, v224, v225
    v_cvt_pk_bf16_f32 v185, v226, v227
    v_cndmask_b32 v84, v164, v152, s[44:45]
    v_cndmask_b32 v85, v165, v153, s[44:45]
    s_waitcnt lgkmcnt(0)
    s_mov_b32 s58, 0x8000
L_rpolla:
    s_cmp_lt_u32 s98, 6
    s_cbranch_scc1 L_rrepolla
L_rpolleda:
    v_cndmask_b32 v86, v166, v154, s[44:45]
    v_cndmask_b32 v87, v167, v155, s[44:45]
    v_cndmask_b32 v88, v196, v184, s[44:45]
    v_cndmask_b32 v89, v197, v185, s[44:45]
    v_cndmask_b32 v90, v198, v186, s[44:45]
    v_cndmask_b32 v91, v199, v187, s[44:45]
    s_mov_b64 exec, s[48:49]
    buffer_store_dwordx4 v[84:87], v5, s[24:27], s52 offen offset:0 sc1
    buffer_store_dwordx4 v[88:91], v5, s[24:27], s52 offen offset:128 sc1
    s_mov_b64 exec, -1
    v_mov_b32 v6, s3
    v_cndmask_b32 v6, v6, v82, s[44:45]
    v_and_or_b32 v6, v92, 48, v6
    v_and_b32 v76, 3, v92
    v_mul_u32_u24 v76, 0x5555, v76
    v_lshlrev_b32 v79, 4, v92
    v_mul_f32 v212, s40, v212
    v_mul_f32 v213, s40, v213
    v_mul_f32 v214, s40, v214
    v_mul_f32 v215, s40, v215
    v_mul_f32 v244, s40, v244
    v_mul_f32 v245, s40, v245
    v_mul_f32 v246, s40, v246
    v_mul_f32 v247, s40, v247
    v_exp_f32 v212, v212
    v_exp_f32 v213, v213
    v_exp_f32 v214, v214
    v_exp_f32 v215, v215
    v_exp_f32 v244, v244
    v_exp_f32 v245, v245
    v_exp_f32 v246, v246
    v_exp_f32 v247, v247
    v_fma_f32 v212, v212, s41, s41
    v_fma_f32 v213, v213, s41, s41
    v_fma_f32 v214, v214, s41, s41
    v_fma_f32 v215, v215, s41, s41
    v_fma_f32 v244, v244, s41, s41
    v_fma_f32 v245, v245, s41, s41
    v_fma_f32 v246, v246, s41, s41
    v_fma_f32 v247, v247, s41, s41
    v_rcp_f32 v212, v212
    v_rcp_f32 v213, v213
    v_rcp_f32 v214, v214
    v_rcp_f32 v215, v215
    v_rcp_f32 v244, v244
    v_rcp_f32 v245, v245
    v_rcp_f32 v246, v246
    v_rcp_f32 v247, v247
    v_mul_f32 v212, v148, v212
    v_mul_f32 v213, v149, v213
    v_mul_f32 v214, v150, v214
    v_mul_f32 v215, v151, v215
    v_mul_f32 v244, v180, v244
    v_mul_f32 v245, v181, v245
    v_mul_f32 v246, v182, v246
    v_mul_f32 v247, v183, v247
    s_mul_i32 s99, s33, 64
    s_buffer_load_dword s98, s[28:31], s99 offset:64
    v_cvt_pk_bf16_f32 v162, v212, v213
    v_cvt_pk_bf16_f32 v163, v214, v215
    v_cvt_pk_bf16_f32 v194, v244, v245
    v_cvt_pk_bf16_f32 v195, v246, v247
    v_mul_f32 v208, s40, v208
    v_mul_f32 v209, s40, v209
    v_mul_f32 v210, s40, v210
    v_mul_f32 v211, s40, v211
    v_mul_f32 v240, s40, v240
    v_mul_f32 v241, s40, v241
    v_mul_f32 v242, s40, v242
    v_mul_f32 v243, s40, v243
    v_exp_f32 v208, v208
    v_exp_f32 v209, v209
    v_exp_f32 v210, v210
    v_exp_f32 v211, v211
    v_exp_f32 v240, v240
    v_exp_f32 v241, v241
    v_exp_f32 v242, v242
    v_exp_f32 v243, v243
    v_fma_f32 v208, v208, s41, s41
    v_fma_f32 v209, v209, s41, s41
    v_fma_f32 v210, v210, s41, s41
    v_fma_f32 v211, v211, s41, s41
    v_fma_f32 v240, v240, s41, s41
    v_fma_f32 v241, v241, s41, s41
    v_fma_f32 v242, v242, s41, s41
    v_fma_f32 v243, v243, s41, s41
    v_rcp_f32 v208, v208
    v_rcp_f32 v209, v209
    v_rcp_f32 v210, v210
    v_rcp_f32 v211, v211
    v_rcp_f32 v240, v240
    v_rcp_f32 v241, v241
    v_rcp_f32 v242, v242
    v_rcp_f32 v243, v243
    v_mul_f32 v208, v144, v208
    v_mul_f32 v209, v145, v209
    v_mul_f32 v210, v146, v210
    v_mul_f32 v211, v147, v211
    v_mul_f32 v240, v176, v240
    v_mul_f32 v241, v177, v241
    v_mul_f32 v242, v178, v242
    v_mul_f32 v243, v179, v243
    v_cvt_pk_bf16_f32 v160, v208, v209
    v_cvt_pk_bf16_f32 v161, v210, v211
    v_cvt_pk_bf16_f32 v192, v240, v241
    v_cvt_pk_bf16_f32 v193, v242, v243
    s_waitcnt vmcnt(2)
    v_lshlrev_b32 v72, v79, v72
    v_lshlrev_b32 v74, v79, v74
    s_mov_b32 s100, 0xf00000f0
    s_mov_b32 s101, 0xf00000f0
    v_cndmask_b32 v66, 0, v64, s[100:101]
    v_cndmask_b32 v67, 0, v65, s[100:101]
    v_cndmask_b32 v70, 0, v68, s[100:101]
    v_cndmask_b32 v71, 0, v69, s[100:101]
    s_mov_b32 s100, 0xf00000f
    s_mov_b32 s101, 0xf00000f
    v_cndmask_b32 v64, 0, v64, s[100:101]
    v_cndmask_b32 v65, 0, v65, s[100:101]
    v_cndmask_b32 v68, 0, v68, s[100:101]
    v_cndmask_b32 v69, 0, v69, s[100:101]
    s_mov_b32 s100, 0xc0000c
    s_mov_b32 s101, 0xc0000c00
    v_cndmask_b32 v73, 0, v72, s[100:101]
    v_cndmask_b32 v75, 0, v74, s[100:101]
    s_mov_b32 s100, 0x300003
    s_mov_b32 s101, 0x30000300
    v_cndmask_b32 v72, 0, v72, s[100:101]
    v_cndmask_b32 v74, 0, v74, s[100:101]
    v_mul_f32 v204, s40, v204
    v_mul_f32 v205, s40, v205
    v_mul_f32 v206, s40, v206
    v_mul_f32 v207, s40, v207
    v_mul_f32 v236, s40, v236
    v_mul_f32 v237, s40, v237
    v_mul_f32 v238, s40, v238
    v_mul_f32 v239, s40, v239
    v_exp_f32 v204, v204
    v_exp_f32 v205, v205
    v_exp_f32 v206, v206
    v_exp_f32 v207, v207
    v_exp_f32 v236, v236
    v_exp_f32 v237, v237
    v_exp_f32 v238, v238
    v_exp_f32 v239, v239
    v_fma_f32 v204, v204, s41, s41
    v_fma_f32 v205, v205, s41, s41
    v_fma_f32 v206, v206, s41, s41
    v_fma_f32 v207, v207, s41, s41
    v_fma_f32 v236, v236, s41, s41
    v_fma_f32 v237, v237, s41, s41
    v_fma_f32 v238, v238, s41, s41
    v_fma_f32 v239, v239, s41, s41
    s_waitcnt lgkmcnt(0)
    s_mov_b32 s58, 0x8000
L_rpolld:
    s_cmp_lt_u32 s98, 6
    s_cbranch_scc1 L_rrepolld
L_rpolledd:
    v_rcp_f32 v204, v204
    v_rcp_f32 v205, v205
    s_buffer_load_dwordx2 s[94:95], s[24:27], s96 offset:60
    v_rcp_f32 v206, v206
    v_rcp_f32 v207, v207
    v_rcp_f32 v236, v236
    v_rcp_f32 v237, v237
    v_rcp_f32 v238, v238
    v_rcp_f32 v239, v239
    s_buffer_load_dwordx2 s[94:95], s[24:27], s96 offset:188
    v_mul_f32 v204, v140, v204
    v_mul_f32 v205, v141, v205
    v_mul_f32 v206, v142, v206
    v_mul_f32 v207, v143, v207
    v_mul_f32 v236, v172, v236
    v_mul_f32 v237, v173, v237
    v_mul_f32 v238, v174, v238
    v_mul_f32 v239, v175, v239
    v_cvt_pk_bf16_f32 v158, v204, v205
    v_cvt_pk_bf16_f32 v159, v206, v207
    v_cvt_pk_bf16_f32 v190, v236, v237
    v_cvt_pk_bf16_f32 v191, v238, v239
    s_buffer_load_dwordx2 s[94:95], s[24:27], s96 offset:316
    v_mul_f32 v200, s40, v200
    v_mul_f32 v201, s40, v201
    v_mul_f32 v202, s40, v202
    v_mul_f32 v203, s40, v203
    v_mul_f32 v232, s40, v232
    v_mul_f32 v233, s40, v233
    v_mul_f32 v234, s40, v234
    v_mul_f32 v235, s40, v235
    v_exp_f32 v200, v200
    v_exp_f32 v201, v201
    s_buffer_load_dwordx2 s[94:95], s[24:27], s96 offset:444
    v_exp_f32 v202, v202
    v_exp_f32 v203, v203
    v_exp_f32 v232, v232
    v_exp_f32 v233, v233
    v_exp_f32 v234, v234
    v_exp_f32 v235, v235
    s_buffer_load_dwordx2 s[94:95], s[24:27], s96 offset:572
    s_setprio 3
    v_mfma_f32_16x16x16_bf16 v[128:131], v[72:73], v[166:167], 0
    v_fma_f32 v200, v200, s41, s41
    v_fma_f32 v201, v201, s41, s41
    v_fma_f32 v202, v202, s41, s41
    v_mfma_f32_16x16x16_bf16 v[132:135], v[74:75], v[198:199], 0
    s_setprio 0
    v_fma_f32 v203, v203, s41, s41
    v_fma_f32 v232, v232, s41, s41
    v_fma_f32 v233, v233, s41, s41
    v_fma_f32 v234, v234, s41, s41
    v_fma_f32 v235, v235, s41, s41
    v_rcp_f32 v200, v200
    v_rcp_f32 v201, v201
    s_buffer_load_dwordx2 s[94:95], s[24:27], s96 offset:700
    v_rcp_f32 v202, v202
    v_rcp_f32 v203, v203
    v_rcp_f32 v232, v232
    v_rcp_f32 v233, v233
    v_rcp_f32 v234, v234
    v_rcp_f32 v235, v235
    s_buffer_load_dwordx2 s[94:95], s[24:27], s96 offset:828
    s_setprio 3
    v_smfmac_f32_16x16x64_bf16 v[128:131], v[64:67], v[158:165], v76
    v_mul_f32 v200, v136, v200
    v_smfmac_f32_16x16x64_bf16 v[132:135], v[68:71], v[190:197], v76
    s_setprio 0
    v_mul_f32 v201, v137, v201
    v_mul_f32 v202, v138, v202
    v_mul_f32 v203, v139, v203
    v_mul_f32 v232, v168, v232
    v_mul_f32 v233, v169, v233
    v_mul_f32 v234, v170, v234
    v_mul_f32 v235, v171, v235
    v_cvt_pk_bf16_f32 v156, v200, v201
    v_cvt_pk_bf16_f32 v157, v202, v203
    v_cvt_pk_bf16_f32 v188, v232, v233
    v_cvt_pk_bf16_f32 v189, v234, v235
    s_buffer_load_dwordx2 s[94:95], s[24:27], s96 offset:956
    v_exp_f32 v84, v128
    v_exp_f32 v85, v129
    v_exp_f32 v86, v130
    v_exp_f32 v87, v131
    v_exp_f32 v88, v132
    v_exp_f32 v89, v133
    s_buffer_load_dwordx2 s[94:95], s[24:27], s96 offset:1084
    v_exp_f32 v90, v134
    v_exp_f32 v91, v135
    s_setprio 3
    v_mfma_f32_16x16x16_bf16 v[136:139], v[72:73], v[164:165], 0
    v_fma_f32 v84, v84, s40, s40
    v_fma_f32 v85, v85, s40, s40
    v_fma_f32 v86, v86, s40, s40
    v_mfma_f32_16x16x16_bf16 v[140:143], v[74:75], v[196:197], 0
    s_setprio 1
    v_fma_f32 v87, v87, s40, s40
    v_fma_f32 v88, v88, s40, s40
    v_fma_f32 v89, v89, s40, s40
    v_fma_f32 v90, v90, s40, s40
    v_fma_f32 v91, v91, s40, s40
    s_buffer_load_dwordx2 s[94:95], s[24:27], s96 offset:1212
    v_rcp_f32 v84, v84
    v_rcp_f32 v85, v85
    v_rcp_f32 v86, v86
    v_rcp_f32 v87, v87
    s_mov_b64 exec, s[48:49]
    buffer_load_dwordx4 v[148:151], v6, s[24:27], s53 offen offset:0 sc1
    buffer_load_dwordx4 v[180:183], v6, s[24:27], s53 offen offset:128 sc1
    s_mov_b64 exec, -1
    v_rcp_f32 v88, v88
    v_rcp_f32 v89, v89
    s_buffer_load_dwordx2 s[94:95], s[24:27], s96 offset:1340
    v_rcp_f32 v90, v90
    v_rcp_f32 v91, v91
    s_setprio 3
    v_smfmac_f32_16x16x64_bf16 v[136:139], v[64:67], v[156:163], v76
    v_mul_f32 v84, v128, v84
    v_smfmac_f32_16x16x64_bf16 v[140:143], v[68:71], v[188:195], v76
    s_setprio 1
    v_mul_f32 v85, v129, v85
    v_mul_f32 v86, v130, v86
    v_mul_f32 v87, v131, v87
    v_mul_f32 v88, v132, v88
    v_mul_f32 v89, v133, v89
    v_mul_f32 v90, v134, v90
    v_mul_f32 v91, v135, v91
    s_buffer_load_dwordx2 s[94:95], s[24:27], s96 offset:1468
    v_cvt_pk_bf16_f32 v116, v84, v85
    v_cvt_pk_bf16_f32 v117, v86, v87
    v_cvt_pk_bf16_f32 v118, v88, v89
    v_cvt_pk_bf16_f32 v119, v90, v91
    v_exp_f32 v84, v136
    s_cmp_eq_u32 s33, 0
    s_cbranch_scc1 L_nw5
    v_xor_b32 v4, 80, v4
    ds_write_b128 v4, v[116:119] offset:0
L_nw5:
    v_exp_f32 v85, v137
    v_exp_f32 v86, v138
    v_exp_f32 v87, v139
    s_buffer_load_dwordx2 s[94:95], s[24:27], s96 offset:1596
    v_exp_f32 v88, v140
    v_exp_f32 v89, v141
    v_exp_f32 v90, v142
    v_exp_f32 v91, v143
    s_setprio 3
    v_mfma_f32_16x16x16_bf16 v[128:131], v[72:73], v[162:163], 0
    v_fma_f32 v84, v84, s40, s40
    v_fma_f32 v85, v85, s40, s40
    v_fma_f32 v86, v86, s40, s40
    v_mfma_f32_16x16x16_bf16 v[132:135], v[74:75], v[194:195], 0
    s_setprio 1
    v_fma_f32 v87, v87, s40, s40
    s_buffer_load_dwordx2 s[94:95], s[24:27], s96 offset:1724
    v_fma_f32 v88, v88, s40, s40
    v_fma_f32 v89, v89, s40, s40
    v_fma_f32 v90, v90, s40, s40
    v_fma_f32 v91, v91, s40, s40
    v_rcp_f32 v84, v84
    v_rcp_f32 v85, v85
    v_rcp_f32 v86, v86
    v_rcp_f32 v87, v87
    s_buffer_load_dwordx2 s[94:95], s[24:27], s96 offset:1852
    v_rcp_f32 v88, v88
    v_rcp_f32 v89, v89
    v_rcp_f32 v90, v90
    v_rcp_f32 v91, v91
    s_setprio 3
    v_smfmac_f32_16x16x64_bf16 v[128:131], v[64:67], v[154:161], v76
    v_mul_f32 v84, v136, v84
    v_smfmac_f32_16x16x64_bf16 v[132:135], v[68:71], v[186:193], v76
    s_setprio 1
    v_mul_f32 v85, v137, v85
    v_mul_f32 v86, v138, v86
    v_mul_f32 v87, v139, v87
    s_buffer_load_dwordx2 s[94:95], s[24:27], s96 offset:1980
    v_mul_f32 v88, v140, v88
    v_mul_f32 v89, v141, v89
    v_mul_f32 v90, v142, v90
    v_mul_f32 v91, v143, v91
    v_cvt_pk_bf16_f32 v112, v84, v85
    v_cvt_pk_bf16_f32 v113, v86, v87
    v_cvt_pk_bf16_f32 v114, v88, v89
    v_cvt_pk_bf16_f32 v115, v90, v91
    v_exp_f32 v84, v128
    s_cmp_eq_u32 s33, 0
    s_cbranch_scc1 L_nw4
    v_xor_b32 v4, 16, v4
    ds_write_b128 v4, v[112:115] offset:0
L_nw4:
    v_exp_f32 v85, v129
    s_buffer_load_dwordx2 s[94:95], s[24:27], s96 offset:2108
    v_exp_f32 v86, v130
    v_exp_f32 v87, v131
    v_exp_f32 v88, v132
    v_exp_f32 v89, v133
    v_exp_f32 v90, v134
    v_exp_f32 v91, v135
    s_buffer_load_dwordx2 s[94:95], s[24:27], s96 offset:2236
    s_setprio 3
    v_mfma_f32_16x16x16_bf16 v[136:139], v[72:73], v[160:161], 0
    v_fma_f32 v84, v84, s40, s40
    v_fma_f32 v85, v85, s40, s40
    v_fma_f32 v86, v86, s40, s40
    v_mfma_f32_16x16x16_bf16 v[140:143], v[74:75], v[192:193], 0
    s_setprio 1
    v_fma_f32 v87, v87, s40, s40
    v_fma_f32 v88, v88, s40, s40
    v_fma_f32 v89, v89, s40, s40
    v_fma_f32 v90, v90, s40, s40
    v_fma_f32 v91, v91, s40, s40
    v_rcp_f32 v84, v84
    v_rcp_f32 v85, v85
    s_buffer_load_dwordx2 s[94:95], s[24:27], s96 offset:2364
    v_rcp_f32 v86, v86
    v_rcp_f32 v87, v87
    v_rcp_f32 v88, v88
    v_rcp_f32 v89, v89
    v_rcp_f32 v90, v90
    v_rcp_f32 v91, v91
    s_buffer_load_dwordx2 s[94:95], s[24:27], s96 offset:2492
    s_setprio 3
    v_smfmac_f32_16x16x64_bf16 v[136:139], v[64:67], v[152:159], v76
    v_mul_f32 v84, v128, v84
    v_smfmac_f32_16x16x64_bf16 v[140:143], v[68:71], v[184:191], v76
    s_setprio 1
    v_mul_f32 v85, v129, v85
    v_mul_f32 v86, v130, v86
    v_mul_f32 v87, v131, v87
    v_mul_f32 v88, v132, v88
    v_mul_f32 v89, v133, v89
    v_mul_f32 v90, v134, v90
    v_mul_f32 v91, v135, v91
    v_cvt_pk_bf16_f32 v108, v84, v85
    v_cvt_pk_bf16_f32 v109, v86, v87
    v_cvt_pk_bf16_f32 v110, v88, v89
    v_cvt_pk_bf16_f32 v111, v90, v91
    s_waitcnt vmcnt(0)
    s_mov_b64 exec, s[48:49]
    s_mov_b32 s58, 0x8000
L_polla:
    v_max3_u32 v82, v148, v149, v150
    v_max3_u32 v83, v180, v181, v182
    v_max3_u32 v82, v82, v151, v183
    v_max_u32 v82, v82, v83
    v_cmp_ne_u32 vcc, -1, v82
    s_nop 1
    s_cmp_eq_u64 vcc, exec
    s_cbranch_scc0 L_repolla
L_polleda:
    s_mov_b64 exec, -1
    s_mov_b64 vcc, s[46:47]
    v_cndmask_b32_dpp v168, v152, v148, vcc row_shl:1 row_mask:0xf bank_mask:0xf bound_ctrl:1
    v_cndmask_b32_dpp v169, v153, v149, vcc row_shl:1 row_mask:0xf bank_mask:0xf bound_ctrl:1
    s_cmp_eq_u32 s33, 0
    s_cbranch_scc1 L_nw3
    v_xor_b32 v4, 112, v4
    ds_write_b128 v4, v[108:111] offset:0
L_nw3:
    v_cndmask_b32_dpp v170, v154, v150, vcc row_shl:1 row_mask:0xf bank_mask:0xf bound_ctrl:1
    v_cndmask_b32_dpp v171, v155, v151, vcc row_shl:1 row_mask:0xf bank_mask:0xf bound_ctrl:1
    v_cndmask_b32_dpp v200, v184, v180, vcc row_shl:1 row_mask:0xf bank_mask:0xf bound_ctrl:1
    v_cndmask_b32_dpp v201, v185, v181, vcc row_shl:1 row_mask:0xf bank_mask:0xf bound_ctrl:1
    v_cndmask_b32_dpp v202, v186, v182, vcc row_shl:1 row_mask:0xf bank_mask:0xf bound_ctrl:1
    v_cndmask_b32_dpp v203, v187, v183, vcc row_shl:1 row_mask:0xf bank_mask:0xf bound_ctrl:1
    v_mov_b32_dpp v148, v164 row_shr:1 row_mask:0xf bank_mask:0xf
    v_mov_b32_dpp v149, v165 row_shr:1 row_mask:0xf bank_mask:0xf
    v_mov_b32_dpp v150, v166 row_shr:1 row_mask:0xf bank_mask:0xf
    v_mov_b32_dpp v151, v167 row_shr:1 row_mask:0xf bank_mask:0xf
    v_mov_b32_dpp v180, v196 row_shr:1 row_mask:0xf bank_mask:0xf
    v_mov_b32_dpp v181, v197 row_shr:1 row_mask:0xf bank_mask:0xf
    v_mov_b32_dpp v182, v198 row_shr:1 row_mask:0xf bank_mask:0xf
    v_mov_b32_dpp v183, v199 row_shr:1 row_mask:0xf bank_mask:0xf
    v_exp_f32 v84, v136
    v_exp_f32 v85, v137
    v_exp_f32 v86, v138
    v_exp_f32 v87, v139
    v_exp_f32 v88, v140
    v_exp_f32 v89, v141
    v_exp_f32 v90, v142
    v_exp_f32 v91, v143
    s_setprio 3
    v_mfma_f32_16x16x16_bf16 v[128:131], v[72:73], v[168:169], 0
    v_fma_f32 v84, v84, s40, s40
    v_fma_f32 v85, v85, s40, s40
    v_fma_f32 v86, v86, s40, s40
    v_mfma_f32_16x16x16_bf16 v[132:135], v[74:75], v[200:201], 0
    s_setprio 1
    v_fma_f32 v87, v87, s40, s40
    v_fma_f32 v88, v88, s40, s40
    v_fma_f32 v89, v89, s40, s40
    v_fma_f32 v90, v90, s40, s40
    v_fma_f32 v91, v91, s40, s40
    v_rcp_f32 v84, v84
    v_rcp_f32 v85, v85
    v_rcp_f32 v86, v86
    v_rcp_f32 v87, v87
    v_rcp_f32 v88, v88
    v_rcp_f32 v89, v89
    v_rcp_f32 v90, v90
    v_rcp_f32 v91, v91
    s_setprio 3
    v_smfmac_f32_16x16x64_bf16 v[128:131], v[64:67], v[160:167], v76
    v_mul_f32 v84, v136, v84
    v_smfmac_f32_16x16x64_bf16 v[132:135], v[68:71], v[192:199], v76
    s_setprio 1
    v_mul_f32 v85, v137, v85
    v_mul_f32 v86, v138, v86
    v_mul_f32 v87, v139, v87
    v_mul_f32 v88, v140, v88
    v_mul_f32 v89, v141, v89
    v_mul_f32 v90, v142, v90
    v_mul_f32 v91, v143, v91
    v_cvt_pk_bf16_f32 v104, v84, v85
    v_cvt_pk_bf16_f32 v105, v86, v87
    v_cvt_pk_bf16_f32 v106, v88, v89
    v_cvt_pk_bf16_f32 v107, v90, v91
    v_exp_f32 v84, v128
    s_cmp_eq_u32 s33, 0
    s_cbranch_scc1 L_nw2
    v_xor_b32 v4, 16, v4
    ds_write_b128 v4, v[104:107] offset:0
L_nw2:
    v_exp_f32 v85, v129
    v_exp_f32 v86, v130
    s_lshl_b32 s38, s32, 16
    s_add_u32 s38, s38, 1048576
    v_exp_f32 v87, v131
    buffer_load_dwordx4 v[32:35], v7, s[24:27], s38 offen offset:0 sc1
    v_exp_f32 v88, v132
    v_exp_f32 v89, v133
    v_exp_f32 v90, v134
    v_exp_f32 v91, v135
    s_setprio 3
    v_mfma_f32_16x16x16_bf16 v[136:139], v[72:73], v[170:171], 0
    v_fma_f32 v84, v84, s40, s40
    v_fma_f32 v85, v85, s40, s40
    v_fma_f32 v86, v86, s40, s40
    v_mfma_f32_16x16x16_bf16 v[140:143], v[74:75], v[202:203], 0
    s_setprio 1
    v_fma_f32 v87, v87, s40, s40
    v_fma_f32 v88, v88, s40, s40
    v_fma_f32 v89, v89, s40, s40
    v_fma_f32 v90, v90, s40, s40
    v_fma_f32 v91, v91, s40, s40
    v_rcp_f32 v84, v84
    buffer_load_dwordx4 v[36:39], v7, s[24:27], s38 offen offset:1024 sc1
    v_rcp_f32 v85, v85
    v_rcp_f32 v86, v86
    v_rcp_f32 v87, v87
    v_rcp_f32 v88, v88
    v_rcp_f32 v89, v89
    v_rcp_f32 v90, v90
    v_rcp_f32 v91, v91
    s_setprio 3
    v_smfmac_f32_16x16x64_bf16 v[136:139], v[64:67], v[162:169], v76
    v_mul_f32 v84, v128, v84
    v_smfmac_f32_16x16x64_bf16 v[140:143], v[68:71], v[194:201], v76
    s_setprio 1
    v_mul_f32 v85, v129, v85
    v_mul_f32 v86, v130, v86
    v_mul_f32 v87, v131, v87
    buffer_load_dwordx4 v[40:43], v7, s[24:27], s38 offen offset:2048 sc1
    v_mul_f32 v88, v132, v88
    v_mul_f32 v89, v133, v89
    v_mul_f32 v90, v134, v90
    v_mul_f32 v91, v135, v91
    v_cvt_pk_bf16_f32 v120, v84, v85
    v_cvt_pk_bf16_f32 v121, v86, v87
    v_cvt_pk_bf16_f32 v122, v88, v89
    v_cvt_pk_bf16_f32 v123, v90, v91
    v_exp_f32 v84, v136
    s_cmp_eq_u32 s33, 0
    s_cbranch_scc1 L_nw6
    v_xor_b32 v4, 64, v4
    ds_write_b128 v4, v[120:123] offset:0
L_nw6:
    v_exp_f32 v85, v137
    v_exp_f32 v86, v138
    v_exp_f32 v87, v139
    v_exp_f32 v88, v140
    buffer_load_dwordx4 v[44:47], v7, s[24:27], s38 offen offset:3072 sc1
    s_add_u32 s38, s38, 4096
    v_exp_f32 v89, v141
    v_exp_f32 v90, v142
    v_exp_f32 v91, v143
    s_setprio 3
    v_mfma_f32_16x16x16_bf16 v[128:131], v[72:73], v[156:157], 0
    v_fma_f32 v84, v84, s40, s40
    v_fma_f32 v85, v85, s40, s40
    v_fma_f32 v86, v86, s40, s40
    v_mfma_f32_16x16x16_bf16 v[132:135], v[74:75], v[188:189], 0
    s_setprio 1
    v_fma_f32 v87, v87, s40, s40
    v_fma_f32 v88, v88, s40, s40
    v_fma_f32 v89, v89, s40, s40
    v_fma_f32 v90, v90, s40, s40
    v_fma_f32 v91, v91, s40, s40
    v_rcp_f32 v84, v84
    v_rcp_f32 v85, v85
    buffer_load_dwordx4 v[48:51], v7, s[24:27], s38 offen offset:0 sc1
    v_rcp_f32 v86, v86
    v_rcp_f32 v87, v87
    v_rcp_f32 v88, v88
    v_rcp_f32 v89, v89
    v_rcp_f32 v90, v90
    v_rcp_f32 v91, v91
    s_setprio 3
    v_smfmac_f32_16x16x64_bf16 v[128:131], v[64:67], v[148:155], v76
    v_mul_f32 v84, v136, v84
    v_smfmac_f32_16x16x64_bf16 v[132:135], v[68:71], v[180:187], v76
    s_setprio 1
    v_mul_f32 v85, v137, v85
    v_mul_f32 v86, v138, v86
    v_mul_f32 v87, v139, v87
    v_mul_f32 v88, v140, v88
    v_mul_f32 v89, v141, v89
    buffer_load_dwordx4 v[52:55], v7, s[24:27], s38 offen offset:1024 sc1
    v_mul_f32 v90, v142, v90
    v_mul_f32 v91, v143, v91
    v_cvt_pk_bf16_f32 v124, v84, v85
    v_cvt_pk_bf16_f32 v125, v86, v87
    v_cvt_pk_bf16_f32 v126, v88, v89
    v_cvt_pk_bf16_f32 v127, v90, v91
    v_exp_f32 v84, v128
    s_cmp_eq_u32 s33, 0
    s_cbranch_scc1 L_nw7
    v_xor_b32 v4, 16, v4
    ds_write_b128 v4, v[124:127] offset:0
L_nw7:
    v_exp_f32 v85, v129
    v_exp_f32 v86, v130
    v_exp_f32 v87, v131
    v_exp_f32 v88, v132
    v_exp_f32 v89, v133
    buffer_load_dwordx4 v[56:59], v7, s[24:27], s38 offen offset:2048 sc1
    v_exp_f32 v90, v134
    v_exp_f32 v91, v135
    s_setprio 3
    v_mfma_f32_16x16x16_bf16 v[136:139], v[72:73], v[158:159], 0
    v_fma_f32 v84, v84, s40, s40
    v_fma_f32 v85, v85, s40, s40
    v_fma_f32 v86, v86, s40, s40
    v_mfma_f32_16x16x16_bf16 v[140:143], v[74:75], v[190:191], 0
    s_setprio 1
    v_fma_f32 v87, v87, s40, s40
    v_fma_f32 v88, v88, s40, s40
    v_fma_f32 v89, v89, s40, s40
    v_fma_f32 v90, v90, s40, s40
    v_fma_f32 v91, v91, s40, s40
    v_rcp_f32 v84, v84
    v_rcp_f32 v85, v85
    v_rcp_f32 v86, v86
    buffer_load_dwordx4 v[60:63], v7, s[24:27], s38 offen offset:3072 sc1
    s_add_u32 s38, s38, 4096
    v_rcp_f32 v87, v87
    v_rcp_f32 v88, v88
    v_rcp_f32 v89, v89
    v_rcp_f32 v90, v90
    v_rcp_f32 v91, v91
    s_setprio 3
    v_smfmac_f32_16x16x64_bf16 v[136:139], v[64:67], v[150:157], v76
    v_mul_f32 v84, v128, v84
    v_smfmac_f32_16x16x64_bf16 v[140:143], v[68:71], v[182:189], v76
    s_setprio 1
    v_mul_f32 v85, v129, v85
    v_mul_f32 v86, v130, v86
    v_mul_f32 v87, v131, v87
    v_mul_f32 v88, v132, v88
    v_mul_f32 v89, v133, v89
    v_mul_f32 v90, v134, v90
    v_mul_f32 v91, v135, v91
    v_cvt_pk_bf16_f32 v96, v84, v85
    v_cvt_pk_bf16_f32 v97, v86, v87
    v_cvt_pk_bf16_f32 v98, v88, v89
    v_cvt_pk_bf16_f32 v99, v90, v91
    v_exp_f32 v84, v136
    s_cmp_eq_u32 s33, 0
    s_cbranch_scc1 L_nw0
    v_xor_b32 v4, 112, v4
    ds_write_b128 v4, v[96:99] offset:0
L_nw0:
    v_exp_f32 v85, v137
    v_exp_f32 v86, v138
    v_exp_f32 v87, v139
    v_exp_f32 v88, v140
    v_exp_f32 v89, v141
    ds_read_b128 v[8:11], v0 offset:0
    v_exp_f32 v90, v142
    v_exp_f32 v91, v143
    v_fma_f32 v84, v84, s40, s40
    v_fma_f32 v85, v85, s40, s40
    v_fma_f32 v86, v86, s40, s40
    v_fma_f32 v87, v87, s40, s40
    ds_read_b128 v[12:15], v1 offset:0
    v_fma_f32 v88, v88, s40, s40
    v_fma_f32 v89, v89, s40, s40
    v_fma_f32 v90, v90, s40, s40
    v_fma_f32 v91, v91, s40, s40
    v_rcp_f32 v84, v84
    v_rcp_f32 v85, v85
    ds_read_b128 v[16:19], v2 offset:0
    v_rcp_f32 v86, v86
    v_rcp_f32 v87, v87
    v_rcp_f32 v88, v88
    v_rcp_f32 v89, v89
    ds_read_b128 v[20:23], v3 offset:0
    v_rcp_f32 v90, v90
    v_rcp_f32 v91, v91
    v_mul_f32 v84, v136, v84
    v_mul_f32 v85, v137, v85
    v_mul_f32 v86, v138, v86
    v_mul_f32 v87, v139, v87
    v_mul_f32 v88, v140, v88
    v_mul_f32 v89, v141, v89
    v_mul_f32 v90, v142, v90
    v_mul_f32 v91, v143, v91
    v_cvt_pk_bf16_f32 v100, v84, v85
    v_cvt_pk_bf16_f32 v101, v86, v87
    v_cvt_pk_bf16_f32 v102, v88, v89
    v_cvt_pk_bf16_f32 v103, v90, v91
    s_cmp_eq_u32 s33, 0
    s_cbranch_scc1 L_nw1
    v_xor_b32 v4, 16, v4
    ds_write_b128 v4, v[100:103] offset:0
L_nw1:
    s_and_b32 s52, s32, 1
    s_mul_i32 s52, s52, 60
    s_sub_u32 s39, s39, s52
    s_add_u32 s39, s39, 512
    s_add_u32 s51, s51, 524288
    s_cmp_eq_u32 s33, 1
    s_cselect_b64 vcc, -1, 0
    s_setprio 1
    s_waitcnt lgkmcnt(2)
    s_waitcnt vmcnt(6)
    v_mfma_f32_16x16x32_bf16 v[128:131], v[32:35], v[8:11], 0
    v_mfma_f32_16x16x32_bf16 v[128:131], v[36:39], v[12:15], v[128:131]
    buffer_load_dwordx4 v[64:67], v7, s[24:27], s38 offen offset:0 sc1
    s_waitcnt vmcnt(5)
    v_mfma_f32_16x16x32_bf16 v[160:163], v[44:47], v[12:15], 0
    ds_read_b128 v[24:27], v0 offset:256
    v_mfma_f32_16x16x32_bf16 v[160:163], v[40:43], v[8:11], v[160:163]
    ds_read_b128 v[28:31], v1 offset:256
    s_waitcnt vmcnt(3)
    v_mfma_f32_16x16x32_bf16 v[192:195], v[48:51], v[8:11], 0
    v_mfma_f32_16x16x32_bf16 v[192:195], v[52:55], v[12:15], v[192:195]
    buffer_load_dwordx4 v[68:71], v7, s[24:27], s38 offen offset:1024 sc1
    s_waitcnt vmcnt(2)
    v_mfma_f32_16x16x32_bf16 v[224:227], v[60:63], v[12:15], 0
    v_mfma_f32_16x16x32_bf16 v[224:227], v[56:59], v[8:11], v[224:227]
    s_waitcnt lgkmcnt(2)
    v_mfma_f32_16x16x32_bf16 v[132:135], v[32:35], v[16:19], 0
    v_mfma_f32_16x16x32_bf16 v[132:135], v[36:39], v[20:23], v[132:135]
    buffer_load_dwordx4 v[72:75], v7, s[24:27], s38 offen offset:2048 sc1
    v_mfma_f32_16x16x32_bf16 v[164:167], v[44:47], v[20:23], 0
    ds_read_b128 v[8:11], v2 offset:256
    v_mfma_f32_16x16x32_bf16 v[164:167], v[40:43], v[16:19], v[164:167]
    ds_read_b128 v[12:15], v3 offset:256
    v_mfma_f32_16x16x32_bf16 v[196:199], v[48:51], v[16:19], 0
    v_mfma_f32_16x16x32_bf16 v[196:199], v[52:55], v[20:23], v[196:199]
    buffer_load_dwordx4 v[76:79], v7, s[24:27], s38 offen offset:3072 sc1
    s_add_u32 s38, s38, 4096
    v_mfma_f32_16x16x32_bf16 v[228:231], v[60:63], v[20:23], 0
    v_mfma_f32_16x16x32_bf16 v[228:231], v[56:59], v[16:19], v[228:231]
    s_waitcnt lgkmcnt(2)
    v_mfma_f32_16x16x32_bf16 v[136:139], v[32:35], v[24:27], 0
    v_mfma_f32_16x16x32_bf16 v[136:139], v[36:39], v[28:31], v[136:139]
    buffer_load_dwordx4 v[80:83], v7, s[24:27], s38 offen offset:0 sc1
    v_mfma_f32_16x16x32_bf16 v[168:171], v[44:47], v[28:31], 0
    ds_read_b128 v[16:19], v0 offset:512
    v_mfma_f32_16x16x32_bf16 v[168:171], v[40:43], v[24:27], v[168:171]
    ds_read_b128 v[20:23], v1 offset:512
    v_mfma_f32_16x16x32_bf16 v[200:203], v[48:51], v[24:27], 0
    v_mfma_f32_16x16x32_bf16 v[200:203], v[52:55], v[28:31], v[200:203]
    buffer_load_dwordx4 v[84:87], v7, s[24:27], s38 offen offset:1024 sc1
    v_mfma_f32_16x16x32_bf16 v[232:235], v[60:63], v[28:31], 0
    v_mfma_f32_16x16x32_bf16 v[232:235], v[56:59], v[24:27], v[232:235]
    s_waitcnt lgkmcnt(2)
    v_mfma_f32_16x16x32_bf16 v[140:143], v[32:35], v[8:11], 0
    v_mfma_f32_16x16x32_bf16 v[140:143], v[36:39], v[12:15], v[140:143]
    buffer_load_dwordx4 v[88:91], v7, s[24:27], s38 offen offset:2048 sc1
    v_mfma_f32_16x16x32_bf16 v[172:175], v[44:47], v[12:15], 0
    ds_read_b128 v[24:27], v2 offset:512
    v_mfma_f32_16x16x32_bf16 v[172:175], v[40:43], v[8:11], v[172:175]
    ds_read_b128 v[28:31], v3 offset:512
    v_mfma_f32_16x16x32_bf16 v[204:207], v[48:51], v[8:11], 0
    v_mfma_f32_16x16x32_bf16 v[204:207], v[52:55], v[12:15], v[204:207]
    buffer_load_dwordx4 v[92:95], v7, s[24:27], s38 offen offset:3072 sc1
    s_add_u32 s38, s38, 4096
    v_mfma_f32_16x16x32_bf16 v[236:239], v[60:63], v[12:15], 0
    v_mfma_f32_16x16x32_bf16 v[236:239], v[56:59], v[8:11], v[236:239]
    s_waitcnt lgkmcnt(2)
    v_mfma_f32_16x16x32_bf16 v[144:147], v[32:35], v[16:19], 0
    v_mfma_f32_16x16x32_bf16 v[144:147], v[36:39], v[20:23], v[144:147]
    v_mfma_f32_16x16x32_bf16 v[176:179], v[44:47], v[20:23], 0
    ds_read_b128 v[8:11], v0 offset:768
    v_mfma_f32_16x16x32_bf16 v[176:179], v[40:43], v[16:19], v[176:179]
    ds_read_b128 v[12:15], v1 offset:768
    v_mfma_f32_16x16x32_bf16 v[208:211], v[48:51], v[16:19], 0
    v_mfma_f32_16x16x32_bf16 v[208:211], v[52:55], v[20:23], v[208:211]
    v_mfma_f32_16x16x32_bf16 v[240:243], v[60:63], v[20:23], 0
    v_mfma_f32_16x16x32_bf16 v[240:243], v[56:59], v[16:19], v[240:243]
    s_waitcnt lgkmcnt(2)
    v_mfma_f32_16x16x32_bf16 v[148:151], v[32:35], v[24:27], 0
    v_mfma_f32_16x16x32_bf16 v[148:151], v[36:39], v[28:31], v[148:151]
    v_mfma_f32_16x16x32_bf16 v[180:183], v[44:47], v[28:31], 0
    ds_read_b128 v[16:19], v2 offset:768
    v_mfma_f32_16x16x32_bf16 v[180:183], v[40:43], v[24:27], v[180:183]
    ds_read_b128 v[20:23], v3 offset:768
    v_mfma_f32_16x16x32_bf16 v[212:215], v[48:51], v[24:27], 0
    v_mfma_f32_16x16x32_bf16 v[212:215], v[52:55], v[28:31], v[212:215]
    v_mfma_f32_16x16x32_bf16 v[244:247], v[60:63], v[28:31], 0
    v_mfma_f32_16x16x32_bf16 v[244:247], v[56:59], v[24:27], v[244:247]
    s_waitcnt lgkmcnt(2)
    v_mfma_f32_16x16x32_bf16 v[152:155], v[32:35], v[8:11], 0
    v_mfma_f32_16x16x32_bf16 v[152:155], v[36:39], v[12:15], v[152:155]
    v_mfma_f32_16x16x32_bf16 v[184:187], v[44:47], v[12:15], 0
    ds_read_b128 v[24:27], v0 offset:16384
    v_mfma_f32_16x16x32_bf16 v[184:187], v[40:43], v[8:11], v[184:187]
    ds_read_b128 v[28:31], v1 offset:16384
    v_mfma_f32_16x16x32_bf16 v[216:219], v[48:51], v[8:11], 0
    v_mfma_f32_16x16x32_bf16 v[216:219], v[52:55], v[12:15], v[216:219]
    v_mfma_f32_16x16x32_bf16 v[248:251], v[60:63], v[12:15], 0
    v_mfma_f32_16x16x32_bf16 v[248:251], v[56:59], v[8:11], v[248:251]
    s_waitcnt lgkmcnt(2)
    v_mfma_f32_16x16x32_bf16 v[156:159], v[32:35], v[16:19], 0
    v_mfma_f32_16x16x32_bf16 v[156:159], v[36:39], v[20:23], v[156:159]
    v_mfma_f32_16x16x32_bf16 v[188:191], v[44:47], v[20:23], 0
    ds_read_b128 v[8:11], v2 offset:16384
    v_mfma_f32_16x16x32_bf16 v[188:191], v[40:43], v[16:19], v[188:191]
    ds_read_b128 v[12:15], v3 offset:16384
    v_mfma_f32_16x16x32_bf16 v[220:223], v[48:51], v[16:19], 0
    v_mfma_f32_16x16x32_bf16 v[220:223], v[52:55], v[20:23], v[220:223]
    v_mfma_f32_16x16x32_bf16 v[252:255], v[60:63], v[20:23], 0
    v_mfma_f32_16x16x32_bf16 v[252:255], v[56:59], v[16:19], v[252:255]
    s_waitcnt lgkmcnt(2)
    s_waitcnt vmcnt(6)
    v_mfma_f32_16x16x32_bf16 v[128:131], v[64:67], v[24:27], v[128:131]
    v_mfma_f32_16x16x32_bf16 v[128:131], v[68:71], v[28:31], v[128:131]
    buffer_load_dwordx4 v[32:35], v7, s[24:27], s38 offen offset:0 sc1
    s_waitcnt vmcnt(5)
    v_mfma_f32_16x16x32_bf16 v[160:163], v[76:79], v[28:31], v[160:163]
    s_setprio 2
    ds_read_b128 v[16:19], v0 offset:16640
    v_mfma_f32_16x16x32_bf16 v[160:163], v[72:75], v[24:27], v[160:163]
    ds_read_b128 v[20:23], v1 offset:16640
    s_waitcnt vmcnt(3)
    v_mfma_f32_16x16x32_bf16 v[192:195], v[80:83], v[24:27], v[192:195]
    v_mfma_f32_16x16x32_bf16 v[192:195], v[84:87], v[28:31], v[192:195]
    buffer_load_dwordx4 v[36:39], v7, s[24:27], s38 offen offset:1024 sc1
    s_waitcnt vmcnt(2)
    v_mfma_f32_16x16x32_bf16 v[224:227], v[92:95], v[28:31], v[224:227]
    v_mfma_f32_16x16x32_bf16 v[224:227], v[88:91], v[24:27], v[224:227]
    s_waitcnt lgkmcnt(2)
    v_mfma_f32_16x16x32_bf16 v[132:135], v[64:67], v[8:11], v[132:135]
    v_mfma_f32_16x16x32_bf16 v[132:135], v[68:71], v[12:15], v[132:135]
    buffer_load_dwordx4 v[40:43], v7, s[24:27], s38 offen offset:2048 sc1
    v_mfma_f32_16x16x32_bf16 v[164:167], v[76:79], v[12:15], v[164:167]
    ds_read_b128 v[24:27], v2 offset:16640
    v_mfma_f32_16x16x32_bf16 v[164:167], v[72:75], v[8:11], v[164:167]
    ds_read_b128 v[28:31], v3 offset:16640
    v_mfma_f32_16x16x32_bf16 v[196:199], v[80:83], v[8:11], v[196:199]
    v_mfma_f32_16x16x32_bf16 v[196:199], v[84:87], v[12:15], v[196:199]
    buffer_load_dwordx4 v[44:47], v7, s[24:27], s38 offen offset:3072 sc1
    s_add_u32 s38, s38, 4096
    v_mfma_f32_16x16x32_bf16 v[228:231], v[92:95], v[12:15], v[228:231]
    v_mfma_f32_16x16x32_bf16 v[228:231], v[88:91], v[8:11], v[228:231]
    s_waitcnt lgkmcnt(2)
    v_mfma_f32_16x16x32_bf16 v[136:139], v[64:67], v[16:19], v[136:139]
    v_mfma_f32_16x16x32_bf16 v[136:139], v[68:71], v[20:23], v[136:139]
    buffer_load_dwordx4 v[48:51], v7, s[24:27], s38 offen offset:0 sc1
    v_mfma_f32_16x16x32_bf16 v[168:171], v[76:79], v[20:23], v[168:171]
    ds_read_b128 v[8:11], v0 offset:16896
    v_mfma_f32_16x16x32_bf16 v[168:171], v[72:75], v[16:19], v[168:171]
    ds_read_b128 v[12:15], v1 offset:16896
    v_mfma_f32_16x16x32_bf16 v[200:203], v[80:83], v[16:19], v[200:203]
    v_mfma_f32_16x16x32_bf16 v[200:203], v[84:87], v[20:23], v[200:203]
    buffer_load_dwordx4 v[52:55], v7, s[24:27], s38 offen offset:1024 sc1
    v_mfma_f32_16x16x32_bf16 v[232:235], v[92:95], v[20:23], v[232:235]
    v_mfma_f32_16x16x32_bf16 v[232:235], v[88:91], v[16:19], v[232:235]
    s_waitcnt lgkmcnt(2)
    v_mfma_f32_16x16x32_bf16 v[140:143], v[64:67], v[24:27], v[140:143]
    v_mfma_f32_16x16x32_bf16 v[140:143], v[68:71], v[28:31], v[140:143]
    buffer_load_dwordx4 v[56:59], v7, s[24:27], s38 offen offset:2048 sc1
    v_mfma_f32_16x16x32_bf16 v[172:175], v[76:79], v[28:31], v[172:175]
    ds_read_b128 v[16:19], v2 offset:16896
    v_mfma_f32_16x16x32_bf16 v[172:175], v[72:75], v[24:27], v[172:175]
    ds_read_b128 v[20:23], v3 offset:16896
    v_mfma_f32_16x16x32_bf16 v[204:207], v[80:83], v[24:27], v[204:207]
    v_mfma_f32_16x16x32_bf16 v[204:207], v[84:87], v[28:31], v[204:207]
    buffer_load_dwordx4 v[60:63], v7, s[24:27], s38 offen offset:3072 sc1
    s_add_u32 s38, s38, 4096
    v_mfma_f32_16x16x32_bf16 v[236:239], v[92:95], v[28:31], v[236:239]
    v_mfma_f32_16x16x32_bf16 v[236:239], v[88:91], v[24:27], v[236:239]
    s_waitcnt lgkmcnt(2)
    v_mfma_f32_16x16x32_bf16 v[144:147], v[64:67], v[8:11], v[144:147]
    v_mfma_f32_16x16x32_bf16 v[144:147], v[68:71], v[12:15], v[144:147]
    v_mfma_f32_16x16x32_bf16 v[176:179], v[76:79], v[12:15], v[176:179]
    ds_read_b128 v[24:27], v0 offset:17152
    v_mfma_f32_16x16x32_bf16 v[176:179], v[72:75], v[8:11], v[176:179]
    ds_read_b128 v[28:31], v1 offset:17152
    v_mfma_f32_16x16x32_bf16 v[208:211], v[80:83], v[8:11], v[208:211]
    v_mfma_f32_16x16x32_bf16 v[208:211], v[84:87], v[12:15], v[208:211]
    v_mfma_f32_16x16x32_bf16 v[240:243], v[92:95], v[12:15], v[240:243]
    v_mfma_f32_16x16x32_bf16 v[240:243], v[88:91], v[8:11], v[240:243]
    s_waitcnt lgkmcnt(2)
    v_mfma_f32_16x16x32_bf16 v[148:151], v[64:67], v[16:19], v[148:151]
    v_mfma_f32_16x16x32_bf16 v[148:151], v[68:71], v[20:23], v[148:151]
    v_mfma_f32_16x16x32_bf16 v[180:183], v[76:79], v[20:23], v[180:183]
    ds_read_b128 v[8:11], v2 offset:17152
    v_mfma_f32_16x16x32_bf16 v[180:183], v[72:75], v[16:19], v[180:183]
    ds_read_b128 v[12:15], v3 offset:17152
    v_mfma_f32_16x16x32_bf16 v[212:215], v[80:83], v[16:19], v[212:215]
    v_mfma_f32_16x16x32_bf16 v[212:215], v[84:87], v[20:23], v[212:215]
    v_mfma_f32_16x16x32_bf16 v[244:247], v[92:95], v[20:23], v[244:247]
    v_mfma_f32_16x16x32_bf16 v[244:247], v[88:91], v[16:19], v[244:247]
    s_waitcnt lgkmcnt(2)
    v_mfma_f32_16x16x32_bf16 v[152:155], v[64:67], v[24:27], v[152:155]
    v_mfma_f32_16x16x32_bf16 v[152:155], v[68:71], v[28:31], v[152:155]
    v_mfma_f32_16x16x32_bf16 v[184:187], v[76:79], v[28:31], v[184:187]
    ds_read_b128 v[16:19], v0 offset:32768
    v_mfma_f32_16x16x32_bf16 v[184:187], v[72:75], v[24:27], v[184:187]
    ds_read_b128 v[20:23], v1 offset:32768
    v_mfma_f32_16x16x32_bf16 v[216:219], v[80:83], v[24:27], v[216:219]
    v_mfma_f32_16x16x32_bf16 v[216:219], v[84:87], v[28:31], v[216:219]
    v_mfma_f32_16x16x32_bf16 v[248:251], v[92:95], v[28:31], v[248:251]
    v_mfma_f32_16x16x32_bf16 v[248:251], v[88:91], v[24:27], v[248:251]
    s_waitcnt lgkmcnt(2)
    v_mfma_f32_16x16x32_bf16 v[156:159], v[64:67], v[8:11], v[156:159]
    v_mfma_f32_16x16x32_bf16 v[156:159], v[68:71], v[12:15], v[156:159]
    v_mfma_f32_16x16x32_bf16 v[188:191], v[76:79], v[12:15], v[188:191]
    ds_read_b128 v[24:27], v2 offset:32768
    v_mfma_f32_16x16x32_bf16 v[188:191], v[72:75], v[8:11], v[188:191]
    ds_read_b128 v[28:31], v3 offset:32768
    v_mfma_f32_16x16x32_bf16 v[220:223], v[80:83], v[8:11], v[220:223]
    v_mfma_f32_16x16x32_bf16 v[220:223], v[84:87], v[12:15], v[220:223]
    v_mfma_f32_16x16x32_bf16 v[252:255], v[92:95], v[12:15], v[252:255]
    v_mfma_f32_16x16x32_bf16 v[252:255], v[88:91], v[8:11], v[252:255]
    s_waitcnt lgkmcnt(2)
    s_waitcnt vmcnt(6)
    v_mfma_f32_16x16x32_bf16 v[128:131], v[32:35], v[16:19], v[128:131]
    v_mfma_f32_16x16x32_bf16 v[128:131], v[36:39], v[20:23], v[128:131]
    buffer_load_dwordx4 v[64:67], v7, s[24:27], s38 offen offset:0 sc1
    s_waitcnt vmcnt(5)
    v_mfma_f32_16x16x32_bf16 v[160:163], v[44:47], v[20:23], v[160:163]
    ds_read_b128 v[8:11], v0 offset:33024
    v_mfma_f32_16x16x32_bf16 v[160:163], v[40:43], v[16:19], v[160:163]
    ds_read_b128 v[12:15], v1 offset:33024
    s_waitcnt vmcnt(3)
    v_mfma_f32_16x16x32_bf16 v[192:195], v[48:51], v[16:19], v[192:195]
    v_mfma_f32_16x16x32_bf16 v[192:195], v[52:55], v[20:23], v[192:195]
    buffer_load_dwordx4 v[68:71], v7, s[24:27], s38 offen offset:1024 sc1
    s_waitcnt vmcnt(2)
    v_mfma_f32_16x16x32_bf16 v[224:227], v[60:63], v[20:23], v[224:227]
    v_mfma_f32_16x16x32_bf16 v[224:227], v[56:59], v[16:19], v[224:227]
    s_waitcnt lgkmcnt(2)
    v_mfma_f32_16x16x32_bf16 v[132:135], v[32:35], v[24:27], v[132:135]
    v_mfma_f32_16x16x32_bf16 v[132:135], v[36:39], v[28:31], v[132:135]
    buffer_load_dwordx4 v[72:75], v7, s[24:27], s38 offen offset:2048 sc1
    v_mfma_f32_16x16x32_bf16 v[164:167], v[44:47], v[28:31], v[164:167]
    ds_read_b128 v[16:19], v2 offset:33024
    v_mfma_f32_16x16x32_bf16 v[164:167], v[40:43], v[24:27], v[164:167]
    ds_read_b128 v[20:23], v3 offset:33024
    v_mfma_f32_16x16x32_bf16 v[196:199], v[48:51], v[24:27], v[196:199]
    v_mfma_f32_16x16x32_bf16 v[196:199], v[52:55], v[28:31], v[196:199]
    buffer_load_dwordx4 v[76:79], v7, s[24:27], s38 offen offset:3072 sc1
    s_add_u32 s38, s38, 4096
    v_mfma_f32_16x16x32_bf16 v[228:231], v[60:63], v[28:31], v[228:231]
    v_mfma_f32_16x16x32_bf16 v[228:231], v[56:59], v[24:27], v[228:231]
    s_waitcnt lgkmcnt(2)
    v_mfma_f32_16x16x32_bf16 v[136:139], v[32:35], v[8:11], v[136:139]
    v_mfma_f32_16x16x32_bf16 v[136:139], v[36:39], v[12:15], v[136:139]
    buffer_load_dwordx4 v[80:83], v7, s[24:27], s38 offen offset:0 sc1
    v_mfma_f32_16x16x32_bf16 v[168:171], v[44:47], v[12:15], v[168:171]
    ds_read_b128 v[24:27], v0 offset:33280
    v_mfma_f32_16x16x32_bf16 v[168:171], v[40:43], v[8:11], v[168:171]
    ds_read_b128 v[28:31], v1 offset:33280
    v_mfma_f32_16x16x32_bf16 v[200:203], v[48:51], v[8:11], v[200:203]
    v_mfma_f32_16x16x32_bf16 v[200:203], v[52:55], v[12:15], v[200:203]
    buffer_load_dwordx4 v[84:87], v7, s[24:27], s38 offen offset:1024 sc1
    v_mfma_f32_16x16x32_bf16 v[232:235], v[60:63], v[12:15], v[232:235]
    v_mfma_f32_16x16x32_bf16 v[232:235], v[56:59], v[8:11], v[232:235]
    s_waitcnt lgkmcnt(2)
    v_mfma_f32_16x16x32_bf16 v[140:143], v[32:35], v[16:19], v[140:143]
    v_mfma_f32_16x16x32_bf16 v[140:143], v[36:39], v[20:23], v[140:143]
    buffer_load_dwordx4 v[88:91], v7, s[24:27], s38 offen offset:2048 sc1
    v_mfma_f32_16x16x32_bf16 v[172:175], v[44:47], v[20:23], v[172:175]
    ds_read_b128 v[8:11], v2 offset:33280
    v_mfma_f32_16x16x32_bf16 v[172:175], v[40:43], v[16:19], v[172:175]
    ds_read_b128 v[12:15], v3 offset:33280
    v_mfma_f32_16x16x32_bf16 v[204:207], v[48:51], v[16:19], v[204:207]
    v_mfma_f32_16x16x32_bf16 v[204:207], v[52:55], v[20:23], v[204:207]
    buffer_load_dwordx4 v[92:95], v7, s[24:27], s38 offen offset:3072 sc1
    s_add_u32 s38, s38, 4096
    v_mfma_f32_16x16x32_bf16 v[236:239], v[60:63], v[20:23], v[236:239]
    v_mfma_f32_16x16x32_bf16 v[236:239], v[56:59], v[16:19], v[236:239]
    s_waitcnt lgkmcnt(2)
    v_mfma_f32_16x16x32_bf16 v[144:147], v[32:35], v[24:27], v[144:147]
    v_mfma_f32_16x16x32_bf16 v[144:147], v[36:39], v[28:31], v[144:147]
    v_mfma_f32_16x16x32_bf16 v[176:179], v[44:47], v[28:31], v[176:179]
    ds_read_b128 v[16:19], v0 offset:33536
    v_mfma_f32_16x16x32_bf16 v[176:179], v[40:43], v[24:27], v[176:179]
    ds_read_b128 v[20:23], v1 offset:33536
    v_mfma_f32_16x16x32_bf16 v[208:211], v[48:51], v[24:27], v[208:211]
    v_mfma_f32_16x16x32_bf16 v[208:211], v[52:55], v[28:31], v[208:211]
    v_mfma_f32_16x16x32_bf16 v[240:243], v[60:63], v[28:31], v[240:243]
    v_mfma_f32_16x16x32_bf16 v[240:243], v[56:59], v[24:27], v[240:243]
    s_waitcnt lgkmcnt(2)
    v_mfma_f32_16x16x32_bf16 v[148:151], v[32:35], v[8:11], v[148:151]
    v_mfma_f32_16x16x32_bf16 v[148:151], v[36:39], v[12:15], v[148:151]
    v_mfma_f32_16x16x32_bf16 v[180:183], v[44:47], v[12:15], v[180:183]
    ds_read_b128 v[24:27], v2 offset:33536
    v_mfma_f32_16x16x32_bf16 v[180:183], v[40:43], v[8:11], v[180:183]
    ds_read_b128 v[28:31], v3 offset:33536
    v_mfma_f32_16x16x32_bf16 v[212:215], v[48:51], v[8:11], v[212:215]
    v_mfma_f32_16x16x32_bf16 v[212:215], v[52:55], v[12:15], v[212:215]
    v_mfma_f32_16x16x32_bf16 v[244:247], v[60:63], v[12:15], v[244:247]
    v_mfma_f32_16x16x32_bf16 v[244:247], v[56:59], v[8:11], v[244:247]
    s_waitcnt lgkmcnt(2)
    v_mfma_f32_16x16x32_bf16 v[152:155], v[32:35], v[16:19], v[152:155]
    v_mfma_f32_16x16x32_bf16 v[152:155], v[36:39], v[20:23], v[152:155]
    v_mfma_f32_16x16x32_bf16 v[184:187], v[44:47], v[20:23], v[184:187]
    ds_read_b128 v[8:11], v0 offset:49152
    v_mfma_f32_16x16x32_bf16 v[184:187], v[40:43], v[16:19], v[184:187]
    ds_read_b128 v[12:15], v1 offset:49152
    v_mfma_f32_16x16x32_bf16 v[216:219], v[48:51], v[16:19], v[216:219]
    v_mfma_f32_16x16x32_bf16 v[216:219], v[52:55], v[20:23], v[216:219]
    v_mfma_f32_16x16x32_bf16 v[248:251], v[60:63], v[20:23], v[248:251]
    v_mfma_f32_16x16x32_bf16 v[248:251], v[56:59], v[16:19], v[248:251]
    s_waitcnt lgkmcnt(2)
    v_mfma_f32_16x16x32_bf16 v[156:159], v[32:35], v[24:27], v[156:159]
    v_mfma_f32_16x16x32_bf16 v[156:159], v[36:39], v[28:31], v[156:159]
    v_mfma_f32_16x16x32_bf16 v[188:191], v[44:47], v[28:31], v[188:191]
    ds_read_b128 v[16:19], v2 offset:49152
    v_mfma_f32_16x16x32_bf16 v[188:191], v[40:43], v[24:27], v[188:191]
    ds_read_b128 v[20:23], v3 offset:49152
    v_mfma_f32_16x16x32_bf16 v[220:223], v[48:51], v[24:27], v[220:223]
    v_mfma_f32_16x16x32_bf16 v[220:223], v[52:55], v[28:31], v[220:223]
    v_mfma_f32_16x16x32_bf16 v[252:255], v[60:63], v[28:31], v[252:255]
    v_mfma_f32_16x16x32_bf16 v[252:255], v[56:59], v[24:27], v[252:255]
    s_waitcnt lgkmcnt(2)
    s_waitcnt vmcnt(6)
    v_mfma_f32_16x16x32_bf16 v[128:131], v[64:67], v[8:11], v[128:131]
    v_mfma_f32_16x16x32_bf16 v[128:131], v[68:71], v[12:15], v[128:131]
    buffer_load_dwordx4 v[32:35], v7, s[24:27], s38 offen offset:0 sc1
    s_waitcnt vmcnt(5)
    v_mfma_f32_16x16x32_bf16 v[160:163], v[76:79], v[12:15], v[160:163]
    ds_read_b128 v[24:27], v0 offset:49408
    v_mfma_f32_16x16x32_bf16 v[160:163], v[72:75], v[8:11], v[160:163]
    ds_read_b128 v[28:31], v1 offset:49408
    s_waitcnt vmcnt(3)
    v_mfma_f32_16x16x32_bf16 v[192:195], v[80:83], v[8:11], v[192:195]
    v_mfma_f32_16x16x32_bf16 v[192:195], v[84:87], v[12:15], v[192:195]
    buffer_load_dwordx4 v[36:39], v7, s[24:27], s38 offen offset:1024 sc1
    s_waitcnt vmcnt(2)
    v_mfma_f32_16x16x32_bf16 v[224:227], v[92:95], v[12:15], v[224:227]
    v_mfma_f32_16x16x32_bf16 v[224:227], v[88:91], v[8:11], v[224:227]
    s_waitcnt lgkmcnt(2)
    v_mfma_f32_16x16x32_bf16 v[132:135], v[64:67], v[16:19], v[132:135]
    v_mfma_f32_16x16x32_bf16 v[132:135], v[68:71], v[20:23], v[132:135]
    buffer_load_dwordx4 v[40:43], v7, s[24:27], s38 offen offset:2048 sc1
    v_mfma_f32_16x16x32_bf16 v[164:167], v[76:79], v[20:23], v[164:167]
    ds_read_b128 v[8:11], v2 offset:49408
    v_mfma_f32_16x16x32_bf16 v[164:167], v[72:75], v[16:19], v[164:167]
    ds_read_b128 v[12:15], v3 offset:49408
    v_mfma_f32_16x16x32_bf16 v[196:199], v[80:83], v[16:19], v[196:199]
    v_mfma_f32_16x16x32_bf16 v[196:199], v[84:87], v[20:23], v[196:199]
    buffer_load_dwordx4 v[44:47], v7, s[24:27], s38 offen offset:3072 sc1
    s_add_u32 s38, s38, 4096
    v_mfma_f32_16x16x32_bf16 v[228:231], v[92:95], v[20:23], v[228:231]
    v_mfma_f32_16x16x32_bf16 v[228:231], v[88:91], v[16:19], v[228:231]
    s_waitcnt lgkmcnt(2)
    v_mfma_f32_16x16x32_bf16 v[136:139], v[64:67], v[24:27], v[136:139]
    v_mfma_f32_16x16x32_bf16 v[136:139], v[68:71], v[28:31], v[136:139]
    buffer_load_dwordx4 v[48:51], v7, s[24:27], s38 offen offset:0 sc1
    v_mfma_f32_16x16x32_bf16 v[168:171], v[76:79], v[28:31], v[168:171]
    ds_read_b128 v[16:19], v0 offset:49664
    v_mfma_f32_16x16x32_bf16 v[168:171], v[72:75], v[24:27], v[168:171]
    ds_read_b128 v[20:23], v1 offset:49664
    v_mfma_f32_16x16x32_bf16 v[200:203], v[80:83], v[24:27], v[200:203]
    v_mfma_f32_16x16x32_bf16 v[200:203], v[84:87], v[28:31], v[200:203]
    buffer_load_dwordx4 v[52:55], v7, s[24:27], s38 offen offset:1024 sc1
    v_mfma_f32_16x16x32_bf16 v[232:235], v[92:95], v[28:31], v[232:235]
    v_mfma_f32_16x16x32_bf16 v[232:235], v[88:91], v[24:27], v[232:235]
    s_waitcnt lgkmcnt(2)
    v_mfma_f32_16x16x32_bf16 v[140:143], v[64:67], v[8:11], v[140:143]
    v_mfma_f32_16x16x32_bf16 v[140:143], v[68:71], v[12:15], v[140:143]
    buffer_load_dwordx4 v[56:59], v7, s[24:27], s38 offen offset:2048 sc1
    v_mfma_f32_16x16x32_bf16 v[172:175], v[76:79], v[12:15], v[172:175]
    ds_read_b128 v[24:27], v2 offset:49664
    v_mfma_f32_16x16x32_bf16 v[172:175], v[72:75], v[8:11], v[172:175]
    ds_read_b128 v[28:31], v3 offset:49664
    v_mfma_f32_16x16x32_bf16 v[204:207], v[80:83], v[8:11], v[204:207]
    v_mfma_f32_16x16x32_bf16 v[204:207], v[84:87], v[12:15], v[204:207]
    buffer_load_dwordx4 v[60:63], v7, s[24:27], s38 offen offset:3072 sc1
    s_add_u32 s38, s38, 4096
    v_mfma_f32_16x16x32_bf16 v[236:239], v[92:95], v[12:15], v[236:239]
    v_mfma_f32_16x16x32_bf16 v[236:239], v[88:91], v[8:11], v[236:239]
    s_waitcnt lgkmcnt(2)
    v_mfma_f32_16x16x32_bf16 v[144:147], v[64:67], v[16:19], v[144:147]
    v_mfma_f32_16x16x32_bf16 v[144:147], v[68:71], v[20:23], v[144:147]
    v_mfma_f32_16x16x32_bf16 v[176:179], v[76:79], v[20:23], v[176:179]
    ds_read_b128 v[8:11], v0 offset:49920
    v_mfma_f32_16x16x32_bf16 v[176:179], v[72:75], v[16:19], v[176:179]
    ds_read_b128 v[12:15], v1 offset:49920
    v_mfma_f32_16x16x32_bf16 v[208:211], v[80:83], v[16:19], v[208:211]
    v_mfma_f32_16x16x32_bf16 v[208:211], v[84:87], v[20:23], v[208:211]
    v_mfma_f32_16x16x32_bf16 v[240:243], v[92:95], v[20:23], v[240:243]
    v_mfma_f32_16x16x32_bf16 v[240:243], v[88:91], v[16:19], v[240:243]
    s_waitcnt lgkmcnt(2)
    v_mfma_f32_16x16x32_bf16 v[148:151], v[64:67], v[24:27], v[148:151]
    v_mfma_f32_16x16x32_bf16 v[148:151], v[68:71], v[28:31], v[148:151]
    v_mfma_f32_16x16x32_bf16 v[180:183], v[76:79], v[28:31], v[180:183]
    ds_read_b128 v[16:19], v2 offset:49920
    v_mfma_f32_16x16x32_bf16 v[180:183], v[72:75], v[24:27], v[180:183]
    ds_read_b128 v[20:23], v3 offset:49920
    v_mfma_f32_16x16x32_bf16 v[212:215], v[80:83], v[24:27], v[212:215]
    v_mfma_f32_16x16x32_bf16 v[212:215], v[84:87], v[28:31], v[212:215]
    v_mfma_f32_16x16x32_bf16 v[244:247], v[92:95], v[28:31], v[244:247]
    v_mfma_f32_16x16x32_bf16 v[244:247], v[88:91], v[24:27], v[244:247]
    s_waitcnt lgkmcnt(2)
    v_mfma_f32_16x16x32_bf16 v[152:155], v[64:67], v[8:11], v[152:155]
    v_mfma_f32_16x16x32_bf16 v[152:155], v[68:71], v[12:15], v[152:155]
    v_mfma_f32_16x16x32_bf16 v[184:187], v[76:79], v[12:15], v[184:187]
    v_add_u32 v0, 0x10000, v0
    v_add_u32 v1, 0x10000, v1
    ds_read_b128 v[24:27], v0 offset:0
    v_mfma_f32_16x16x32_bf16 v[184:187], v[72:75], v[8:11], v[184:187]
    ds_read_b128 v[28:31], v1 offset:0
    v_mfma_f32_16x16x32_bf16 v[216:219], v[80:83], v[8:11], v[216:219]
    v_mfma_f32_16x16x32_bf16 v[216:219], v[84:87], v[12:15], v[216:219]
    v_mfma_f32_16x16x32_bf16 v[248:251], v[92:95], v[12:15], v[248:251]
    v_mfma_f32_16x16x32_bf16 v[248:251], v[88:91], v[8:11], v[248:251]
    s_waitcnt lgkmcnt(2)
    v_mfma_f32_16x16x32_bf16 v[156:159], v[64:67], v[16:19], v[156:159]
    v_mfma_f32_16x16x32_bf16 v[156:159], v[68:71], v[20:23], v[156:159]
    v_mfma_f32_16x16x32_bf16 v[188:191], v[76:79], v[20:23], v[188:191]
    v_add_u32 v2, 0x10000, v2
    v_add_u32 v3, 0x10000, v3
    ds_read_b128 v[8:11], v2 offset:0
    v_mfma_f32_16x16x32_bf16 v[188:191], v[72:75], v[16:19], v[188:191]
    ds_read_b128 v[12:15], v3 offset:0
    v_mfma_f32_16x16x32_bf16 v[220:223], v[80:83], v[16:19], v[220:223]
    v_mfma_f32_16x16x32_bf16 v[220:223], v[84:87], v[20:23], v[220:223]
    v_mfma_f32_16x16x32_bf16 v[252:255], v[92:95], v[20:23], v[252:255]
    v_mfma_f32_16x16x32_bf16 v[252:255], v[88:91], v[16:19], v[252:255]
    s_waitcnt lgkmcnt(2)
    s_waitcnt vmcnt(6)
    v_mfma_f32_16x16x32_bf16 v[128:131], v[32:35], v[24:27], v[128:131]
    v_mfma_f32_16x16x32_bf16 v[128:131], v[36:39], v[28:31], v[128:131]
    buffer_load_dwordx4 v[64:67], v7, s[24:27], s38 offen offset:0 sc1
    s_waitcnt vmcnt(5)
    v_mfma_f32_16x16x32_bf16 v[160:163], v[44:47], v[28:31], v[160:163]
    s_cbranch_vccnz L_bar_y
L_barret_y:
    ds_read_b128 v[16:19], v0 offset:256
    v_mfma_f32_16x16x32_bf16 v[160:163], v[40:43], v[24:27], v[160:163]
    ds_read_b128 v[20:23], v1 offset:256
    s_waitcnt vmcnt(3)
    v_mfma_f32_16x16x32_bf16 v[192:195], v[48:51], v[24:27], v[192:195]
    v_mfma_f32_16x16x32_bf16 v[192:195], v[52:55], v[28:31], v[192:195]
    buffer_load_dwordx4 v[68:71], v7, s[24:27], s38 offen offset:1024 sc1
    s_waitcnt vmcnt(2)
    v_mfma_f32_16x16x32_bf16 v[224:227], v[60:63], v[28:31], v[224:227]
    v_mfma_f32_16x16x32_bf16 v[224:227], v[56:59], v[24:27], v[224:227]
    s_waitcnt lgkmcnt(2)
    v_mfma_f32_16x16x32_bf16 v[132:135], v[32:35], v[8:11], v[132:135]
    v_mfma_f32_16x16x32_bf16 v[132:135], v[36:39], v[12:15], v[132:135]
    buffer_load_dwordx4 v[72:75], v7, s[24:27], s38 offen offset:2048 sc1
    v_mfma_f32_16x16x32_bf16 v[164:167], v[44:47], v[12:15], v[164:167]
    ds_read_b128 v[24:27], v2 offset:256
    v_mfma_f32_16x16x32_bf16 v[164:167], v[40:43], v[8:11], v[164:167]
    ds_read_b128 v[28:31], v3 offset:256
    v_mfma_f32_16x16x32_bf16 v[196:199], v[48:51], v[8:11], v[196:199]
    v_mfma_f32_16x16x32_bf16 v[196:199], v[52:55], v[12:15], v[196:199]
    buffer_load_dwordx4 v[76:79], v7, s[24:27], s38 offen offset:3072 sc1
    s_add_u32 s38, s38, 4096
    v_mfma_f32_16x16x32_bf16 v[228:231], v[60:63], v[12:15], v[228:231]
    v_mfma_f32_16x16x32_bf16 v[228:231], v[56:59], v[8:11], v[228:231]
    s_waitcnt lgkmcnt(2)
    v_mfma_f32_16x16x32_bf16 v[136:139], v[32:35], v[16:19], v[136:139]
    v_mfma_f32_16x16x32_bf16 v[136:139], v[36:39], v[20:23], v[136:139]
    buffer_load_dwordx4 v[80:83], v7, s[24:27], s38 offen offset:0 sc1
    v_mfma_f32_16x16x32_bf16 v[168:171], v[44:47], v[20:23], v[168:171]
    ds_read_b128 v[8:11], v0 offset:512
    v_mfma_f32_16x16x32_bf16 v[168:171], v[40:43], v[16:19], v[168:171]
    ds_read_b128 v[12:15], v1 offset:512
    v_mfma_f32_16x16x32_bf16 v[200:203], v[48:51], v[16:19], v[200:203]
    v_mfma_f32_16x16x32_bf16 v[200:203], v[52:55], v[20:23], v[200:203]
    buffer_load_dwordx4 v[84:87], v7, s[24:27], s38 offen offset:1024 sc1
    v_mfma_f32_16x16x32_bf16 v[232:235], v[60:63], v[20:23], v[232:235]
    v_mfma_f32_16x16x32_bf16 v[232:235], v[56:59], v[16:19], v[232:235]
    s_waitcnt lgkmcnt(2)
    v_mfma_f32_16x16x32_bf16 v[140:143], v[32:35], v[24:27], v[140:143]
    v_mfma_f32_16x16x32_bf16 v[140:143], v[36:39], v[28:31], v[140:143]
    buffer_load_dwordx4 v[88:91], v7, s[24:27], s38 offen offset:2048 sc1
    v_mfma_f32_16x16x32_bf16 v[172:175], v[44:47], v[28:31], v[172:175]
    ds_read_b128 v[16:19], v2 offset:512
    v_mfma_f32_16x16x32_bf16 v[172:175], v[40:43], v[24:27], v[172:175]
    ds_read_b128 v[20:23], v3 offset:512
    v_mfma_f32_16x16x32_bf16 v[204:207], v[48:51], v[24:27], v[204:207]
    v_mfma_f32_16x16x32_bf16 v[204:207], v[52:55], v[28:31], v[204:207]
    buffer_load_dwordx4 v[92:95], v7, s[24:27], s38 offen offset:3072 sc1
    s_add_u32 s38, s38, 4096
    v_mfma_f32_16x16x32_bf16 v[236:239], v[60:63], v[28:31], v[236:239]
    v_mfma_f32_16x16x32_bf16 v[236:239], v[56:59], v[24:27], v[236:239]
    s_waitcnt lgkmcnt(2)
    v_mfma_f32_16x16x32_bf16 v[144:147], v[32:35], v[8:11], v[144:147]
    v_mfma_f32_16x16x32_bf16 v[144:147], v[36:39], v[12:15], v[144:147]
    v_mfma_f32_16x16x32_bf16 v[176:179], v[44:47], v[12:15], v[176:179]
    ds_read_b128 v[24:27], v0 offset:768
    v_mfma_f32_16x16x32_bf16 v[176:179], v[40:43], v[8:11], v[176:179]
    ds_read_b128 v[28:31], v1 offset:768
    v_mfma_f32_16x16x32_bf16 v[208:211], v[48:51], v[8:11], v[208:211]
    v_mfma_f32_16x16x32_bf16 v[208:211], v[52:55], v[12:15], v[208:211]
    v_mfma_f32_16x16x32_bf16 v[240:243], v[60:63], v[12:15], v[240:243]
    v_mfma_f32_16x16x32_bf16 v[240:243], v[56:59], v[8:11], v[240:243]
    s_waitcnt lgkmcnt(2)
    v_mfma_f32_16x16x32_bf16 v[148:151], v[32:35], v[16:19], v[148:151]
    v_mfma_f32_16x16x32_bf16 v[148:151], v[36:39], v[20:23], v[148:151]
    v_mfma_f32_16x16x32_bf16 v[180:183], v[44:47], v[20:23], v[180:183]
    ds_read_b128 v[8:11], v2 offset:768
    v_mfma_f32_16x16x32_bf16 v[180:183], v[40:43], v[16:19], v[180:183]
    ds_read_b128 v[12:15], v3 offset:768
    v_mfma_f32_16x16x32_bf16 v[212:215], v[48:51], v[16:19], v[212:215]
    v_mfma_f32_16x16x32_bf16 v[212:215], v[52:55], v[20:23], v[212:215]
    v_mfma_f32_16x16x32_bf16 v[244:247], v[60:63], v[20:23], v[244:247]
    v_mfma_f32_16x16x32_bf16 v[244:247], v[56:59], v[16:19], v[244:247]
    s_waitcnt lgkmcnt(2)
    v_mfma_f32_16x16x32_bf16 v[152:155], v[32:35], v[24:27], v[152:155]
    v_mfma_f32_16x16x32_bf16 v[152:155], v[36:39], v[28:31], v[152:155]
    v_mfma_f32_16x16x32_bf16 v[184:187], v[44:47], v[28:31], v[184:187]
    ds_read_b128 v[16:19], v0 offset:16384
    v_mfma_f32_16x16x32_bf16 v[184:187], v[40:43], v[24:27], v[184:187]
    ds_read_b128 v[20:23], v1 offset:16384
    v_mfma_f32_16x16x32_bf16 v[216:219], v[48:51], v[24:27], v[216:219]
    v_mfma_f32_16x16x32_bf16 v[216:219], v[52:55], v[28:31], v[216:219]
    v_mfma_f32_16x16x32_bf16 v[248:251], v[60:63], v[28:31], v[248:251]
    v_mfma_f32_16x16x32_bf16 v[248:251], v[56:59], v[24:27], v[248:251]
    s_waitcnt lgkmcnt(2)
    v_mfma_f32_16x16x32_bf16 v[156:159], v[32:35], v[8:11], v[156:159]
    v_mfma_f32_16x16x32_bf16 v[156:159], v[36:39], v[12:15], v[156:159]
    v_mfma_f32_16x16x32_bf16 v[188:191], v[44:47], v[12:15], v[188:191]
    ds_read_b128 v[24:27], v2 offset:16384
    v_mfma_f32_16x16x32_bf16 v[188:191], v[40:43], v[8:11], v[188:191]
    ds_read_b128 v[28:31], v3 offset:16384
    v_mfma_f32_16x16x32_bf16 v[220:223], v[48:51], v[8:11], v[220:223]
    v_mfma_f32_16x16x32_bf16 v[220:223], v[52:55], v[12:15], v[220:223]
    v_mfma_f32_16x16x32_bf16 v[252:255], v[60:63], v[12:15], v[252:255]
    v_mfma_f32_16x16x32_bf16 v[252:255], v[56:59], v[8:11], v[252:255]
    s_waitcnt lgkmcnt(2)
    s_waitcnt vmcnt(6)
    v_mfma_f32_16x16x32_bf16 v[128:131], v[64:67], v[16:19], v[128:131]
    v_mfma_f32_16x16x32_bf16 v[128:131], v[68:71], v[20:23], v[128:131]
    buffer_load_dwordx4 v[32:35], v7, s[24:27], s38 offen offset:0 sc1
    s_waitcnt vmcnt(5)
    v_mfma_f32_16x16x32_bf16 v[160:163], v[76:79], v[20:23], v[160:163]
    ds_read_b128 v[8:11], v0 offset:16640
    v_mfma_f32_16x16x32_bf16 v[160:163], v[72:75], v[16:19], v[160:163]
    ds_read_b128 v[12:15], v1 offset:16640
    s_waitcnt vmcnt(3)
    v_mfma_f32_16x16x32_bf16 v[192:195], v[80:83], v[16:19], v[192:195]
    v_mfma_f32_16x16x32_bf16 v[192:195], v[84:87], v[20:23], v[192:195]
    buffer_load_dwordx4 v[36:39], v7, s[24:27], s38 offen offset:1024 sc1
    s_waitcnt vmcnt(2)
    v_mfma_f32_16x16x32_bf16 v[224:227], v[92:95], v[20:23], v[224:227]
    v_mfma_f32_16x16x32_bf16 v[224:227], v[88:91], v[16:19], v[224:227]
    s_waitcnt lgkmcnt(2)
    v_mfma_f32_16x16x32_bf16 v[132:135], v[64:67], v[24:27], v[132:135]
    v_mfma_f32_16x16x32_bf16 v[132:135], v[68:71], v[28:31], v[132:135]
    buffer_load_dwordx4 v[40:43], v7, s[24:27], s38 offen offset:2048 sc1
    v_mfma_f32_16x16x32_bf16 v[164:167], v[76:79], v[28:31], v[164:167]
    ds_read_b128 v[16:19], v2 offset:16640
    v_mfma_f32_16x16x32_bf16 v[164:167], v[72:75], v[24:27], v[164:167]
    ds_read_b128 v[20:23], v3 offset:16640
    v_mfma_f32_16x16x32_bf16 v[196:199], v[80:83], v[24:27], v[196:199]
    v_mfma_f32_16x16x32_bf16 v[196:199], v[84:87], v[28:31], v[196:199]
    buffer_load_dwordx4 v[44:47], v7, s[24:27], s38 offen offset:3072 sc1
    s_add_u32 s38, s38, 4096
    v_mfma_f32_16x16x32_bf16 v[228:231], v[92:95], v[28:31], v[228:231]
    v_mfma_f32_16x16x32_bf16 v[228:231], v[88:91], v[24:27], v[228:231]
    s_waitcnt lgkmcnt(2)
    v_mfma_f32_16x16x32_bf16 v[136:139], v[64:67], v[8:11], v[136:139]
    v_mfma_f32_16x16x32_bf16 v[136:139], v[68:71], v[12:15], v[136:139]
    buffer_load_dwordx4 v[48:51], v7, s[24:27], s38 offen offset:0 sc1
    v_mfma_f32_16x16x32_bf16 v[168:171], v[76:79], v[12:15], v[168:171]
    ds_read_b128 v[24:27], v0 offset:16896
    v_mfma_f32_16x16x32_bf16 v[168:171], v[72:75], v[8:11], v[168:171]
    ds_read_b128 v[28:31], v1 offset:16896
    v_mfma_f32_16x16x32_bf16 v[200:203], v[80:83], v[8:11], v[200:203]
    v_mfma_f32_16x16x32_bf16 v[200:203], v[84:87], v[12:15], v[200:203]
    buffer_load_dwordx4 v[52:55], v7, s[24:27], s38 offen offset:1024 sc1
    v_mfma_f32_16x16x32_bf16 v[232:235], v[92:95], v[12:15], v[232:235]
    v_mfma_f32_16x16x32_bf16 v[232:235], v[88:91], v[8:11], v[232:235]
    s_waitcnt lgkmcnt(2)
    v_mfma_f32_16x16x32_bf16 v[140:143], v[64:67], v[16:19], v[140:143]
    v_mfma_f32_16x16x32_bf16 v[140:143], v[68:71], v[20:23], v[140:143]
    buffer_load_dwordx4 v[56:59], v7, s[24:27], s38 offen offset:2048 sc1
    v_mfma_f32_16x16x32_bf16 v[172:175], v[76:79], v[20:23], v[172:175]
    ds_read_b128 v[8:11], v2 offset:16896
    v_mfma_f32_16x16x32_bf16 v[172:175], v[72:75], v[16:19], v[172:175]
    ds_read_b128 v[12:15], v3 offset:16896
    v_mfma_f32_16x16x32_bf16 v[204:207], v[80:83], v[16:19], v[204:207]
    v_mfma_f32_16x16x32_bf16 v[204:207], v[84:87], v[20:23], v[204:207]
    buffer_load_dwordx4 v[60:63], v7, s[24:27], s38 offen offset:3072 sc1
    s_add_u32 s38, s38, 4096
    v_mfma_f32_16x16x32_bf16 v[236:239], v[92:95], v[20:23], v[236:239]
    v_mfma_f32_16x16x32_bf16 v[236:239], v[88:91], v[16:19], v[236:239]
    s_waitcnt lgkmcnt(2)
    v_mfma_f32_16x16x32_bf16 v[144:147], v[64:67], v[24:27], v[144:147]
    v_mfma_f32_16x16x32_bf16 v[144:147], v[68:71], v[28:31], v[144:147]
    v_mfma_f32_16x16x32_bf16 v[176:179], v[76:79], v[28:31], v[176:179]
    ds_read_b128 v[16:19], v0 offset:17152
    v_mfma_f32_16x16x32_bf16 v[176:179], v[72:75], v[24:27], v[176:179]
    ds_read_b128 v[20:23], v1 offset:17152
    v_mfma_f32_16x16x32_bf16 v[208:211], v[80:83], v[24:27], v[208:211]
    v_mfma_f32_16x16x32_bf16 v[208:211], v[84:87], v[28:31], v[208:211]
    v_mfma_f32_16x16x32_bf16 v[240:243], v[92:95], v[28:31], v[240:243]
    v_mfma_f32_16x16x32_bf16 v[240:243], v[88:91], v[24:27], v[240:243]
    s_waitcnt lgkmcnt(2)
    v_mfma_f32_16x16x32_bf16 v[148:151], v[64:67], v[8:11], v[148:151]
    v_mfma_f32_16x16x32_bf16 v[148:151], v[68:71], v[12:15], v[148:151]
    v_mfma_f32_16x16x32_bf16 v[180:183], v[76:79], v[12:15], v[180:183]
    ds_read_b128 v[24:27], v2 offset:17152
    v_mfma_f32_16x16x32_bf16 v[180:183], v[72:75], v[8:11], v[180:183]
    ds_read_b128 v[28:31], v3 offset:17152
    v_mfma_f32_16x16x32_bf16 v[212:215], v[80:83], v[8:11], v[212:215]
    v_mfma_f32_16x16x32_bf16 v[212:215], v[84:87], v[12:15], v[212:215]
    v_mfma_f32_16x16x32_bf16 v[244:247], v[92:95], v[12:15], v[244:247]
    v_mfma_f32_16x16x32_bf16 v[244:247], v[88:91], v[8:11], v[244:247]
    s_waitcnt lgkmcnt(2)
    v_mfma_f32_16x16x32_bf16 v[152:155], v[64:67], v[16:19], v[152:155]
    v_mfma_f32_16x16x32_bf16 v[152:155], v[68:71], v[20:23], v[152:155]
    v_mfma_f32_16x16x32_bf16 v[184:187], v[76:79], v[20:23], v[184:187]
    ds_read_b128 v[8:11], v0 offset:32768
    v_mfma_f32_16x16x32_bf16 v[184:187], v[72:75], v[16:19], v[184:187]
    ds_read_b128 v[12:15], v1 offset:32768
    v_mfma_f32_16x16x32_bf16 v[216:219], v[80:83], v[16:19], v[216:219]
    v_mfma_f32_16x16x32_bf16 v[216:219], v[84:87], v[20:23], v[216:219]
    v_mfma_f32_16x16x32_bf16 v[248:251], v[92:95], v[20:23], v[248:251]
    v_mfma_f32_16x16x32_bf16 v[248:251], v[88:91], v[16:19], v[248:251]
    s_waitcnt lgkmcnt(2)
    v_mfma_f32_16x16x32_bf16 v[156:159], v[64:67], v[24:27], v[156:159]
    v_mfma_f32_16x16x32_bf16 v[156:159], v[68:71], v[28:31], v[156:159]
    v_mfma_f32_16x16x32_bf16 v[188:191], v[76:79], v[28:31], v[188:191]
    ds_read_b128 v[16:19], v2 offset:32768
    v_mfma_f32_16x16x32_bf16 v[188:191], v[72:75], v[24:27], v[188:191]
    ds_read_b128 v[20:23], v3 offset:32768
    v_mfma_f32_16x16x32_bf16 v[220:223], v[80:83], v[24:27], v[220:223]
    v_mfma_f32_16x16x32_bf16 v[220:223], v[84:87], v[28:31], v[220:223]
    v_mfma_f32_16x16x32_bf16 v[252:255], v[92:95], v[28:31], v[252:255]
    v_mfma_f32_16x16x32_bf16 v[252:255], v[88:91], v[24:27], v[252:255]
    s_waitcnt lgkmcnt(2)
    s_waitcnt vmcnt(6)
    v_mfma_f32_16x16x32_bf16 v[128:131], v[32:35], v[8:11], v[128:131]
    v_mfma_f32_16x16x32_bf16 v[128:131], v[36:39], v[12:15], v[128:131]
    buffer_load_dwordx4 v[64:67], v7, s[24:27], s38 offen offset:0 sc1
    s_waitcnt vmcnt(5)
    v_mfma_f32_16x16x32_bf16 v[160:163], v[44:47], v[12:15], v[160:163]
    ds_read_b128 v[24:27], v0 offset:33024
    v_mfma_f32_16x16x32_bf16 v[160:163], v[40:43], v[8:11], v[160:163]
    ds_read_b128 v[28:31], v1 offset:33024
    s_waitcnt vmcnt(3)
    v_mfma_f32_16x16x32_bf16 v[192:195], v[48:51], v[8:11], v[192:195]
    v_mfma_f32_16x16x32_bf16 v[192:195], v[52:55], v[12:15], v[192:195]
    buffer_load_dwordx4 v[68:71], v7, s[24:27], s38 offen offset:1024 sc1
    s_waitcnt vmcnt(2)
    v_mfma_f32_16x16x32_bf16 v[224:227], v[60:63], v[12:15], v[224:227]
    v_mfma_f32_16x16x32_bf16 v[224:227], v[56:59], v[8:11], v[224:227]
    s_waitcnt lgkmcnt(2)
    v_mfma_f32_16x16x32_bf16 v[132:135], v[32:35], v[16:19], v[132:135]
    v_mfma_f32_16x16x32_bf16 v[132:135], v[36:39], v[20:23], v[132:135]
    buffer_load_dwordx4 v[72:75], v7, s[24:27], s38 offen offset:2048 sc1
    v_mfma_f32_16x16x32_bf16 v[164:167], v[44:47], v[20:23], v[164:167]
    ds_read_b128 v[8:11], v2 offset:33024
    v_mfma_f32_16x16x32_bf16 v[164:167], v[40:43], v[16:19], v[164:167]
    ds_read_b128 v[12:15], v3 offset:33024
    v_mfma_f32_16x16x32_bf16 v[196:199], v[48:51], v[16:19], v[196:199]
    v_mfma_f32_16x16x32_bf16 v[196:199], v[52:55], v[20:23], v[196:199]
    buffer_load_dwordx4 v[76:79], v7, s[24:27], s38 offen offset:3072 sc1
    s_add_u32 s38, s38, 4096
    v_mfma_f32_16x16x32_bf16 v[228:231], v[60:63], v[20:23], v[228:231]
    v_mfma_f32_16x16x32_bf16 v[228:231], v[56:59], v[16:19], v[228:231]
    s_waitcnt lgkmcnt(2)
    v_mfma_f32_16x16x32_bf16 v[136:139], v[32:35], v[24:27], v[136:139]
    v_mfma_f32_16x16x32_bf16 v[136:139], v[36:39], v[28:31], v[136:139]
    buffer_load_dwordx4 v[80:83], v7, s[24:27], s38 offen offset:0 sc1
    v_mfma_f32_16x16x32_bf16 v[168:171], v[44:47], v[28:31], v[168:171]
    ds_read_b128 v[16:19], v0 offset:33280
    v_mfma_f32_16x16x32_bf16 v[168:171], v[40:43], v[24:27], v[168:171]
    ds_read_b128 v[20:23], v1 offset:33280
    v_mfma_f32_16x16x32_bf16 v[200:203], v[48:51], v[24:27], v[200:203]
    v_mfma_f32_16x16x32_bf16 v[200:203], v[52:55], v[28:31], v[200:203]
    buffer_load_dwordx4 v[84:87], v7, s[24:27], s38 offen offset:1024 sc1
    v_mfma_f32_16x16x32_bf16 v[232:235], v[60:63], v[28:31], v[232:235]
    v_mfma_f32_16x16x32_bf16 v[232:235], v[56:59], v[24:27], v[232:235]
    s_waitcnt lgkmcnt(2)
    v_mfma_f32_16x16x32_bf16 v[140:143], v[32:35], v[8:11], v[140:143]
    v_mfma_f32_16x16x32_bf16 v[140:143], v[36:39], v[12:15], v[140:143]
    buffer_load_dwordx4 v[88:91], v7, s[24:27], s38 offen offset:2048 sc1
    v_mfma_f32_16x16x32_bf16 v[172:175], v[44:47], v[12:15], v[172:175]
    ds_read_b128 v[24:27], v2 offset:33280
    v_mfma_f32_16x16x32_bf16 v[172:175], v[40:43], v[8:11], v[172:175]
    ds_read_b128 v[28:31], v3 offset:33280
    v_mfma_f32_16x16x32_bf16 v[204:207], v[48:51], v[8:11], v[204:207]
    v_mfma_f32_16x16x32_bf16 v[204:207], v[52:55], v[12:15], v[204:207]
    buffer_load_dwordx4 v[92:95], v7, s[24:27], s38 offen offset:3072 sc1
    s_add_u32 s38, s38, 4096
    v_mfma_f32_16x16x32_bf16 v[236:239], v[60:63], v[12:15], v[236:239]
    v_mfma_f32_16x16x32_bf16 v[236:239], v[56:59], v[8:11], v[236:239]
    s_waitcnt lgkmcnt(2)
    v_mfma_f32_16x16x32_bf16 v[144:147], v[32:35], v[16:19], v[144:147]
    v_mfma_f32_16x16x32_bf16 v[144:147], v[36:39], v[20:23], v[144:147]
    v_mfma_f32_16x16x32_bf16 v[176:179], v[44:47], v[20:23], v[176:179]
    ds_read_b128 v[8:11], v0 offset:33536
    v_mfma_f32_16x16x32_bf16 v[176:179], v[40:43], v[16:19], v[176:179]
    ds_read_b128 v[12:15], v1 offset:33536
    v_mfma_f32_16x16x32_bf16 v[208:211], v[48:51], v[16:19], v[208:211]
    v_mfma_f32_16x16x32_bf16 v[208:211], v[52:55], v[20:23], v[208:211]
    v_mfma_f32_16x16x32_bf16 v[240:243], v[60:63], v[20:23], v[240:243]
    v_mfma_f32_16x16x32_bf16 v[240:243], v[56:59], v[16:19], v[240:243]
    s_waitcnt lgkmcnt(2)
    v_mfma_f32_16x16x32_bf16 v[148:151], v[32:35], v[24:27], v[148:151]
    v_mfma_f32_16x16x32_bf16 v[148:151], v[36:39], v[28:31], v[148:151]
    v_mfma_f32_16x16x32_bf16 v[180:183], v[44:47], v[28:31], v[180:183]
    ds_read_b128 v[16:19], v2 offset:33536
    v_mfma_f32_16x16x32_bf16 v[180:183], v[40:43], v[24:27], v[180:183]
    ds_read_b128 v[20:23], v3 offset:33536
    v_mfma_f32_16x16x32_bf16 v[212:215], v[48:51], v[24:27], v[212:215]
    v_mfma_f32_16x16x32_bf16 v[212:215], v[52:55], v[28:31], v[212:215]
    v_mfma_f32_16x16x32_bf16 v[244:247], v[60:63], v[28:31], v[244:247]
    v_mfma_f32_16x16x32_bf16 v[244:247], v[56:59], v[24:27], v[244:247]
    s_waitcnt lgkmcnt(2)
    v_mfma_f32_16x16x32_bf16 v[152:155], v[32:35], v[8:11], v[152:155]
    v_mfma_f32_16x16x32_bf16 v[152:155], v[36:39], v[12:15], v[152:155]
    v_mfma_f32_16x16x32_bf16 v[184:187], v[44:47], v[12:15], v[184:187]
    ds_read_b128 v[24:27], v0 offset:49152
    v_mfma_f32_16x16x32_bf16 v[184:187], v[40:43], v[8:11], v[184:187]
    ds_read_b128 v[28:31], v1 offset:49152
    v_mfma_f32_16x16x32_bf16 v[216:219], v[48:51], v[8:11], v[216:219]
    v_mfma_f32_16x16x32_bf16 v[216:219], v[52:55], v[12:15], v[216:219]
    v_mfma_f32_16x16x32_bf16 v[248:251], v[60:63], v[12:15], v[248:251]
    v_mfma_f32_16x16x32_bf16 v[248:251], v[56:59], v[8:11], v[248:251]
    s_waitcnt lgkmcnt(2)
    v_mfma_f32_16x16x32_bf16 v[156:159], v[32:35], v[16:19], v[156:159]
    v_mfma_f32_16x16x32_bf16 v[156:159], v[36:39], v[20:23], v[156:159]
    v_mfma_f32_16x16x32_bf16 v[188:191], v[44:47], v[20:23], v[188:191]
    ds_read_b128 v[8:11], v2 offset:49152
    v_mfma_f32_16x16x32_bf16 v[188:191], v[40:43], v[16:19], v[188:191]
    ds_read_b128 v[12:15], v3 offset:49152
    v_mfma_f32_16x16x32_bf16 v[220:223], v[48:51], v[16:19], v[220:223]
    v_mfma_f32_16x16x32_bf16 v[220:223], v[52:55], v[20:23], v[220:223]
    v_mfma_f32_16x16x32_bf16 v[252:255], v[60:63], v[20:23], v[252:255]
    v_mfma_f32_16x16x32_bf16 v[252:255], v[56:59], v[16:19], v[252:255]
    s_waitcnt lgkmcnt(2)
    s_waitcnt vmcnt(6)
    v_mfma_f32_16x16x32_bf16 v[128:131], v[64:67], v[24:27], v[128:131]
    v_mfma_f32_16x16x32_bf16 v[128:131], v[68:71], v[28:31], v[128:131]
    s_waitcnt vmcnt(4)
    v_mfma_f32_16x16x32_bf16 v[160:163], v[76:79], v[28:31], v[160:163]
    s_setprio 3
    ds_read_b128 v[16:19], v0 offset:49408
    v_mfma_f32_16x16x32_bf16 v[160:163], v[72:75], v[24:27], v[160:163]
    ds_read_b128 v[20:23], v1 offset:49408
    s_waitcnt vmcnt(2)
    v_mfma_f32_16x16x32_bf16 v[192:195], v[80:83], v[24:27], v[192:195]
    v_mfma_f32_16x16x32_bf16 v[192:195], v[84:87], v[28:31], v[192:195]
    s_waitcnt vmcnt(0)
    v_mfma_f32_16x16x32_bf16 v[224:227], v[92:95], v[28:31], v[224:227]
    v_mfma_f32_16x16x32_bf16 v[224:227], v[88:91], v[24:27], v[224:227]
    s_waitcnt lgkmcnt(2)
    v_mfma_f32_16x16x32_bf16 v[132:135], v[64:67], v[8:11], v[132:135]
    v_mfma_f32_16x16x32_bf16 v[132:135], v[68:71], v[12:15], v[132:135]
    v_mfma_f32_16x16x32_bf16 v[164:167], v[76:79], v[12:15], v[164:167]
    ds_read_b128 v[24:27], v2 offset:49408
    v_mfma_f32_16x16x32_bf16 v[164:167], v[72:75], v[8:11], v[164:167]
    ds_read_b128 v[28:31], v3 offset:49408
    v_mfma_f32_16x16x32_bf16 v[196:199], v[80:83], v[8:11], v[196:199]
    v_mfma_f32_16x16x32_bf16 v[196:199], v[84:87], v[12:15], v[196:199]
    v_mfma_f32_16x16x32_bf16 v[228:231], v[92:95], v[12:15], v[228:231]
    v_mfma_f32_16x16x32_bf16 v[228:231], v[88:91], v[8:11], v[228:231]
    s_waitcnt lgkmcnt(2)
    v_mfma_f32_16x16x32_bf16 v[136:139], v[64:67], v[16:19], v[136:139]
    v_mfma_f32_16x16x32_bf16 v[136:139], v[68:71], v[20:23], v[136:139]
    v_mfma_f32_16x16x32_bf16 v[168:171], v[76:79], v[20:23], v[168:171]
    ds_read_b128 v[8:11], v0 offset:49664
    v_mfma_f32_16x16x32_bf16 v[168:171], v[72:75], v[16:19], v[168:171]
    ds_read_b128 v[12:15], v1 offset:49664
    v_mfma_f32_16x16x32_bf16 v[200:203], v[80:83], v[16:19], v[200:203]
    v_mfma_f32_16x16x32_bf16 v[200:203], v[84:87], v[20:23], v[200:203]
    v_mfma_f32_16x16x32_bf16 v[232:235], v[92:95], v[20:23], v[232:235]
    v_mfma_f32_16x16x32_bf16 v[232:235], v[88:91], v[16:19], v[232:235]
    s_waitcnt lgkmcnt(2)
    v_mfma_f32_16x16x32_bf16 v[140:143], v[64:67], v[24:27], v[140:143]
    v_mfma_f32_16x16x32_bf16 v[140:143], v[68:71], v[28:31], v[140:143]
    v_mfma_f32_16x16x32_bf16 v[172:175], v[76:79], v[28:31], v[172:175]
    ds_read_b128 v[16:19], v2 offset:49664
    v_mfma_f32_16x16x32_bf16 v[172:175], v[72:75], v[24:27], v[172:175]
    ds_read_b128 v[20:23], v3 offset:49664
    v_mfma_f32_16x16x32_bf16 v[204:207], v[80:83], v[24:27], v[204:207]
    v_mfma_f32_16x16x32_bf16 v[204:207], v[84:87], v[28:31], v[204:207]
    v_mfma_f32_16x16x32_bf16 v[236:239], v[92:95], v[28:31], v[236:239]
    v_mfma_f32_16x16x32_bf16 v[236:239], v[88:91], v[24:27], v[236:239]
    s_waitcnt lgkmcnt(2)
    v_mfma_f32_16x16x32_bf16 v[144:147], v[64:67], v[8:11], v[144:147]
    v_mfma_f32_16x16x32_bf16 v[144:147], v[68:71], v[12:15], v[144:147]
    v_mfma_f32_16x16x32_bf16 v[176:179], v[76:79], v[12:15], v[176:179]
    ds_read_b128 v[24:27], v0 offset:49920
    v_mfma_f32_16x16x32_bf16 v[176:179], v[72:75], v[8:11], v[176:179]
    ds_read_b128 v[28:31], v1 offset:49920
    v_mfma_f32_16x16x32_bf16 v[208:211], v[80:83], v[8:11], v[208:211]
    v_mfma_f32_16x16x32_bf16 v[208:211], v[84:87], v[12:15], v[208:211]
    v_mfma_f32_16x16x32_bf16 v[240:243], v[92:95], v[12:15], v[240:243]
    v_mfma_f32_16x16x32_bf16 v[240:243], v[88:91], v[8:11], v[240:243]
    s_waitcnt lgkmcnt(2)
    v_mfma_f32_16x16x32_bf16 v[148:151], v[64:67], v[16:19], v[148:151]
    v_mfma_f32_16x16x32_bf16 v[148:151], v[68:71], v[20:23], v[148:151]
    v_mfma_f32_16x16x32_bf16 v[180:183], v[76:79], v[20:23], v[180:183]
    ds_read_b128 v[8:11], v2 offset:49920
    v_mfma_f32_16x16x32_bf16 v[180:183], v[72:75], v[16:19], v[180:183]
    ds_read_b128 v[12:15], v3 offset:49920
    v_mfma_f32_16x16x32_bf16 v[212:215], v[80:83], v[16:19], v[212:215]
    v_mfma_f32_16x16x32_bf16 v[212:215], v[84:87], v[20:23], v[212:215]
    v_mfma_f32_16x16x32_bf16 v[244:247], v[92:95], v[20:23], v[244:247]
    v_mfma_f32_16x16x32_bf16 v[244:247], v[88:91], v[16:19], v[244:247]
    s_waitcnt lgkmcnt(2)
    v_mfma_f32_16x16x32_bf16 v[152:155], v[64:67], v[24:27], v[152:155]
    v_mfma_f32_16x16x32_bf16 v[152:155], v[68:71], v[28:31], v[152:155]
    v_mfma_f32_16x16x32_bf16 v[184:187], v[76:79], v[28:31], v[184:187]
    v_mfma_f32_16x16x32_bf16 v[184:187], v[72:75], v[24:27], v[184:187]
    v_mfma_f32_16x16x32_bf16 v[216:219], v[80:83], v[24:27], v[216:219]
    v_mfma_f32_16x16x32_bf16 v[216:219], v[84:87], v[28:31], v[216:219]
    v_mfma_f32_16x16x32_bf16 v[248:251], v[92:95], v[28:31], v[248:251]
    v_mfma_f32_16x16x32_bf16 v[248:251], v[88:91], v[24:27], v[248:251]
    s_waitcnt lgkmcnt(0)
    v_mfma_f32_16x16x32_bf16 v[156:159], v[64:67], v[8:11], v[156:159]
    v_mfma_f32_16x16x32_bf16 v[156:159], v[68:71], v[12:15], v[156:159]
    v_mfma_f32_16x16x32_bf16 v[188:191], v[76:79], v[12:15], v[188:191]
    v_mfma_f32_16x16x32_bf16 v[188:191], v[72:75], v[8:11], v[188:191]
    v_mfma_f32_16x16x32_bf16 v[220:223], v[80:83], v[8:11], v[220:223]
    v_mfma_f32_16x16x32_bf16 v[220:223], v[84:87], v[12:15], v[220:223]
    v_mfma_f32_16x16x32_bf16 v[252:255], v[92:95], v[12:15], v[252:255]
    v_mfma_f32_16x16x32_bf16 v[252:255], v[88:91], v[8:11], v[252:255]
    s_setprio 0
    s_setpc_b64 s[42:43]
L_helper:
    s_cmp_eq_u32 s32, 4
    s_cbranch_scc0 L_help1
    s_lshl_b32 s54, s50, 15
    s_add_u32 s54, s54, 0
    buffer_load_dword v4, v15, s[8:11], s54 offen
L_help1:
    s_mov_b32 s12, s14
    s_mov_b32 s13, s15
    s_mov_b32 s28, s18
    s_mov_b32 s29, s19
    s_mov_b32 s14, 524288
    s_mov_b32 s15, 0x20000
    s_mov_b32 s26, 2097152
    s_mov_b32 s27, 0x20000
    s_mul_i32 s51, s32, 6
    s_add_u32 s51, s51, s58
    s_mov_b32 s66, 0x05040100
    s_mov_b32 s67, 0x07060302
    v_lshlrev_b32 v7, 4, v92
    v_mov_b32 v0, -1
    v_mov_b32 v1, -1
    v_mov_b32 v2, -1
    v_mov_b32 v3, -1
    v_and_b32 v9, 15, v92
    v_lshlrev_b32 v9, 3, v9
    v_lshl_add_u32 v10, v8, 14, v9
    v_lshl_add_u32 v11, v8, 12, v9
    s_mov_b32 s98, 1
    s_add_u32 s60, s51, 0
    s_and_b32 s54, s60, 1
    s_and_b32 s52, s60, 15
    s_lshl_b32 s61, s52, 16
    s_bfe_u32 s53, s60, 0x10004
    s_lshl_b32 s52, s53, 10
    s_add_u32 s61, s61, s52
    s_lshl_b32 s62, s53, 12
    s_lshr_b32 s53, s60, 5
    s_lshl_b32 s52, s53, 7
    s_add_u32 s61, s61, s52
    s_add_u32 s61, s61, 512
    buffer_load_dwordx2 v[16:17], v10, s[8:11], s61 offen offset:0
    buffer_load_dwordx2 v[18:19], v10, s[8:11], s61 offen offset:2048
    s_add_u32 s61, s61, 4096
    buffer_load_dwordx2 v[20:21], v10, s[8:11], s61 offen offset:0
    buffer_load_dwordx2 v[22:23], v10, s[8:11], s61 offen offset:2048
    s_add_u32 s61, s61, 4096
    buffer_load_dwordx2 v[24:25], v10, s[8:11], s61 offen offset:0
    buffer_load_dwordx2 v[26:27], v10, s[8:11], s61 offen offset:2048
    s_add_u32 s61, s61, 4096
    buffer_load_dwordx2 v[28:29], v10, s[8:11], s61 offen offset:0
    buffer_load_dwordx2 v[30:31], v10, s[8:11], s61 offen offset:2048
    s_lshl_b32 s52, s53, 17
    s_add_u32 s62, s62, s52
    s_bfe_u32 s52, s60, 0x30001
    s_lshl_b32 s52, s52, 13
    s_add_u32 s62, s62, s52
    s_lshl_b32 s52, s54, 10
    s_add_u32 s62, s62, s52
    s_add_u32 s70, s62, 1048576
    s_cmp_ge_u32 s51, 16
    s_cbranch_scc1 L_hskip1
    s_add_u32 s60, s51, 48
    s_and_b32 s54, s60, 1
    s_and_b32 s52, s60, 15
    s_lshl_b32 s61, s52, 16
    s_bfe_u32 s53, s60, 0x10004
    s_lshl_b32 s52, s53, 10
    s_add_u32 s61, s61, s52
    s_lshl_b32 s62, s53, 12
    s_lshr_b32 s53, s60, 5
    s_lshl_b32 s52, s53, 7
    s_add_u32 s61, s61, s52
    s_add_u32 s61, s61, 512
    buffer_load_dwordx2 v[32:33], v10, s[8:11], s61 offen offset:0
    buffer_load_dwordx2 v[34:35], v10, s[8:11], s61 offen offset:2048
    s_add_u32 s61, s61, 4096
    buffer_load_dwordx2 v[36:37], v10, s[8:11], s61 offen offset:0
    buffer_load_dwordx2 v[38:39], v10, s[8:11], s61 offen offset:2048
    s_add_u32 s61, s61, 4096
    buffer_load_dwordx2 v[40:41], v10, s[8:11], s61 offen offset:0
    buffer_load_dwordx2 v[42:43], v10, s[8:11], s61 offen offset:2048
    s_add_u32 s61, s61, 4096
    buffer_load_dwordx2 v[44:45], v10, s[8:11], s61 offen offset:0
    buffer_load_dwordx2 v[46:47], v10, s[8:11], s61 offen offset:2048
    s_lshl_b32 s52, s53, 17
    s_add_u32 s62, s62, s52
    s_bfe_u32 s52, s60, 0x30001
    s_lshl_b32 s52, s52, 13
    s_add_u32 s62, s62, s52
    s_lshl_b32 s52, s54, 10
    s_add_u32 s62, s62, s52
    s_add_u32 s71, s62, 1048576
L_hskip1:
    s_add_u32 s60, s51, 64
    s_and_b32 s54, s60, 1
    s_and_b32 s52, s60, 15
    s_lshl_b32 s61, s52, 16
    s_bfe_u32 s53, s60, 0x10004
    s_lshl_b32 s52, s53, 10
    s_add_u32 s61, s61, s52
    s_lshl_b32 s62, s53, 12
    s_lshr_b32 s53, s60, 5
    s_lshl_b32 s52, s53, 7
    s_add_u32 s61, s61, s52
    s_add_u32 s61, s61, 512
    buffer_load_dwordx2 v[48:49], v10, s[8:11], s61 offen offset:0
    buffer_load_dwordx2 v[50:51], v10, s[8:11], s61 offen offset:2048
    s_add_u32 s61, s61, 4096
    buffer_load_dwordx2 v[52:53], v10, s[8:11], s61 offen offset:0
    buffer_load_dwordx2 v[54:55], v10, s[8:11], s61 offen offset:2048
    s_add_u32 s61, s61, 4096
    buffer_load_dwordx2 v[56:57], v10, s[8:11], s61 offen offset:0
    buffer_load_dwordx2 v[58:59], v10, s[8:11], s61 offen offset:2048
    s_add_u32 s61, s61, 4096
    buffer_load_dwordx2 v[60:61], v10, s[8:11], s61 offen offset:0
    buffer_load_dwordx2 v[62:63], v10, s[8:11], s61 offen offset:2048
    s_lshl_b32 s52, s53, 17
    s_add_u32 s62, s62, s52
    s_bfe_u32 s52, s60, 0x30001
    s_lshl_b32 s52, s52, 13
    s_add_u32 s62, s62, s52
    s_lshl_b32 s52, s54, 10
    s_add_u32 s62, s62, s52
    s_add_u32 s72, s62, 1048576
    s_cmp_ge_u32 s51, 16
    s_cbranch_scc1 L_hskip2
    s_add_u32 s60, s51, 112
    s_and_b32 s54, s60, 1
    s_and_b32 s52, s60, 15
    s_lshl_b32 s61, s52, 16
    s_bfe_u32 s53, s60, 0x10004
    s_lshl_b32 s52, s53, 10
    s_add_u32 s61, s61, s52
    s_lshl_b32 s62, s53, 12
    s_lshr_b32 s53, s60, 5
    s_lshl_b32 s52, s53, 7
    s_add_u32 s61, s61, s52
    s_add_u32 s61, s61, 512
    buffer_load_dwordx2 v[64:65], v10, s[8:11], s61 offen offset:0
    buffer_load_dwordx2 v[66:67], v10, s[8:11], s61 offen offset:2048
    s_add_u32 s61, s61, 4096
    buffer_load_dwordx2 v[68:69], v10, s[8:11], s61 offen offset:0
    buffer_load_dwordx2 v[70:71], v10, s[8:11], s61 offen offset:2048
    s_add_u32 s61, s61, 4096
    buffer_load_dwordx2 v[72:73], v10, s[8:11], s61 offen offset:0
    buffer_load_dwordx2 v[74:75], v10, s[8:11], s61 offen offset:2048
    s_add_u32 s61, s61, 4096
    buffer_load_dwordx2 v[76:77], v10, s[8:11], s61 offen offset:0
    buffer_load_dwordx2 v[78:79], v10, s[8:11], s61 offen offset:2048
    s_lshl_b32 s52, s53, 17
    s_add_u32 s62, s62, s52
    s_bfe_u32 s52, s60, 0x30001
    s_lshl_b32 s52, s52, 13
    s_add_u32 s62, s62, s52
    s_lshl_b32 s52, s54, 10
    s_add_u32 s62, s62, s52
    s_add_u32 s73, s62, 1048576
L_hskip2:
    s_waitcnt vmcnt(0)
    v_perm_b32 v192, v18, v16, s66
    v_perm_b32 v193, v22, v20, s66
    v_perm_b32 v194, v26, v24, s66
    v_perm_b32 v195, v30, v28, s66
    v_perm_b32 v196, v18, v16, s67
    v_perm_b32 v197, v22, v20, s67
    v_perm_b32 v198, v26, v24, s67
    v_perm_b32 v199, v30, v28, s67
    v_perm_b32 v200, v19, v17, s66
    v_perm_b32 v201, v23, v21, s66
    v_perm_b32 v202, v27, v25, s66
    v_perm_b32 v203, v31, v29, s66
    v_perm_b32 v204, v19, v17, s67
    v_perm_b32 v205, v23, v21, s67
    v_perm_b32 v206, v27, v25, s67
    v_perm_b32 v207, v31, v29, s67
    v_perm_b32 v208, v34, v32, s66
    v_perm_b32 v209, v38, v36, s66
    v_perm_b32 v210, v42, v40, s66
    v_perm_b32 v211, v46, v44, s66
    v_perm_b32 v212, v34, v32, s67
    v_perm_b32 v213, v38, v36, s67
    v_perm_b32 v214, v42, v40, s67
    v_perm_b32 v215, v46, v44, s67
    v_perm_b32 v216, v35, v33, s66
    v_perm_b32 v217, v39, v37, s66
    v_perm_b32 v218, v43, v41, s66
    v_perm_b32 v219, v47, v45, s66
    v_perm_b32 v220, v35, v33, s67
    v_perm_b32 v221, v39, v37, s67
    v_perm_b32 v222, v43, v41, s67
    v_perm_b32 v223, v47, v45, s67
    v_perm_b32 v224, v50, v48, s66
    v_perm_b32 v225, v54, v52, s66
    v_perm_b32 v226, v58, v56, s66
    v_perm_b32 v227, v62, v60, s66
    v_perm_b32 v228, v50, v48, s67
    v_perm_b32 v229, v54, v52, s67
    v_perm_b32 v230, v58, v56, s67
    v_perm_b32 v231, v62, v60, s67
    v_perm_b32 v232, v51, v49, s66
    v_perm_b32 v233, v55, v53, s66
    v_perm_b32 v234, v59, v57, s66
    v_perm_b32 v235, v63, v61, s66
    v_perm_b32 v236, v51, v49, s67
    v_perm_b32 v237, v55, v53, s67
    v_perm_b32 v238, v59, v57, s67
    v_perm_b32 v239, v63, v61, s67
    v_perm_b32 v240, v66, v64, s66
    v_perm_b32 v241, v70, v68, s66
    v_perm_b32 v242, v74, v72, s66
    v_perm_b32 v243, v78, v76, s66
    v_perm_b32 v244, v66, v64, s67
    v_perm_b32 v245, v70, v68, s67
    v_perm_b32 v246, v74, v72, s67
    v_perm_b32 v247, v78, v76, s67
    v_perm_b32 v248, v67, v65, s66
    v_perm_b32 v249, v71, v69, s66
    v_perm_b32 v250, v75, v73, s66
    v_perm_b32 v251, v79, v77, s66
    v_perm_b32 v252, v67, v65, s67
    v_perm_b32 v253, v71, v69, s67
    v_perm_b32 v254, v75, v73, s67
    v_perm_b32 v255, v79, v77, s67
    s_cmp_eq_u32 s32, 7
    s_cbranch_scc0 L_htrig
    s_mov_b32 s53, 0x8000
L_htpoll:
    s_load_dword s52, s[28:29], 224 glc
    s_sub_u32 s53, s53, 1
    s_cbranch_scc1 L_htrig
    s_waitcnt lgkmcnt(0)
    s_cmp_lt_u32 s52, 6
    s_cbranch_scc1 L_htpoll
L_htrig:
    s_waitcnt lgkmcnt(0)
    s_barrier
    s_add_u32 s60, s51, 1
    s_lshl_b32 s52, s60, 10
    s_add_u32 s52, s52, 0
    buffer_store_dwordx4 v[0:3], v7, s[24:27], s52 offen sc1
    s_add_u32 s60, s51, 49
    s_lshl_b32 s52, s60, 10
    s_add_u32 s52, s52, 0
    buffer_store_dwordx4 v[0:3], v7, s[24:27], s52 offen sc1
    s_add_u32 s60, s51, 97
    s_lshl_b32 s52, s60, 10
    s_add_u32 s52, s52, 0
    buffer_store_dwordx4 v[0:3], v7, s[24:27], s52 offen sc1
    s_add_u32 s60, s51, 145
    s_lshl_b32 s52, s60, 10
    s_add_u32 s52, s52, 0
    buffer_store_dwordx4 v[0:3], v7, s[24:27], s52 offen sc1
    s_add_u32 s60, s51, 193
    s_lshl_b32 s52, s60, 10
    s_add_u32 s52, s52, 0
    buffer_store_dwordx4 v[0:3], v7, s[24:27], s52 offen sc1
    s_add_u32 s60, s51, 241
    s_min_u32 s60, s60, 250
    s_lshl_b32 s52, s60, 10
    s_add_u32 s52, s52, 0
    buffer_store_dwordx4 v[0:3], v7, s[24:27], s52 offen sc1
    s_waitcnt vmcnt(0)
    s_barrier
    s_cmp_eq_u32 s32, 7
    s_cbranch_scc0 L_hflag0
    s_atomic_add s98, s[28:29], 0
L_hflag0:
    s_add_u32 s52, s70, 65536
    buffer_store_dwordx4 v[192:195], v7, s[24:27], s70 offen offset:0 sc1
    buffer_store_dwordx4 v[196:199], v7, s[24:27], s70 offen offset:2048 sc1
    buffer_store_dwordx4 v[200:203], v7, s[24:27], s52 offen offset:0 sc1
    buffer_store_dwordx4 v[204:207], v7, s[24:27], s52 offen offset:2048 sc1
    s_cmp_ge_u32 s51, 16
    s_cbranch_scc1 L_hskip3
    s_add_u32 s52, s71, 65536
    buffer_store_dwordx4 v[208:211], v7, s[24:27], s71 offen offset:0 sc1
    buffer_store_dwordx4 v[212:215], v7, s[24:27], s71 offen offset:2048 sc1
    buffer_store_dwordx4 v[216:219], v7, s[24:27], s52 offen offset:0 sc1
    buffer_store_dwordx4 v[220:223], v7, s[24:27], s52 offen offset:2048 sc1
L_hskip3:
    s_waitcnt vmcnt(0)
    s_barrier
    s_cmp_eq_u32 s32, 7
    s_cbranch_scc0 L_hflag1
    s_atomic_add s98, s[28:29], 64
L_hflag1:
    s_add_u32 s60, s51, 1
    s_lshl_b32 s52, s60, 10
    s_add_u32 s52, s52, 262144
    buffer_store_dwordx4 v[0:3], v7, s[24:27], s52 offen sc1
    s_add_u32 s60, s51, 49
    s_lshl_b32 s52, s60, 10
    s_add_u32 s52, s52, 262144
    buffer_store_dwordx4 v[0:3], v7, s[24:27], s52 offen sc1
    s_add_u32 s60, s51, 97
    s_lshl_b32 s52, s60, 10
    s_add_u32 s52, s52, 262144
    buffer_store_dwordx4 v[0:3], v7, s[24:27], s52 offen sc1
    s_add_u32 s60, s51, 145
    s_lshl_b32 s52, s60, 10
    s_add_u32 s52, s52, 262144
    buffer_store_dwordx4 v[0:3], v7, s[24:27], s52 offen sc1
    s_add_u32 s60, s51, 193
    s_lshl_b32 s52, s60, 10
    s_add_u32 s52, s52, 262144
    buffer_store_dwordx4 v[0:3], v7, s[24:27], s52 offen sc1
    s_add_u32 s60, s51, 241
    s_min_u32 s60, s60, 250
    s_lshl_b32 s52, s60, 10
    s_add_u32 s52, s52, 262144
    buffer_store_dwordx4 v[0:3], v7, s[24:27], s52 offen sc1
    s_add_u32 s52, s72, 65536
    buffer_store_dwordx4 v[224:227], v7, s[24:27], s72 offen offset:0 sc1
    buffer_store_dwordx4 v[228:231], v7, s[24:27], s72 offen offset:2048 sc1
    buffer_store_dwordx4 v[232:235], v7, s[24:27], s52 offen offset:0 sc1
    buffer_store_dwordx4 v[236:239], v7, s[24:27], s52 offen offset:2048 sc1
    s_cmp_ge_u32 s51, 16
    s_cbranch_scc1 L_hskip4
    s_add_u32 s52, s73, 65536
    buffer_store_dwordx4 v[240:243], v7, s[24:27], s73 offen offset:0 sc1
    buffer_store_dwordx4 v[244:247], v7, s[24:27], s73 offen offset:2048 sc1
    buffer_store_dwordx4 v[248:251], v7, s[24:27], s52 offen offset:0 sc1
    buffer_store_dwordx4 v[252:255], v7, s[24:27], s52 offen offset:2048 sc1
L_hskip4:
    s_waitcnt vmcnt(0)
    s_barrier
    s_cmp_eq_u32 s32, 7
    s_cbranch_scc0 L_hflag2
    s_atomic_add s98, s[28:29], 128
L_hflag2:
    s_add_u32 s60, s51, 0
    s_and_b32 s54, s60, 1
    s_lshr_b32 s52, s60, 1
    s_lshl_b32 s52, s52, 13
    s_lshl_b32 s53, s54, 10
    s_add_u32 s52, s52, s53
    s_add_u32 s74, s52, 1572864
    s_bitcmp1_b32 s60, 3
    s_cselect_b32 s52, 0, 4
    s_cselect_b64 vcc, -1, 0
    s_cselect_b32 s63, 4, 1
    s_cselect_b32 s64, 1, 16
    s_cselect_b32 s53, 11, 15
    v_cndmask_b32 v13, v11, v10, vcc
    s_lshl_b32 s54, s54, s53
    s_xor_b32 s52, s52, s60
    s_bfe_u32 s52, s52, 0x30001
    s_lshl_b32 s52, s52, 16
    s_add_u32 s61, s52, s54
    s_lshr_b32 s53, s60, 4
    s_lshl_b32 s53, s53, 7
    s_add_u32 s61, s61, s53
    s_lshl_b32 s63, s63, 10
    s_lshl_b32 s64, s64, 10
    s_add_u32 s62, s61, s64
    buffer_load_dwordx2 v[80:81], v13, s[12:15], s61 offen
    buffer_load_dwordx2 v[88:89], v13, s[12:15], s62 offen
    s_add_u32 s61, s61, s63
    s_add_u32 s62, s62, s63
    buffer_load_dwordx2 v[82:83], v13, s[12:15], s61 offen
    buffer_load_dwordx2 v[90:91], v13, s[12:15], s62 offen
    s_add_u32 s61, s61, s63
    s_add_u32 s62, s62, s63
    buffer_load_dwordx2 v[84:85], v13, s[12:15], s61 offen
    buffer_load_dwordx2 v[92:93], v13, s[12:15], s62 offen
    s_add_u32 s61, s61, s63
    s_add_u32 s62, s62, s63
    buffer_load_dwordx2 v[86:87], v13, s[12:15], s61 offen
    buffer_load_dwordx2 v[94:95], v13, s[12:15], s62 offen
    s_cmp_ge_u32 s51, 16
    s_cbranch_scc1 L_hskip5
    s_add_u32 s60, s51, 48
    s_and_b32 s54, s60, 1
    s_lshr_b32 s52, s60, 1
    s_lshl_b32 s52, s52, 13
    s_lshl_b32 s53, s54, 10
    s_add_u32 s52, s52, s53
    s_add_u32 s75, s52, 1572864
    s_bitcmp1_b32 s60, 3
    s_cselect_b32 s52, 0, 4
    s_cselect_b64 vcc, -1, 0
    s_cselect_b32 s63, 4, 1
    s_cselect_b32 s64, 1, 16
    s_cselect_b32 s53, 11, 15
    v_cndmask_b32 v13, v11, v10, vcc
    s_lshl_b32 s54, s54, s53
    s_xor_b32 s52, s52, s60
    s_bfe_u32 s52, s52, 0x30001
    s_lshl_b32 s52, s52, 16
    s_add_u32 s61, s52, s54
    s_lshr_b32 s53, s60, 4
    s_lshl_b32 s53, s53, 7
    s_add_u32 s61, s61, s53
    s_lshl_b32 s63, s63, 10
    s_lshl_b32 s64, s64, 10
    s_add_u32 s62, s61, s64
    buffer_load_dwordx2 v[96:97], v13, s[12:15], s61 offen
    buffer_load_dwordx2 v[104:105], v13, s[12:15], s62 offen
    s_add_u32 s61, s61, s63
    s_add_u32 s62, s62, s63
    buffer_load_dwordx2 v[98:99], v13, s[12:15], s61 offen
    buffer_load_dwordx2 v[106:107], v13, s[12:15], s62 offen
    s_add_u32 s61, s61, s63
    s_add_u32 s62, s62, s63
    buffer_load_dwordx2 v[100:101], v13, s[12:15], s61 offen
    buffer_load_dwordx2 v[108:109], v13, s[12:15], s62 offen
    s_add_u32 s61, s61, s63
    s_add_u32 s62, s62, s63
    buffer_load_dwordx2 v[102:103], v13, s[12:15], s61 offen
    buffer_load_dwordx2 v[110:111], v13, s[12:15], s62 offen
L_hskip5:
    s_add_u32 s60, s51, 64
    s_and_b32 s54, s60, 1
    s_lshr_b32 s52, s60, 1
    s_lshl_b32 s52, s52, 13
    s_lshl_b32 s53, s54, 10
    s_add_u32 s52, s52, s53
    s_add_u32 s76, s52, 1572864
    s_bitcmp1_b32 s60, 3
    s_cselect_b32 s52, 0, 4
    s_cselect_b64 vcc, -1, 0
    s_cselect_b32 s63, 4, 1
    s_cselect_b32 s64, 1, 16
    s_cselect_b32 s53, 11, 15
    v_cndmask_b32 v13, v11, v10, vcc
    s_lshl_b32 s54, s54, s53
    s_xor_b32 s52, s52, s60
    s_bfe_u32 s52, s52, 0x30001
    s_lshl_b32 s52, s52, 16
    s_add_u32 s61, s52, s54
    s_lshr_b32 s53, s60, 4
    s_lshl_b32 s53, s53, 7
    s_add_u32 s61, s61, s53
    s_lshl_b32 s63, s63, 10
    s_lshl_b32 s64, s64, 10
    s_add_u32 s62, s61, s64
    buffer_load_dwordx2 v[112:113], v13, s[12:15], s61 offen
    buffer_load_dwordx2 v[120:121], v13, s[12:15], s62 offen
    s_add_u32 s61, s61, s63
    s_add_u32 s62, s62, s63
    buffer_load_dwordx2 v[114:115], v13, s[12:15], s61 offen
    buffer_load_dwordx2 v[122:123], v13, s[12:15], s62 offen
    s_add_u32 s61, s61, s63
    s_add_u32 s62, s62, s63
    buffer_load_dwordx2 v[116:117], v13, s[12:15], s61 offen
    buffer_load_dwordx2 v[124:125], v13, s[12:15], s62 offen
    s_add_u32 s61, s61, s63
    s_add_u32 s62, s62, s63
    buffer_load_dwordx2 v[118:119], v13, s[12:15], s61 offen
    buffer_load_dwordx2 v[126:127], v13, s[12:15], s62 offen
    s_cmp_ge_u32 s51, 16
    s_cbranch_scc1 L_hskip6
    s_add_u32 s60, s51, 112
    s_and_b32 s54, s60, 1
    s_lshr_b32 s52, s60, 1
    s_lshl_b32 s52, s52, 13
    s_lshl_b32 s53, s54, 10
    s_add_u32 s52, s52, s53
    s_add_u32 s77, s52, 1572864
    s_bitcmp1_b32 s60, 3
    s_cselect_b32 s52, 0, 4
    s_cselect_b64 vcc, -1, 0
    s_cselect_b32 s63, 4, 1
    s_cselect_b32 s64, 1, 16
    s_cselect_b32 s53, 11, 15
    v_cndmask_b32 v13, v11, v10, vcc
    s_lshl_b32 s54, s54, s53
    s_xor_b32 s52, s52, s60
    s_bfe_u32 s52, s52, 0x30001
    s_lshl_b32 s52, s52, 16
    s_add_u32 s61, s52, s54
    s_lshr_b32 s53, s60, 4
    s_lshl_b32 s53, s53, 7
    s_add_u32 s61, s61, s53
    s_lshl_b32 s63, s63, 10
    s_lshl_b32 s64, s64, 10
    s_add_u32 s62, s61, s64
    buffer_load_dwordx2 v[128:129], v13, s[12:15], s61 offen
    buffer_load_dwordx2 v[136:137], v13, s[12:15], s62 offen
    s_add_u32 s61, s61, s63
    s_add_u32 s62, s62, s63
    buffer_load_dwordx2 v[130:131], v13, s[12:15], s61 offen
    buffer_load_dwordx2 v[138:139], v13, s[12:15], s62 offen
    s_add_u32 s61, s61, s63
    s_add_u32 s62, s62, s63
    buffer_load_dwordx2 v[132:133], v13, s[12:15], s61 offen
    buffer_load_dwordx2 v[140:141], v13, s[12:15], s62 offen
    s_add_u32 s61, s61, s63
    s_add_u32 s62, s62, s63
    buffer_load_dwordx2 v[134:135], v13, s[12:15], s61 offen
    buffer_load_dwordx2 v[142:143], v13, s[12:15], s62 offen
L_hskip6:
    s_add_u32 s60, s51, 1
    s_lshl_b32 s52, s60, 10
    s_add_u32 s52, s52, 524288
    buffer_store_dwordx4 v[0:3], v7, s[24:27], s52 offen sc1
    s_add_u32 s60, s51, 49
    s_lshl_b32 s52, s60, 10
    s_add_u32 s52, s52, 524288
    buffer_store_dwordx4 v[0:3], v7, s[24:27], s52 offen sc1
    s_add_u32 s60, s51, 97
    s_lshl_b32 s52, s60, 10
    s_add_u32 s52, s52, 524288
    buffer_store_dwordx4 v[0:3], v7, s[24:27], s52 offen sc1
    s_add_u32 s60, s51, 145
    s_lshl_b32 s52, s60, 10
    s_add_u32 s52, s52, 524288
    buffer_store_dwordx4 v[0:3], v7, s[24:27], s52 offen sc1
    s_add_u32 s60, s51, 193
    s_lshl_b32 s52, s60, 10
    s_add_u32 s52, s52, 524288
    buffer_store_dwordx4 v[0:3], v7, s[24:27], s52 offen sc1
    s_add_u32 s60, s51, 241
    s_min_u32 s60, s60, 250
    s_lshl_b32 s52, s60, 10
    s_add_u32 s52, s52, 524288
    buffer_store_dwordx4 v[0:3], v7, s[24:27], s52 offen sc1
    s_add_u32 s60, s51, 1
    s_lshl_b32 s52, s60, 10
    s_add_u32 s52, s52, 786432
    buffer_store_dwordx4 v[0:3], v7, s[24:27], s52 offen sc1
    s_add_u32 s60, s51, 49
    s_lshl_b32 s52, s60, 10
    s_add_u32 s52, s52, 786432
    buffer_store_dwordx4 v[0:3], v7, s[24:27], s52 offen sc1
    s_add_u32 s60, s51, 97
    s_lshl_b32 s52, s60, 10
    s_add_u32 s52, s52, 786432
    buffer_store_dwordx4 v[0:3], v7, s[24:27], s52 offen sc1
    s_add_u32 s60, s51, 145
    s_lshl_b32 s52, s60, 10
    s_add_u32 s52, s52, 786432
    buffer_store_dwordx4 v[0:3], v7, s[24:27], s52 offen sc1
    s_add_u32 s60, s51, 193
    s_lshl_b32 s52, s60, 10
    s_add_u32 s52, s52, 786432
    buffer_store_dwordx4 v[0:3], v7, s[24:27], s52 offen sc1
    s_add_u32 s60, s51, 241
    s_min_u32 s60, s60, 250
    s_lshl_b32 s52, s60, 10
    s_add_u32 s52, s52, 786432
    buffer_store_dwordx4 v[0:3], v7, s[24:27], s52 offen sc1
    s_waitcnt vmcnt(12)
    v_perm_b32 v192, v82, v80, s66
    v_perm_b32 v193, v86, v84, s66
    v_perm_b32 v194, v90, v88, s66
    v_perm_b32 v195, v94, v92, s66
    v_perm_b32 v196, v82, v80, s67
    v_perm_b32 v197, v86, v84, s67
    v_perm_b32 v198, v90, v88, s67
    v_perm_b32 v199, v94, v92, s67
    v_perm_b32 v200, v83, v81, s66
    v_perm_b32 v201, v87, v85, s66
    v_perm_b32 v202, v91, v89, s66
    v_perm_b32 v203, v95, v93, s66
    v_perm_b32 v204, v83, v81, s67
    v_perm_b32 v205, v87, v85, s67
    v_perm_b32 v206, v91, v89, s67
    v_perm_b32 v207, v95, v93, s67
    v_perm_b32 v208, v98, v96, s66
    v_perm_b32 v209, v102, v100, s66
    v_perm_b32 v210, v106, v104, s66
    v_perm_b32 v211, v110, v108, s66
    v_perm_b32 v212, v98, v96, s67
    v_perm_b32 v213, v102, v100, s67
    v_perm_b32 v214, v106, v104, s67
    v_perm_b32 v215, v110, v108, s67
    v_perm_b32 v216, v99, v97, s66
    v_perm_b32 v217, v103, v101, s66
    v_perm_b32 v218, v107, v105, s66
    v_perm_b32 v219, v111, v109, s66
    v_perm_b32 v220, v99, v97, s67
    v_perm_b32 v221, v103, v101, s67
    v_perm_b32 v222, v107, v105, s67
    v_perm_b32 v223, v111, v109, s67
    v_perm_b32 v224, v114, v112, s66
    v_perm_b32 v225, v118, v116, s66
    v_perm_b32 v226, v122, v120, s66
    v_perm_b32 v227, v126, v124, s66
    v_perm_b32 v228, v114, v112, s67
    v_perm_b32 v229, v118, v116, s67
    v_perm_b32 v230, v122, v120, s67
    v_perm_b32 v231, v126, v124, s67
    v_perm_b32 v232, v115, v113, s66
    v_perm_b32 v233, v119, v117, s66
    v_perm_b32 v234, v123, v121, s66
    v_perm_b32 v235, v127, v125, s66
    v_perm_b32 v236, v115, v113, s67
    v_perm_b32 v237, v119, v117, s67
    v_perm_b32 v238, v123, v121, s67
    v_perm_b32 v239, v127, v125, s67
    v_perm_b32 v240, v130, v128, s66
    v_perm_b32 v241, v134, v132, s66
    v_perm_b32 v242, v138, v136, s66
    v_perm_b32 v243, v142, v140, s66
    v_perm_b32 v244, v130, v128, s67
    v_perm_b32 v245, v134, v132, s67
    v_perm_b32 v246, v138, v136, s67
    v_perm_b32 v247, v142, v140, s67
    v_perm_b32 v248, v131, v129, s66
    v_perm_b32 v249, v135, v133, s66
    v_perm_b32 v250, v139, v137, s66
    v_perm_b32 v251, v143, v141, s66
    v_perm_b32 v252, v131, v129, s67
    v_perm_b32 v253, v135, v133, s67
    v_perm_b32 v254, v139, v137, s67
    v_perm_b32 v255, v143, v141, s67
    s_add_u32 s52, s74, 4096
    buffer_store_dwordx4 v[192:195], v7, s[24:27], s74 offen offset:0 sc1
    buffer_store_dwordx4 v[196:199], v7, s[24:27], s74 offen offset:2048 sc1
    buffer_store_dwordx4 v[200:203], v7, s[24:27], s52 offen offset:0 sc1
    buffer_store_dwordx4 v[204:207], v7, s[24:27], s52 offen offset:2048 sc1
    s_cmp_ge_u32 s51, 16
    s_cbranch_scc1 L_hskip7
    s_add_u32 s52, s75, 4096
    buffer_store_dwordx4 v[208:211], v7, s[24:27], s75 offen offset:0 sc1
    buffer_store_dwordx4 v[212:215], v7, s[24:27], s75 offen offset:2048 sc1
    buffer_store_dwordx4 v[216:219], v7, s[24:27], s52 offen offset:0 sc1
    buffer_store_dwordx4 v[220:223], v7, s[24:27], s52 offen offset:2048 sc1
L_hskip7:
    s_add_u32 s52, s76, 4096
    buffer_store_dwordx4 v[224:227], v7, s[24:27], s76 offen offset:0 sc1
    buffer_store_dwordx4 v[228:231], v7, s[24:27], s76 offen offset:2048 sc1
    buffer_store_dwordx4 v[232:235], v7, s[24:27], s52 offen offset:0 sc1
    buffer_store_dwordx4 v[236:239], v7, s[24:27], s52 offen offset:2048 sc1
    s_cmp_ge_u32 s51, 16
    s_cbranch_scc1 L_hskip8
    s_add_u32 s52, s77, 4096
    buffer_store_dwordx4 v[240:243], v7, s[24:27], s77 offen offset:0 sc1
    buffer_store_dwordx4 v[244:247], v7, s[24:27], s77 offen offset:2048 sc1
    buffer_store_dwordx4 v[248:251], v7, s[24:27], s52 offen offset:0 sc1
    buffer_store_dwordx4 v[252:255], v7, s[24:27], s52 offen offset:2048 sc1
L_hskip8:
    s_waitcnt vmcnt(0)
    s_barrier
    s_cmp_eq_u32 s32, 7
    s_cbranch_scc0 L_hflag3
    s_atomic_add s98, s[28:29], 192
L_hflag3:
    s_endpgm
L_rrepolla:
    s_sub_u32 s58, s58, 1
    s_cbranch_scc1 L_rpolleda
    buffer_load_dword v8, off, s[28:31], s99 offset:0 sc1
    s_waitcnt vmcnt(0)
    v_readfirstlane_b32 s98, v8
    s_nop 3
    s_branch L_rpolla
L_rrepolld:
    s_sub_u32 s58, s58, 1
    s_cbranch_scc1 L_rpolledd
    buffer_load_dword v8, off, s[28:31], s99 offset:64 sc1
    s_waitcnt vmcnt(0)
    v_readfirstlane_b32 s98, v8
    s_nop 3
    s_branch L_rpolld
L_repolla:
    s_sub_u32 s58, s58, 1
    s_cbranch_scc1 L_polleda
    buffer_load_dwordx4 v[148:151], v6, s[24:27], s53 offen offset:0 sc1
    buffer_load_dwordx4 v[180:183], v6, s[24:27], s53 offen offset:128 sc1
    s_waitcnt vmcnt(0)
    s_branch L_polla
L_bar_y:
    s_barrier
    s_branch L_barret_y
L_rrepollb:
    s_sub_u32 s58, s58, 1
    s_cbranch_scc1 L_rpolledb
    buffer_load_dword v8, off, s[28:31], s99 offset:192 sc1
    s_waitcnt vmcnt(0)
    v_readfirstlane_b32 s98, v8
    s_nop 3
    s_branch L_rpollb
L_repollb:
    s_sub_u32 s58, s58, 1
    s_cbranch_scc1 L_polledb
    buffer_load_dwordx4 v[148:151], v6, s[24:27], s53 offen offset:0 sc1
    buffer_load_dwordx4 v[180:183], v6, s[24:27], s53 offen offset:128 sc1
    s_waitcnt vmcnt(0)
    s_branch L_pollb
L_repollc:
    s_sub_u32 s58, s58, 1
    s_cbranch_scc1 L_polledc
    buffer_load_dwordx4 v[148:151], v6, s[24:27], s53 offen offset:0 sc1
    buffer_load_dwordx4 v[180:183], v6, s[24:27], s53 offen offset:128 sc1
    s_waitcnt vmcnt(0)
    s_branch L_pollc
L_bar_s1:
    s_barrier
    s_branch L_barret_s1
L_exit:
    s_endpgm
.section .rodata,"a"
.p2align 6
.amdhsa_kernel standalone__conformer_conv_module__speech_kernel
  .amdhsa_next_free_vgpr 256
  .amdhsa_next_free_sgpr 102
  .amdhsa_accum_offset 256
  .amdhsa_group_segment_fixed_size 0
  .amdhsa_kernarg_size 56
  .amdhsa_user_sgpr_count 2
  .amdhsa_user_sgpr_kernarg_segment_ptr 1
  .amdhsa_system_sgpr_workgroup_id_x 1
.end_amdhsa_kernel
```
